```python
import torch

def _softmax(x, axis=-1):
    return torch.softmax(x, dim=axis)

def _gelu(x):
    return torch.nn.functional.gelu(x, approximate='tanh')

def _silu(x):
    return torch.nn.functional.silu(x)

def _sigmoid(x):
    return torch.sigmoid(x)

def _layernorm(x, axis=-1, eps=1e-05):
    m = x.mean(dim=axis, keepdim=True)
    v = x.var(dim=axis, keepdim=True, unbiased=False)
    return (x - m) / torch.sqrt(v + eps)

def _scatter_add(tgt, idx, src, axis=0):
    return tgt.clone().index_add_(axis, idx, src)

def _segment_sum(src, seg, n):
    out = torch.zeros((n,) + src.shape[1:], dtype=src.dtype)
    return out.index_add_(0, seg, src)

def _pad(x, pw):
    flat = tuple((v for pair in reversed(pw) for v in pair))
    return torch.nn.functional.pad(x, flat)
kernel_name = 'gated_mix__grouped_kv_mqa__mixer_gmlp__prompt'

def setup_inputs():

    _w = lambda a: (lambda t: t.to(torch.bfloat16) if t.is_floating_point() else t)(torch.as_tensor(a))

    def _A_setup():
        B, S, D, H = (1, 2048, 640, 32)
        Dh = D // H
        return {'x': _w((lambda *s: torch.randn(*s, dtype=torch.bfloat16) * 0.05)(B, S, D)), 'wq': _w((lambda *s: torch.randn(*s, dtype=torch.bfloat16) * 1.6)(D, H * Dh)), 'wk': _w((lambda *s: torch.randn(*s, dtype=torch.bfloat16) * 1.6)(D, Dh)), 'wv': _w((lambda *s: torch.randn(*s, dtype=torch.bfloat16) * 0.2)(D, Dh)), 'wo': _w((lambda *s: torch.randn(*s, dtype=torch.bfloat16) * 0.2)(H * Dh, D))}
    _A_in = _A_setup()

    def _B_setup():
        B, S, D, F = (1, 2048, 640, 1536)
        Fh = F // 2
        return {'x': _w((lambda *s: torch.randn(*s, dtype=torch.bfloat16) * 0.05)(B, S, D)), 'w_in': _w((lambda *s: torch.randn(*s, dtype=torch.bfloat16) * 0.8)(D, 2 * Fh)), 'w_sp': _w(0.01 * (lambda *s: torch.randn(*s, dtype=torch.bfloat16) * 0.8)(S, S)), 'b_sp': _w(1.0 + 0.01 * (lambda *s: torch.randn(*s, dtype=torch.bfloat16) * 0.05)(S)), 'w_out': _w((lambda *s: torch.randn(*s, dtype=torch.bfloat16) * 0.05)(Fh, D))}
    _B_in = _B_setup()
    return {'A_x': _A_in['x'], 'A_wq': _A_in['wq'], 'A_wk': _A_in['wk'], 'A_wv': _A_in['wv'], 'A_wo': _A_in['wo'], 'B_x': _B_in['x'], 'B_w_in': _B_in['w_in'], 'B_w_sp': _B_in['w_sp'], 'B_b_sp': _B_in['b_sp'], 'B_w_out': _B_in['w_out'], 'gate_w': _w((lambda *s: torch.randn(*s, dtype=torch.bfloat16) * 0.05)(640) * 16.0)}

def reference(A_x, A_wq, A_wk, A_wv, A_wo, B_x, B_w_in, B_w_sp, B_b_sp, B_w_out, gate_w):

    def _A_ref(x, wq, wk, wv, wo):
        B, S, D = x.shape
        H = 32
        Dh = D // H
        q = (lambda x, *d: x.permute(*d))((x @ wq).reshape(B, S, H, Dh), 0, 2, 1, 3)
        k = x @ wk
        v = x @ wv
        scores = torch.einsum('bhqd,bkd->bhqk', q, k) * Dh ** (-0.5)
        p = _softmax(scores, axis=-1)
        o = torch.einsum('bhqk,bkd->bhqd', p, v)
        return (lambda x, *d: x.permute(*d))(o, 0, 2, 1, 3).reshape(B, S, H * Dh) @ wo

    def _B_ref(x, w_in, w_sp, b_sp, w_out):
        B, S, D = x.shape
        F = w_in.shape[-1]
        Fh = F // 2
        z = _gelu(torch.einsum('bsd,df->bsf', x, w_in))
        z1 = z[..., :Fh].clone()
        z2 = _layernorm(z[..., Fh:], axis=-1)
        g = torch.einsum('ts,bsf->btf', w_sp, z2) + b_sp[None, :, None]
        return torch.einsum('bsf,fd->bsd', z1 * g, w_out)
    x = A_x
    g = _sigmoid((x * gate_w).sum(-1, keepdims=True))
    a = _A_ref(x, A_wq, A_wk, A_wv, A_wo)
    b = _B_ref(x, B_w_in, B_w_sp, B_b_sp, B_w_out)
    return g * a + (1 - g) * b
```

```asm
; @launch grid=(256,1,1) block=(512,1,1) lds=163840
.amdgcn_target "amdgcn-amd-amdhsa--gfx950"
.text
.globl gated_mix__grouped_kv_mqa__mixer_gmlp__prompt_kernel
.p2align 8
.type gated_mix__grouped_kv_mqa__mixer_gmlp__prompt_kernel,@function
gated_mix__grouped_kv_mqa__mixer_gmlp__prompt_kernel:
    s_cmp_ge_u32 s2, 0x100
    s_cbranch_scc1 gated_mix__grouped_kv_mqa__mixer_gmlp__prompt_kernel_exit
    s_load_dwordx16 s[4:19], s[0:1], 0
    s_load_dwordx8 s[20:27], s[0:1], 64
    s_load_dwordx4 s[28:31], s[0:1], 96
    v_lshrrev_b32 v1, 6, v0
    v_and_b32 v0, 63, v0
    s_lshr_b32 s3, s2, 3
    v_readfirstlane_b32 s34, v1
    s_and_b32 s33, s3, 3
    s_lshr_b32 s32, s3, 2
    s_and_b32 s3, s2, 1
    s_lshl_b32 s3, s3, 2
    s_or_b32 s33, s33, s3
    s_bfe_u32 s3, s2, 0x20001
    s_lshl_b32 s3, s3, 3
    s_or_b32 s32, s32, s3
    s_and_b32 s52, s34, 3
    s_cmp_ge_u32 s34, 4
    s_cbranch_scc1 gated_mix__grouped_kv_mqa__mixer_gmlp__prompt_kernel_B
    s_getpc_b64 s[56:57]
gated_mix__grouped_kv_mqa__mixer_gmlp__prompt_kernel_pc:
    s_bfe_u32 s48, s2, 0x30003
    s_lshl_b32 s48, s48, 2
    s_add_u32 s48, s48, s52
    s_lshl_b32 s48, s48, 11
    v_lshl_add_u32 v2, v0, 7, s48
    v_min_u32 v2, gated_mix__grouped_kv_mqa__mixer_gmlp__prompt_kernel_exit-gated_mix__grouped_kv_mqa__mixer_gmlp__prompt_kernel_pc, v2
    s_mov_b64 exec, 0xffff
    global_load_dword v163, v2, s[56:57]
    s_mov_b64 exec, -1
    s_branch gated_mix__grouped_kv_mqa__mixer_gmlp__prompt_kernel_A
gated_mix__grouped_kv_mqa__mixer_gmlp__prompt_kernel_B:
    s_setprio 0
    v_lshrrev_b32 v22, 3, v0
    s_lshl_b32 s48, s52, 4
    v_bfe_u32 v23, v0, 4, 2
    v_and_b32 v24, 7, v0
    s_lshl_b32 s49, s32, 6
    v_xor_b32 v23, v23, v24
    s_add_u32 s49, s49, s48
    v_add_u32 v22, s49, v22
    v_mul_u32_u24 v22, 0x500, v22
    v_lshl_add_u32 v12, v23, 4, v22
    s_mul_i32 s75, s52, 3072
    v_xor_b32 v13, 64, v12
    s_lshl_b32 s49, s75, 4
    v_add_u32 v13, 9216, v13
    v_lshlrev_b32 v11, 4, v0
    v_add_u32 v22, 0, v0
    v_mul_u32_u24 v22, 5462, v22
    v_lshrrev_b32 v22, 16, v22
    v_mul_u32_u24 v22, 2880, v22
    v_add3_u32 v14, v22, v11, s49
    v_add_u32 v22, 64, v0
    v_mul_u32_u24 v22, 5462, v22
    v_lshrrev_b32 v22, 16, v22
    v_mul_u32_u24 v22, 2880, v22
    v_add3_u32 v15, v22, v11, s49
    v_add_u32 v22, 128, v0
    v_mul_u32_u24 v22, 5462, v22
    v_lshrrev_b32 v22, 16, v22
    v_mul_u32_u24 v22, 2880, v22
    v_add3_u32 v16, v22, v11, s49
    s_and_b32 s48, s33, 3
    s_mul_i32 s48, s48, 3
    s_add_u32 s72, s48, s32
    s_mul_i32 s48, s72, 26
    s_lshr_b32 s48, s48, 8
    s_mul_i32 s48, s48, 10
    s_sub_u32 s72, s72, s48
    s_lshl_b32 s73, s72, 7
    s_lshl_b32 s74, s52, 11
    s_add_u32 s74, s74, 74240
    s_mul_i32 s77, s52, 640
    v_add_u32 v20, s77, v11
    s_mul_i32 s48, s33, 192
    s_add_u32 s48, s48, 1536
    s_sub_u32 s42, 1966080, s48
    s_mov_b32 s43, 0x20000
    s_mov_b32 s62, 2621440
    s_mov_b32 s63, 0x20000
    s_cmp_lt_u32 s33, 2
    s_cselect_b32 s80, -1, 0
    s_cselect_b32 s81, 0xff, 0
    s_mov_b32 s66, 25600
    s_mov_b32 s67, 0x20000
    s_waitcnt lgkmcnt(0)
    s_mov_b32 s60, s4
    s_mov_b32 s61, s5
    s_add_u32 s40, s16, s48
    s_addc_u32 s41, s17, 0
    s_bitcmp1_b32 s33, 0
    s_cselect_b32 s64, s10, s8
    s_cselect_b32 s65, s11, s9
    s_mov_b32 s51, s73
    s_add_u32 m0, s74, 24576
    s_add_u32 s48, s73, 128
    buffer_load_dwordx4 v12, s[60:63], s73 offen  lds
    buffer_load_dwordx4 v13, s[60:63], s73 offen offset:1024  lds
    s_cmp_eq_u32 s48, 1280
    s_cselect_b32 s73, 0, s48
    s_add_u32 m0, s77, 12288
    s_mul_i32 s50, s72, 2560
    s_mov_b64 exec, s[80:81]
    buffer_load_dwordx4 v20, s[64:67], s50 offen lds
    s_mov_b64 exec, -1
    s_add_u32 m0, s75, 0
    s_mul_i32 s50, s72, 196608
    buffer_load_dwordx4 v14, s[40:43], s50 offen offset:0  lds
    s_add_u32 s72, s72, 1
    s_cmp_eq_u32 s72, 10
    s_cselect_b32 s72, 0, s72
    buffer_load_dwordx4 v15, s[40:43], s50 offen offset:1024  lds
    buffer_load_dwordx4 v16, s[40:43], s50 offen offset:2048  lds
    s_add_u32 m0, s74, 32768
    s_add_u32 s48, s73, 128
    buffer_load_dwordx4 v12, s[60:63], s73 offen  lds
    buffer_load_dwordx4 v13, s[60:63], s73 offen offset:1024  lds
    s_cmp_eq_u32 s48, 1280
    s_cselect_b32 s73, 0, s48
    s_add_u32 m0, s77, 27136
    s_mul_i32 s50, s72, 2560
    s_mov_b64 exec, s[80:81]
    buffer_load_dwordx4 v20, s[64:67], s50 offen lds
    s_mov_b64 exec, -1
    s_add_u32 m0, s75, 14848
    s_mul_i32 s50, s72, 196608
    buffer_load_dwordx4 v14, s[40:43], s50 offen offset:0  lds
    s_add_u32 s72, s72, 1
    s_cmp_eq_u32 s72, 10
    s_cselect_b32 s72, 0, s72
    buffer_load_dwordx4 v15, s[40:43], s50 offen offset:1024  lds
    buffer_load_dwordx4 v16, s[40:43], s50 offen offset:2048  lds
    s_add_u32 m0, s74, 0
    s_add_u32 s48, s73, 128
    buffer_load_dwordx4 v12, s[60:63], s73 offen  lds
    buffer_load_dwordx4 v13, s[60:63], s73 offen offset:1024  lds
    s_cmp_eq_u32 s48, 1280
    s_cselect_b32 s73, 0, s48
    s_add_u32 m0, s77, 41984
    s_mul_i32 s50, s72, 2560
    s_mov_b64 exec, s[80:81]
    buffer_load_dwordx4 v20, s[64:67], s50 offen lds
    s_mov_b64 exec, -1
    s_add_u32 m0, s75, 29696
    s_mul_i32 s50, s72, 196608
    buffer_load_dwordx4 v14, s[40:43], s50 offen offset:0  lds
    s_add_u32 s72, s72, 1
    s_cmp_eq_u32 s72, 10
    s_cselect_b32 s72, 0, s72
    buffer_load_dwordx4 v15, s[40:43], s50 offen offset:1024  lds
    buffer_load_dwordx4 v16, s[40:43], s50 offen offset:2048  lds
    s_mov_b32 s36, s30
    s_mov_b32 s37, s31
    s_mov_b32 s38, 0x135c000
    s_mov_b32 s39, 0x20000
    s_mov_b32 s48, 0x135b000
    s_load_dword s59, s[30:31], s48
    s_mul_i32 s48, s52, 320
    s_add_u32 s48, s48, s51
    v_add_u32 v21, s48, v11
    v_subrev_u32 v22, 1280, v21
    v_min_u32 v21, v21, v22
    s_and_b32 s48, s52, 1
    s_mul_i32 s76, s48, 6144
    s_mul_i32 s49, s48, 20480
    s_cmp_lt_u32 s52, 2
    s_cselect_b32 s82, 98304, 0
    s_cselect_b64 vcc, -1, 0
    s_cselect_b32 s48, 0, 3072
    s_add_u32 s76, s76, s48
    s_max_u32 s82, s82, 40960
    s_mul_i32 s83, s82, 20
    v_add_u32 v22, 0, v0
    v_mul_u32_u24 v22, 6554, v22
    v_lshrrev_b32 v22, 16, v22
    v_mul_u32_u24 v23, 160, v22
    v_sub_u32 v23, v11, v23
    v_and_b32 v24, 8, v22
    v_bfe_u32 v25, v22, 1, 2
    v_and_b32 v22, 1, v22
    v_lshl_add_u32 v22, v22, 2, v25
    v_add_u32 v22, v22, v24
    v_mul_u32_u24 v22, 0x500, v22
    v_add3_u32 v17, v22, v23, s49
    v_cndmask_b32 v17, v17, v14, vcc
    v_add_u32 v22, 64, v0
    v_mul_u32_u24 v22, 6554, v22
    v_lshrrev_b32 v22, 16, v22
    v_mul_u32_u24 v23, 160, v22
    v_sub_u32 v23, v11, v23
    v_and_b32 v24, 8, v22
    v_bfe_u32 v25, v22, 1, 2
    v_and_b32 v22, 1, v22
    v_lshl_add_u32 v22, v22, 2, v25
    v_add_u32 v22, v22, v24
    v_mul_u32_u24 v22, 0x500, v22
    v_add3_u32 v18, v22, v23, s49
    v_cndmask_b32 v18, v18, v15, vcc
    v_add_u32 v22, 128, v0
    v_mul_u32_u24 v22, 6554, v22
    v_lshrrev_b32 v22, 16, v22
    v_mul_u32_u24 v23, 160, v22
    v_sub_u32 v23, v11, v23
    v_and_b32 v24, 8, v22
    v_bfe_u32 v25, v22, 1, 2
    v_and_b32 v22, 1, v22
    v_lshl_add_u32 v22, v22, 2, v25
    v_add_u32 v22, v22, v24
    v_mul_u32_u24 v22, 0x500, v22
    v_add3_u32 v19, v22, v23, s49
    s_mov_b32 exec_lo, 0
    v_mov_b32 v19, -4.0
    s_mov_b32 exec_lo, -1
    v_cndmask_b32 v19, v19, v16, vcc
    s_and_b32 s53, s34, 1
    s_bfe_u32 s54, s34, 0x10001
    s_xor_b32 s58, s52, s33
    s_and_b32 s58, s58, 3
    s_xor_b32 s48, s58, 1
    s_lshl_b32 s49, s32, 2
    s_add_u32 s48, s48, s49
    s_mul_i32 s44, s48, 45056
    s_xor_b32 s48, s58, 2
    s_lshl_b32 s49, s32, 2
    s_add_u32 s48, s48, s49
    s_mul_i32 s45, s48, 45056
    s_xor_b32 s48, s58, 3
    s_lshl_b32 s49, s32, 2
    s_add_u32 s48, s48, s49
    s_mul_i32 s46, s48, 45056
    s_xor_b32 s48, s58, 0
    s_lshl_b32 s49, s32, 2
    s_add_u32 s48, s48, s49
    s_mul_i32 s47, s48, 45056
    v_lshlrev_b32 v1, 4, v0
    v_and_b32 v22, 31, v0
    v_lshrrev_b32 v23, 5, v0
    v_lshlrev_b32 v2, 4, v22
    v_min_u32 v3, 23, v22
    v_mul_u32_u24 v23, 0x180, v23
    v_lshl_add_u32 v3, v3, 4, v23
    v_add_u32 v1, 74240, v1
    v_add_u32 v2, 74240, v2
    v_add_u32 v3, 74240, v3
    s_add_u32 s69, s75, 74240
    v_add_u32 v4, s75, v11
    v_add_u32 v30, 115200, v4
    s_lshr_b32 s68, s32, 1
    s_mul_i32 s68, s68, 12288
    s_add_u32 s68, s68, 0x280000
    v_add_u32 v252, 0x1000, v11
    s_mov_b32 s70, 0x8000
    s_mov_b32 s78, 0x60000
    s_and_b32 s48, s32, 30
    v_min_u32 v253, 11, v0
    v_lshl_add_u32 v253, s48, 1, v253
    v_and_b32 v253, 63, v253
    v_lshlrev_b32 v253, 7, v253
    s_lshl_b32 s48, s33, 2
    s_add_u32 s48, s48, s52
    s_lshl_b32 s88, s48, 12
    s_add_u32 s88, s88, 0x20000
    s_mul_i32 s71, s48, 56320
    s_add_u32 s71, s71, 0x1162000
    s_mul_i32 s48, s52, 6144
    s_add_u32 s48, s48, 0xbd5000
    s_add_u32 s44, s44, s48
    s_add_u32 s45, s45, s48
    s_add_u32 s46, s46, s48
    s_add_u32 s47, s47, s48
    s_waitcnt vmcnt(12)
    s_barrier
    s_add_u32 m0, s74, 8192
    s_add_u32 s48, s73, 128
    buffer_load_dwordx4 v12, s[60:63], s73 offen  lds
    buffer_load_dwordx4 v13, s[60:63], s73 offen offset:1024  lds
    s_cmp_eq_u32 s48, 1280
    s_cselect_b32 s73, 0, s48
    s_add_u32 m0, s77, 56832
    s_mul_i32 s50, s72, 2560
    s_mov_b64 exec, s[80:81]
    buffer_load_dwordx4 v20, s[64:67], s50 offen lds
    s_mov_b64 exec, -1
    s_add_u32 m0, s75, 44544
    s_mul_i32 s50, s72, 196608
    buffer_load_dwordx4 v14, s[40:43], s50 offen offset:0  lds
    s_add_u32 s72, s72, 1
    s_cmp_eq_u32 s72, 10
    s_cselect_b32 s72, 0, s72
    buffer_load_dwordx4 v15, s[40:43], s50 offen offset:1024  lds
    buffer_load_dwordx4 v16, s[40:43], s50 offen offset:2048  lds
    s_add_u32 m0, s74, 16384
    s_add_u32 s48, s73, 128
    buffer_load_dwordx4 v12, s[60:63], s73 offen  lds
    buffer_load_dwordx4 v13, s[60:63], s73 offen offset:1024  lds
    s_cmp_eq_u32 s48, 1280
    s_cselect_b32 s73, 0, s48
    s_add_u32 m0, s77, 71680
    s_mul_i32 s50, s72, 2560
    s_mov_b64 exec, s[80:81]
    buffer_load_dwordx4 v20, s[64:67], s50 offen lds
    s_mov_b64 exec, -1
    s_add_u32 m0, s75, 59392
    s_mul_i32 s50, s72, 196608
    buffer_load_dwordx4 v14, s[40:43], s50 offen offset:0  lds
    s_add_u32 s72, s72, 1
    s_cmp_eq_u32 s72, 10
    s_cselect_b32 s72, 0, s72
    buffer_load_dwordx4 v15, s[40:43], s50 offen offset:1024  lds
    buffer_load_dwordx4 v16, s[40:43], s50 offen offset:2048  lds
    s_waitcnt vmcnt(18)
    s_barrier
    s_add_u32 m0, s74, 40960
    s_add_u32 s48, s73, 128
    buffer_load_dwordx4 v12, s[60:63], s73 offen  lds
    buffer_load_dwordx4 v13, s[60:63], s73 offen offset:1024  lds
    s_cmp_eq_u32 s48, 1280
    s_cselect_b32 s73, 0, s48
    s_add_u32 m0, s77, 12288
    s_mul_i32 s50, s72, 2560
    s_mov_b64 exec, s[80:81]
    buffer_load_dwordx4 v20, s[64:67], s50 offen lds
    s_mov_b64 exec, -1
    s_add_u32 m0, s75, 0
    s_mul_i32 s50, s72, 196608
    buffer_load_dwordx4 v14, s[40:43], s50 offen offset:0  lds
    s_add_u32 s72, s72, 1
    s_cmp_eq_u32 s72, 10
    s_cselect_b32 s72, 0, s72
    buffer_load_dwordx4 v15, s[40:43], s50 offen offset:1024  lds
    buffer_load_dwordx4 v16, s[40:43], s50 offen offset:2048  lds
    s_add_u32 m0, s74, 49152
    s_add_u32 s48, s73, 128
    buffer_load_dwordx4 v12, s[60:63], s73 offen  lds
    buffer_load_dwordx4 v13, s[60:63], s73 offen offset:1024  lds
    s_cmp_eq_u32 s48, 1280
    s_cselect_b32 s73, 0, s48
    s_waitcnt vmcnt(20)
    s_barrier
    s_add_u32 m0, s74, 57344
    s_add_u32 s48, s73, 128
    buffer_load_dwordx4 v12, s[60:63], s73 offen  lds
    buffer_load_dwordx4 v13, s[60:63], s73 offen offset:1024  lds
    s_cmp_eq_u32 s48, 1280
    s_cselect_b32 s73, 0, s48
    s_add_u32 m0, s77, 27136
    s_mul_i32 s50, s72, 2560
    s_mov_b64 exec, s[80:81]
    buffer_load_dwordx4 v20, s[64:67], s50 offen lds
    s_mov_b64 exec, -1
    s_add_u32 m0, s75, 14848
    s_mul_i32 s50, s72, 196608
    buffer_load_dwordx4 v14, s[40:43], s50 offen offset:0  lds
    s_add_u32 s72, s72, 1
    s_cmp_eq_u32 s72, 10
    s_cselect_b32 s72, 0, s72
    buffer_load_dwordx4 v15, s[40:43], s50 offen offset:1024  lds
    buffer_load_dwordx4 v16, s[40:43], s50 offen offset:2048  lds
    s_add_u32 m0, s74, 65536
    s_add_u32 s48, s73, 128
    buffer_load_dwordx4 v12, s[60:63], s73 offen  lds
    buffer_load_dwordx4 v13, s[60:63], s73 offen offset:1024  lds
    s_cmp_eq_u32 s48, 1280
    s_cselect_b32 s73, 0, s48
    s_waitcnt vmcnt(22)
    s_barrier
    s_add_u32 m0, s74, 73728
    s_add_u32 s48, s73, 128
    buffer_load_dwordx4 v12, s[60:63], s73 offen  lds
    buffer_load_dwordx4 v13, s[60:63], s73 offen offset:1024  lds
    s_cmp_eq_u32 s48, 1280
    s_cselect_b32 s73, 0, s48
    s_add_u32 m0, s77, 41984
    s_mul_i32 s50, s72, 2560
    s_mov_b64 exec, s[80:81]
    buffer_load_dwordx4 v20, s[64:67], s50 offen lds
    s_mov_b64 exec, -1
    s_add_u32 m0, s75, 29696
    s_mul_i32 s50, s72, 196608
    buffer_load_dwordx4 v14, s[40:43], s50 offen offset:0  lds
    s_add_u32 s72, s72, 1
    s_cmp_eq_u32 s72, 10
    s_cselect_b32 s72, 0, s72
    buffer_load_dwordx4 v15, s[40:43], s50 offen offset:1024  lds
    buffer_load_dwordx4 v16, s[40:43], s50 offen offset:2048  lds
    s_waitcnt vmcnt(22)
    s_barrier
    s_add_u32 m0, s77, 56832
    s_mul_i32 s50, s72, 2560
    s_mov_b64 exec, s[80:81]
    buffer_load_dwordx4 v20, s[64:67], s50 offen lds
    s_mov_b64 exec, -1
    s_add_u32 m0, s75, 44544
    s_mul_i32 s50, s72, 196608
    buffer_load_dwordx4 v14, s[40:43], s50 offen offset:0  lds
    s_add_u32 s72, s72, 1
    s_cmp_eq_u32 s72, 10
    s_cselect_b32 s72, 0, s72
    buffer_load_dwordx4 v15, s[40:43], s50 offen offset:1024  lds
    buffer_load_dwordx4 v16, s[40:43], s50 offen offset:2048  lds
    s_waitcnt vmcnt(20)
    s_barrier
    s_add_u32 m0, s77, 71680
    s_mul_i32 s50, s72, 2560
    s_mov_b64 exec, s[80:81]
    buffer_load_dwordx4 v20, s[64:67], s50 offen lds
    s_mov_b64 exec, -1
    s_add_u32 m0, s75, 59392
    s_mul_i32 s50, s72, 196608
    buffer_load_dwordx4 v14, s[40:43], s50 offen offset:0  lds
    s_add_u32 s72, s72, 1
    s_cmp_eq_u32 s72, 10
    s_cselect_b32 s72, 0, s72
    buffer_load_dwordx4 v15, s[40:43], s50 offen offset:1024  lds
    buffer_load_dwordx4 v16, s[40:43], s50 offen offset:2048  lds
    s_mul_i32 s48, s52, 320
    s_add_u32 m0, s48, 156160
    s_mov_b32 s60, s24
    s_mov_b32 s61, s25
    s_mov_b32 s62, 1280
    s_mov_b64 exec, 0xfffff
    buffer_load_dwordx4 v21, s[60:63], 0 offen lds
    s_mov_b64 exec, -1
    s_waitcnt vmcnt(17)
    s_barrier
    s_mul_i32 s48, s33, 160
    s_add_u32 s56, s6, s48
    s_addc_u32 s57, s7, 0
    s_sub_u32 s48, 819200, s48
    s_sub_u32 s40, s40, 1536
    s_subb_u32 s41, s41, 0
    s_mul_i32 s72, s72, s82
    s_lshl_b32 s72, s72, 1
    s_cmp_lt_u32 s52, 2
    s_cselect_b64 s[40:41], s[40:41], s[56:57]
    s_cselect_b32 s42, s42, s48
    s_add_u32 m0, s76, 0
    s_add_u32 s50, s72, s82
    buffer_load_dwordx4 v17, s[40:43], s72 offen offset:0  lds
    buffer_load_dwordx4 v18, s[40:43], s72 offen offset:1024  lds
    v_lshrrev_b32 v23, 5, v0
    v_bfe_u32 v24, v0, 2, 2
    v_and_b32 v25, 31, v0
    v_and_b32 v27, 3, v0
    s_lshl_b32 s48, s53, 1
    s_add_u32 s48, s48, s54
    s_lshl_b32 s48, s48, 9
    s_add_u32 s48, s48, 157440
    v_lshl_add_u32 v212, v0, 3, s48
    buffer_load_dwordx4 v19, s[40:43], s72 offen offset:2048  lds
    s_cmp_eq_u32 s50, s83
    s_cselect_b32 s72, 0, s50
    s_lshl_b32 s48, s52, 10
    s_add_u32 s48, s48, 159488
    v_lshl_add_u32 v208, v25, 5, s48
    v_lshl_add_u32 v208, v23, 3, v208
    v_lshrrev_b32 v28, 4, v0
    v_lshl_add_u32 v209, v28, 3, v24
    v_lshl_add_u32 v209, v209, 5, s48
    v_lshl_add_u32 v209, v27, 3, v209
    s_waitcnt vmcnt(12)
    s_barrier
    s_add_u32 m0, s76, 12288
    s_add_u32 s50, s72, s82
    buffer_load_dwordx4 v17, s[40:43], s72 offen offset:0  lds
    buffer_load_dwordx4 v18, s[40:43], s72 offen offset:1024  lds
    v_mul_u32_u24 v210, 3072, v23
    v_and_b32 v28, 1, v28
    v_lshl_add_u32 v210, v28, 9, v210
    v_and_b32 v28, 7, v0
    v_lshl_add_u32 v210, v28, 4, v210
    v_bfe_u32 v28, v0, 3, 1
    v_lshl_add_u32 v210, v28, 8, v210
    v_add_u32 v215, 61952, v4
    buffer_load_dwordx4 v19, s[40:43], s72 offen offset:2048  lds
    s_cmp_eq_u32 s50, s83
    s_cselect_b32 s72, 0, s50
    s_lshl_b32 s48, s32, 1
    s_add_u32 s48, s48, s53
    s_lshl_b32 s85, s48, 12
    s_add_u32 s85, s85, 0x131a000
    s_mul_i32 s84, s48, 6144
    s_mul_i32 s48, s33, 393216
    s_add_u32 s84, s84, s48
    s_lshl_b32 s48, s54, 7
    s_add_u32 s84, s84, s48
    s_add_u32 s84, s84, 0x8d0000
    s_waitcnt vmcnt(11)
    s_barrier
    s_add_u32 m0, s76, 24576
    s_add_u32 s50, s72, s82
    buffer_load_dwordx4 v17, s[40:43], s72 offen offset:0  lds
    buffer_load_dwordx4 v18, s[40:43], s72 offen offset:1024  lds
    s_lshl_b32 s48, s33, 5
    s_add_u32 s48, s48, s32
    s_lshl_b32 s48, s48, 2
    s_add_u32 s48, s48, s52
    s_lshl_b32 s86, s48, 7
    s_lshl_b32 s48, s32, 2
    s_add_u32 s48, s48, s52
    s_lshl_b32 s48, s48, 10
    s_add_u32 s87, s48, 0x40000
    buffer_load_dwordx4 v19, s[40:43], s72 offen offset:2048  lds
    s_cmp_eq_u32 s50, s83
    s_cselect_b32 s72, 0, s50
    s_lshl_b32 s49, s54, 5
    s_sub_u32 s49, 32, s49
    v_cmp_gt_u32 vcc, s49, v0
    s_lshl_b32 s48, s33, 9
    v_add_u32 v28, s48, v11
    v_cndmask_b32 v213, -4.0, v28, vcc
    v_mov_b32 v192, 0xc0135761
    v_mov_b64 v[188:189], 0
    v_mov_b64 v[190:191], 0
    s_waitcnt vmcnt(10)
    s_barrier
    s_add_u32 m0, s76, 36864
    s_add_u32 s50, s72, s82
    buffer_load_dwordx4 v17, s[40:43], s72 offen offset:0  lds
    buffer_load_dwordx4 v18, s[40:43], s72 offen offset:1024  lds
    s_lshr_b32 s48, s32, 1
    s_mul_i32 s51, s48, 12288
    s_and_b32 s48, s32, 1
    s_lshl_b32 s49, s48, 1
    s_add_u32 s49, s49, s53
    s_mul_i32 s66, s49, 1536
    s_add_u32 s66, s66, 5120
    s_lshl_b32 s49, s49, 10
    s_lshl_b32 s48, s48, 9
    s_add_u32 s48, s48, 0x1000
    s_cmp_eq_u32 s54, 0
    s_cselect_b32 s48, s49, s48
    s_cselect_b32 s49, 16, 0x400
    v_add_u32 v236, s49, v208
    s_cmp_eq_u32 s33, 0
    s_cselect_b32 s48, s48, s66
    s_cselect_b64 s[80:81], -1, 0
    s_add_u32 s51, s51, s48
    s_add_u32 s51, s51, 0x280000
    s_cmp_lt_u32 s33, 2
    s_cselect_b32 s66, s51, 0x135c000
    buffer_load_dwordx4 v19, s[40:43], s72 offen offset:2048  lds
    s_cmp_eq_u32 s50, s83
    s_cselect_b32 s72, 0, s50
    s_lshl_b32 s48, s54, 4
    v_and_b32 v26, 15, v0
    v_add_u32 v26, s48, v26
    v_lshrrev_b32 v238, 4, v0
    v_mul_u32_u24 v238, 0x180, v238
    v_lshl_add_u32 v238, v26, 4, v238
    v_mov_b32 v239, 0x3f803f80
    v_cmp_eq_u32 vcc, 20, v26
    v_cmp_gt_u32 s[64:65], 24, v26
    s_lshl_b32 s48, s52, 5
    s_sub_u32 s48, 96, s48
    v_cndmask_b32 v239, 0, v239, vcc
    v_cmp_gt_u32 vcc, s48, v0
    v_cndmask_b32 v238, -4.0, v238, s[64:65]
    v_cmp_gt_u32 s[64:65], 20, v26
    v_cndmask_b32 v26, -4.0, v11, vcc
    v_cndmask_b32 v238, v238, v26, s[80:81]
    s_or_b64 s[64:65], s[64:65], s[80:81]
    s_waitcnt vmcnt(9)
    s_barrier
    s_add_u32 m0, s76, 49152
    s_add_u32 s50, s72, s82
    buffer_load_dwordx4 v17, s[40:43], s72 offen offset:0  lds
    buffer_load_dwordx4 v18, s[40:43], s72 offen offset:1024  lds
    s_and_b32 s48, s32, 7
    s_lshl_b32 s48, s48, 2
    s_add_u32 s48, s48, s52
    s_lshr_b32 s49, s32, 3
    s_lshl_b32 s51, s33, 2
    s_add_u32 s51, s51, s49
    s_mul_i32 s51, s51, 55
    s_add_u32 s51, s51, s48
    s_lshl_b32 s51, s51, 10
    s_add_u32 s89, s51, 0x1162000
    s_add_u32 s90, s51, 0x1169800
    s_cmp_lt_u32 s48, 30
    s_cselect_b32 s89, s89, 0x135c000
    s_cmp_lt_u32 s48, 25
    s_cselect_b32 s90, s90, 0x135c000
    s_mul_i32 s56, s48, 52
    s_lshr_b32 s56, s56, 8
    s_sub_u32 s51, s33, s56
    s_mul_i32 s51, s51, 5
    s_add_u32 s51, s51, s48
    s_lshl_b32 s51, s51, 5
    v_and_b32 v22, 1, v0
    v_lshl_add_u32 v22, v22, 4, s51
    v_bfe_u32 v26, v0, 1, 2
    v_bfe_u32 v27, v0, 3, 1
    v_bfe_u32 v28, v0, 4, 1
    buffer_load_dwordx4 v19, s[40:43], s72 offen offset:2048  lds
    s_cmp_eq_u32 s50, s83
    s_cselect_b32 s72, 0, s50
    s_lshr_b32 s49, s32, 3
    s_mul_i32 s51, s49, 12
    s_add_u32 s51, s51, s56
    s_cmp_ge_u32 s56, 3
    s_cselect_b32 s48, 3, 0
    s_add_u32 s51, s51, s48
    s_lshl_b32 s51, s51, 4
    v_lshl_add_u32 v217, v27, 2, v26
    v_mad_u32_u24 v217, v28, 48, v217
    v_lshl_add_u32 v217, v23, 3, v217
    v_add_u32 v217, s51, v217
    v_mul_u32_u24 v217, 0x500, v217
    v_add_u32 v217, v217, v22
    s_waitcnt vmcnt(9)
    s_barrier
    s_and_b32 s48, s56, 1
    s_and_b32 s51, s56, 2
    s_lshl_b32 s51, s51, 1
    s_add_u32 s51, s51, s48
    s_mul_i32 s51, s51, 20
    s_cmp_eq_u32 s56, 4
    s_cselect_b32 s51, 16, s51
    s_cselect_b32 s48, 20, 4
    v_mad_u32_u24 v218, v27, s48, v26
    s_cselect_b32 s48, 80, 40
    v_mad_u32_u24 v218, v28, s48, v218
    s_cselect_b32 s48, 40, 8
    v_mad_u32_u24 v218, v23, s48, v218
    s_lshr_b32 s49, s32, 3
    s_mul_i32 s49, s49, 160
    s_add_u32 s51, s51, s49
    v_add_u32 v218, s51, v218
    v_mul_u32_u24 v218, 0x500, v218
    v_add_u32 v218, v218, v22
    s_lshl_b32 s48, s52, 11
    s_add_u32 s77, s48, 143872
    v_lshl_add_u32 v216, v0, 3, s77
    s_waitcnt lgkmcnt(0)
    s_add_u32 s59, s59, 0x9e3779b9
    v_mov_b32 v245, s59
    v_mov_b32 v247, s59
    s_lshl_b32 s48, s32, 1
    s_add_u32 s48, s48, s33
    s_lshl_b32 s48, s48, 7
    s_add_u32 s73, s48, 0x60000
    s_lshl_b32 s48, s52, 1
    s_or_b32 s48, s48, s33
    s_cmp_lt_u32 s48, 2
    s_cselect_b32 s73, s73, 0x135c000
    s_waitcnt vmcnt(6)
    s_barrier
    ds_read_b128 v[196:199], v215 offset:0
    ds_read_b64_tr_b16 v[232:233], v209
    ds_read_b64_tr_b16 v[234:235], v209 offset:128
    s_mov_b64 exec, s[80:81]
    ds_read_b64 v[232:233], v208
    ds_read_b64 v[234:235], v236
    s_mov_b64 exec, -1
    s_add_u32 m0, s76, 0
    s_add_u32 s50, s72, s82
    buffer_load_dwordx4 v17, s[40:43], s72 offen offset:0  lds
    s_waitcnt lgkmcnt(4)
    v_lshlrev_b32 v104, 16, v196
    v_and_b32 v105, 0xffff0000, v196
    v_lshlrev_b32 v106, 16, v197
    v_and_b32 v107, 0xffff0000, v197
    v_lshlrev_b32 v108, 16, v198
    v_and_b32 v109, 0xffff0000, v198
    buffer_load_dwordx4 v18, s[40:43], s72 offen offset:1024  lds
    v_lshlrev_b32 v110, 16, v199
    v_and_b32 v111, 0xffff0000, v199
    v_mul_f32 v168, v104, v104
    v_mul_f32 v169, v105, v105
    v_mul_f32 v170, v106, v106
    v_mul_f32 v171, v107, v107
    v_mul_f32 v172, v108, v108
    buffer_load_dwordx4 v19, s[40:43], s72 offen offset:2048  lds
    s_cmp_eq_u32 s50, s83
    s_cselect_b32 s72, 0, s50
    v_mul_f32 v173, v109, v109
    v_mul_f32 v174, v110, v110
    v_mul_f32 v175, v111, v111
    v_fmamk_f32 v168, v168, 0xbdd2d3e8, v192
    v_fmamk_f32 v169, v169, 0xbdd2d3e8, v192
    v_fmamk_f32 v170, v170, 0xbdd2d3e8, v192
    v_fmamk_f32 v171, v171, 0xbdd2d3e8, v192
    s_waitcnt lgkmcnt(0)
    v_cndmask_b32 v232, v239, v232, s[64:65]
    v_cndmask_b32 v233, v239, v233, s[64:65]
    v_cndmask_b32 v234, v239, v234, s[64:65]
    v_cndmask_b32 v235, v239, v235, s[64:65]
    buffer_store_dwordx4 v[232:235], v238, s[36:39], s66 offen sc1
    v_fmamk_f32 v172, v172, 0xbdd2d3e8, v192
    v_fmamk_f32 v173, v173, 0xbdd2d3e8, v192
    v_fmamk_f32 v174, v174, 0xbdd2d3e8, v192
    v_fmamk_f32 v175, v175, 0xbdd2d3e8, v192
    v_mul_f32 v168, v168, v104
    s_waitcnt vmcnt(7)
    s_barrier
    ds_read_b128 v[200:203], v215 offset:1024
    s_add_u32 m0, s76, 12288
    s_add_u32 s50, s72, s82
    buffer_load_dwordx4 v17, s[40:43], s72 offen offset:0  lds
    v_mul_f32 v169, v169, v105
    v_mul_f32 v170, v170, v106
    v_mul_f32 v171, v171, v107
    v_mul_f32 v172, v172, v108
    v_mul_f32 v173, v173, v109
    v_mul_f32 v174, v174, v110
    buffer_load_dwordx4 v18, s[40:43], s72 offen offset:1024  lds
    v_mul_f32 v175, v175, v111
    v_exp_f32 v168, v168
    v_exp_f32 v169, v169
    v_exp_f32 v170, v170
    v_exp_f32 v171, v171
    buffer_load_dwordx4 v19, s[40:43], s72 offen offset:2048  lds
    s_cmp_eq_u32 s50, s83
    s_cselect_b32 s72, 0, s50
    v_exp_f32 v172, v172
    v_exp_f32 v173, v173
    v_exp_f32 v174, v174
    v_exp_f32 v175, v175
    v_add_f32 v168, 1.0, v168
    v_add_f32 v169, 1.0, v169
    v_add_f32 v170, 1.0, v170
    v_add_f32 v171, 1.0, v171
    v_add_f32 v172, 1.0, v172
    v_add_f32 v173, 1.0, v173
    v_add_f32 v174, 1.0, v174
    v_add_f32 v175, 1.0, v175
    v_rcp_f32 v168, v168
    s_waitcnt vmcnt(7)
    s_barrier
    ds_read_b128 v[204:207], v215 offset:2048
    s_add_u32 m0, s76, 24576
    s_add_u32 s50, s72, s82
    buffer_load_dwordx4 v17, s[40:43], s72 offen offset:0  lds
    v_rcp_f32 v169, v169
    v_rcp_f32 v170, v170
    v_rcp_f32 v171, v171
    v_rcp_f32 v172, v172
    v_rcp_f32 v173, v173
    buffer_load_dwordx4 v18, s[40:43], s72 offen offset:1024  lds
    v_rcp_f32 v174, v174
    v_rcp_f32 v175, v175
    v_mul_f32 v104, v104, v168
    v_mul_f32 v105, v105, v169
    v_mul_f32 v106, v106, v170
    v_mul_f32 v107, v107, v171
    buffer_load_dwordx4 v19, s[40:43], s72 offen offset:2048  lds
    s_cmp_eq_u32 s50, s83
    s_cselect_b32 s72, 0, s50
    v_mul_f32 v108, v108, v172
    v_mul_f32 v109, v109, v173
    v_mul_f32 v110, v110, v174
    v_mul_f32 v111, v111, v175
    v_add_f32 v188, v188, v104
    v_add_f32 v189, v189, v105
    v_add_f32 v188, v188, v106
    v_add_f32 v189, v189, v107
    v_add_f32 v188, v188, v108
    v_add_f32 v189, v189, v109
    v_add_f32 v188, v188, v110
    v_add_f32 v189, v189, v111
    s_waitcnt vmcnt(7) lgkmcnt(0)
    s_barrier
    s_add_u32 m0, s76, 36864
    s_add_u32 s50, s72, s82
    buffer_load_dwordx4 v17, s[40:43], s72 offen offset:0  lds
    v_fmac_f32 v190, v104, v104
    v_fmac_f32 v191, v105, v105
    v_fmac_f32 v190, v106, v106
    buffer_load_dwordx4 v18, s[40:43], s72 offen offset:1024  lds
    v_fmac_f32 v191, v107, v107
    v_fmac_f32 v190, v108, v108
    v_fmac_f32 v191, v109, v109
    buffer_load_dwordx4 v19, s[40:43], s72 offen offset:2048  lds
    s_cmp_eq_u32 s50, s83
    s_cselect_b32 s72, 0, s50
    v_fmac_f32 v190, v110, v110
    v_fmac_f32 v191, v111, v111
    v_lshlrev_b32 v112, 16, v200
    v_and_b32 v113, 0xffff0000, v200
    s_add_u32 m0, s76, 61440
    s_add_u32 s50, s72, s82
    buffer_load_dwordx4 v17, s[40:43], s72 offen offset:0  lds
    v_lshlrev_b32 v114, 16, v201
    v_and_b32 v115, 0xffff0000, v201
    v_lshlrev_b32 v116, 16, v202
    v_and_b32 v117, 0xffff0000, v202
    buffer_load_dwordx4 v18, s[40:43], s72 offen offset:1024  lds
    v_lshlrev_b32 v118, 16, v203
    v_and_b32 v119, 0xffff0000, v203
    v_mul_f32 v168, v112, v112
    v_mul_f32 v169, v113, v113
    buffer_load_dwordx4 v19, s[40:43], s72 offen offset:2048  lds
    s_cmp_eq_u32 s50, s83
    s_cselect_b32 s72, 0, s50
    v_mul_f32 v170, v114, v114
    v_mul_f32 v171, v115, v115
    v_mul_f32 v172, v116, v116
    v_mul_f32 v173, v117, v117
    v_mul_f32 v174, v118, v118
    v_mul_f32 v175, v119, v119
    v_fmamk_f32 v168, v168, 0xbdd2d3e8, v192
    v_fmamk_f32 v169, v169, 0xbdd2d3e8, v192
    v_fmamk_f32 v170, v170, 0xbdd2d3e8, v192
    v_fmamk_f32 v171, v171, 0xbdd2d3e8, v192
    s_waitcnt vmcnt(9)
    s_barrier
    s_mov_b64 exec, 1
    buffer_store_dword v245, off, s[36:39], s73 sc1
    s_mov_b64 exec, -1
    s_add_u32 m0, s76, 49152
    s_add_u32 s50, s72, s82
    buffer_load_dwordx4 v17, s[40:43], s72 offen offset:0  lds
    v_fmamk_f32 v172, v172, 0xbdd2d3e8, v192
    v_fmamk_f32 v173, v173, 0xbdd2d3e8, v192
    v_fmamk_f32 v174, v174, 0xbdd2d3e8, v192
    v_fmamk_f32 v175, v175, 0xbdd2d3e8, v192
    v_mul_f32 v168, v168, v112
    buffer_load_dwordx4 v18, s[40:43], s72 offen offset:1024  lds
    v_mul_f32 v169, v169, v113
    v_mul_f32 v170, v170, v114
    v_mul_f32 v171, v171, v115
    v_mul_f32 v172, v172, v116
    v_mul_f32 v173, v173, v117
    v_mul_f32 v174, v174, v118
    buffer_load_dwordx4 v19, s[40:43], s72 offen offset:2048  lds
    s_cmp_eq_u32 s50, s83
    s_cselect_b32 s72, 0, s50
    v_mul_f32 v175, v175, v119
    v_exp_f32 v168, v168
    v_exp_f32 v169, v169
    v_exp_f32 v170, v170
    v_exp_f32 v171, v171
    v_exp_f32 v172, v172
    v_exp_f32 v173, v173
    v_exp_f32 v174, v174
    v_exp_f32 v175, v175
    v_add_f32 v168, 1.0, v168
    v_add_f32 v169, 1.0, v169
    v_add_f32 v170, 1.0, v170
    s_waitcnt vmcnt(10)
    s_barrier
    s_add_u32 m0, s76, 0
    s_add_u32 s50, s72, s82
    buffer_load_dwordx4 v17, s[40:43], s72 offen offset:0  lds
    v_add_f32 v171, 1.0, v171
    v_add_f32 v172, 1.0, v172
    v_add_f32 v173, 1.0, v173
    v_add_f32 v174, 1.0, v174
    v_add_f32 v175, 1.0, v175
    v_rcp_f32 v168, v168
    buffer_load_dwordx4 v18, s[40:43], s72 offen offset:1024  lds
    v_rcp_f32 v169, v169
    v_rcp_f32 v170, v170
    v_rcp_f32 v171, v171
    v_rcp_f32 v172, v172
    v_rcp_f32 v173, v173
    buffer_load_dwordx4 v19, s[40:43], s72 offen offset:2048  lds
    s_cmp_eq_u32 s50, s83
    s_cselect_b32 s72, 0, s50
    v_rcp_f32 v174, v174
    v_rcp_f32 v175, v175
    v_mul_f32 v112, v112, v168
    v_mul_f32 v113, v113, v169
    v_mul_f32 v114, v114, v170
    v_mul_f32 v115, v115, v171
    v_mul_f32 v116, v116, v172
    v_mul_f32 v117, v117, v173
    v_mul_f32 v118, v118, v174
    v_mul_f32 v119, v119, v175
    v_add_f32 v188, v188, v112
    v_add_f32 v189, v189, v113
    s_waitcnt vmcnt(10)
    s_barrier
    v_add_f32 v188, v188, v114
    s_add_u32 m0, s76, 12288
    s_add_u32 s50, s72, s82
    buffer_load_dwordx4 v17, s[40:43], s72 offen offset:0  lds
    v_add_f32 v189, v189, v115
    v_add_f32 v188, v188, v116
    v_add_f32 v189, v189, v117
    v_add_f32 v188, v188, v118
    v_add_f32 v189, v189, v119
    buffer_load_dwordx4 v18, s[40:43], s72 offen offset:1024  lds
    v_fmac_f32 v190, v112, v112
    v_fmac_f32 v191, v113, v113
    v_fmac_f32 v190, v114, v114
    v_fmac_f32 v191, v115, v115
    v_fmac_f32 v190, v116, v116
    v_fmac_f32 v191, v117, v117
    buffer_load_dwordx4 v19, s[40:43], s72 offen offset:2048  lds
    s_cmp_eq_u32 s50, s83
    s_cselect_b32 s72, 0, s50
    v_fmac_f32 v190, v118, v118
    v_fmac_f32 v191, v119, v119
    v_lshlrev_b32 v120, 16, v204
    v_and_b32 v121, 0xffff0000, v204
    v_lshlrev_b32 v122, 16, v205
    v_and_b32 v123, 0xffff0000, v205
    v_lshlrev_b32 v124, 16, v206
    v_and_b32 v125, 0xffff0000, v206
    v_lshlrev_b32 v126, 16, v207
    v_and_b32 v127, 0xffff0000, v207
    v_mul_f32 v168, v120, v120
    v_mul_f32 v169, v121, v121
    v_mul_f32 v170, v122, v122
    v_mul_f32 v171, v123, v123
    v_mul_f32 v172, v124, v124
    v_mul_f32 v173, v125, v125
    s_waitcnt vmcnt(10)
    s_barrier
    s_add_u32 m0, s76, 24576
    s_add_u32 s50, s72, s82
    buffer_load_dwordx4 v17, s[40:43], s72 offen offset:0  lds
    v_mul_f32 v174, v126, v126
    v_mul_f32 v175, v127, v127
    v_fmamk_f32 v168, v168, 0xbdd2d3e8, v192
    v_fmamk_f32 v169, v169, 0xbdd2d3e8, v192
    v_fmamk_f32 v170, v170, 0xbdd2d3e8, v192
    v_fmamk_f32 v171, v171, 0xbdd2d3e8, v192
    buffer_load_dwordx4 v18, s[40:43], s72 offen offset:1024  lds
    v_fmamk_f32 v172, v172, 0xbdd2d3e8, v192
    v_fmamk_f32 v173, v173, 0xbdd2d3e8, v192
    v_fmamk_f32 v174, v174, 0xbdd2d3e8, v192
    v_fmamk_f32 v175, v175, 0xbdd2d3e8, v192
    v_mul_f32 v168, v168, v120
    buffer_load_dwordx4 v19, s[40:43], s72 offen offset:2048  lds
    s_cmp_eq_u32 s50, s83
    s_cselect_b32 s72, 0, s50
    v_mul_f32 v169, v169, v121
    v_mul_f32 v170, v170, v122
    v_mul_f32 v171, v171, v123
    v_mul_f32 v172, v172, v124
    v_mul_f32 v173, v173, v125
    v_mul_f32 v174, v174, v126
    v_mul_f32 v175, v175, v127
    v_exp_f32 v168, v168
    v_exp_f32 v169, v169
    v_exp_f32 v170, v170
    v_exp_f32 v171, v171
    v_exp_f32 v172, v172
    s_waitcnt vmcnt(9)
    s_barrier
    v_exp_f32 v173, v173
    s_add_u32 m0, s76, 36864
    s_add_u32 s50, s72, s82
    buffer_load_dwordx4 v17, s[40:43], s72 offen offset:0  lds
    v_exp_f32 v174, v174
    v_exp_f32 v175, v175
    v_add_f32 v168, 1.0, v168
    v_add_f32 v169, 1.0, v169
    v_add_f32 v170, 1.0, v170
    buffer_load_dwordx4 v18, s[40:43], s72 offen offset:1024  lds
    v_add_f32 v171, 1.0, v171
    v_add_f32 v172, 1.0, v172
    v_add_f32 v173, 1.0, v173
    v_add_f32 v174, 1.0, v174
    v_add_f32 v175, 1.0, v175
    v_rcp_f32 v168, v168
    buffer_load_dwordx4 v19, s[40:43], s72 offen offset:2048  lds
    s_cmp_eq_u32 s50, s83
    s_cselect_b32 s72, 0, s50
    v_rcp_f32 v169, v169
    v_rcp_f32 v170, v170
    v_rcp_f32 v171, v171
    v_rcp_f32 v172, v172
    v_rcp_f32 v173, v173
    v_rcp_f32 v174, v174
    v_rcp_f32 v175, v175
    v_mul_f32 v120, v120, v168
    v_mul_f32 v121, v121, v169
    v_mul_f32 v122, v122, v170
    v_mul_f32 v123, v123, v171
    v_mul_f32 v124, v124, v172
    s_waitcnt vmcnt(9)
    s_barrier
    s_add_u32 m0, s76, 61440
    s_add_u32 s50, s72, s82
    buffer_load_dwordx4 v17, s[40:43], s72 offen offset:0  lds
    v_mul_f32 v125, v125, v173
    v_mul_f32 v126, v126, v174
    v_mul_f32 v127, v127, v175
    v_add_f32 v188, v188, v120
    v_add_f32 v189, v189, v121
    v_add_f32 v188, v188, v122
    buffer_load_dwordx4 v18, s[40:43], s72 offen offset:1024  lds
    v_add_f32 v189, v189, v123
    v_add_f32 v188, v188, v124
    v_add_f32 v189, v189, v125
    v_add_f32 v188, v188, v126
    v_add_f32 v189, v189, v127
    buffer_load_dwordx4 v19, s[40:43], s72 offen offset:2048  lds
    s_cmp_eq_u32 s50, s83
    s_cselect_b32 s72, 0, s50
    v_fmac_f32 v190, v120, v120
    v_fmac_f32 v191, v121, v121
    v_fmac_f32 v190, v122, v122
    v_fmac_f32 v191, v123, v123
    v_fmac_f32 v190, v124, v124
    v_fmac_f32 v191, v125, v125
    v_fmac_f32 v190, v126, v126
    v_fmac_f32 v191, v127, v127
    v_add_f32 v188, v188, v189
    v_add_f32 v189, v190, v191
    v_mov_b64 v[168:169], v[188:189]
    s_nop 1
    v_permlane32_swap_b32 v188, v168
    v_permlane32_swap_b32 v189, v169
    v_add_f32 v188, v188, v168
    v_add_f32 v189, v189, v169
    ds_write_b64 v212, v[188:189]
    s_waitcnt vmcnt(9) lgkmcnt(0)
    s_barrier
    ds_read_b64 v[168:169], v212 offset:512
    s_waitcnt lgkmcnt(0)
    v_add_f32 v244, v188, v168
    v_add_f32 v246, v189, v169
    buffer_store_dwordx4 v[244:247], v213, s[36:39], s85 offen sc1
    s_add_u32 m0, s76, 49152
    s_add_u32 s50, s72, s82
    buffer_load_dwordx4 v17, s[40:43], s72 offen offset:0  lds
    buffer_load_dwordx4 v18, s[40:43], s72 offen offset:1024  lds
    buffer_load_dwordx4 v19, s[40:43], s72 offen offset:2048  lds
    s_cmp_eq_u32 s50, s83
    s_cselect_b32 s72, 0, s50
    s_waitcnt vmcnt(10)
    s_barrier
    s_add_u32 m0, s76, 0
    s_add_u32 s50, s72, s82
    buffer_load_dwordx4 v17, s[40:43], s72 offen offset:0  lds
    buffer_load_dwordx4 v18, s[40:43], s72 offen offset:1024  lds
    buffer_load_dwordx4 v19, s[40:43], s72 offen offset:2048  lds
    s_cmp_eq_u32 s50, s83
    s_cselect_b32 s72, 0, s50
    s_waitcnt vmcnt(10)
    s_barrier
    s_add_u32 m0, s76, 12288
    s_add_u32 s50, s72, s82
    buffer_load_dwordx4 v17, s[40:43], s72 offen offset:0  lds
    buffer_load_dwordx4 v18, s[40:43], s72 offen offset:1024  lds
    buffer_load_dwordx4 v19, s[40:43], s72 offen offset:2048  lds
    s_cmp_eq_u32 s50, s83
    s_cselect_b32 s72, 0, s50
    s_waitcnt vmcnt(10)
    s_barrier
    s_add_u32 m0, s76, 24576
    s_add_u32 s50, s72, s82
    buffer_load_dwordx4 v17, s[40:43], s72 offen offset:0  lds
    buffer_load_dwordx4 v18, s[40:43], s72 offen offset:1024  lds
    buffer_load_dwordx4 v19, s[40:43], s72 offen offset:2048  lds
    s_cmp_eq_u32 s50, s83
    s_cselect_b32 s72, 0, s50
    buffer_load_dword v254, v253, s[36:39], s78 offen sc1
    s_waitcnt vmcnt(10)
    s_barrier
    s_waitcnt vmcnt(7)
    s_barrier
    s_waitcnt vmcnt(4)
    s_barrier
    s_setprio 2
gated_mix__grouped_kv_mqa__mixer_gmlp__prompt_kernel_kpoll:
    s_waitcnt vmcnt(0)
    v_cmp_ne_u32 vcc, s59, v254
    s_cbranch_vccnz gated_mix__grouped_kv_mqa__mixer_gmlp__prompt_kernel_kretry
gated_mix__grouped_kv_mqa__mixer_gmlp__prompt_kernel_kok:
    s_add_u32 m0, s69, 24576
    s_nop 0
    buffer_load_dwordx4 v4, s[36:39], s68 offen offset:0 sc1 lds
    buffer_load_dwordx4 v4, s[36:39], s68 offen offset:1024 sc1 lds
    buffer_load_dwordx4 v4, s[36:39], s68 offen offset:2048 sc1 lds
    s_add_u32 s68, s68, 12288
    s_cmp_eq_u32 s68, 0x2b0000
    s_cselect_b32 s68, 0x280000, s68
    s_add_u32 m0, s69, 0
    s_nop 0
    buffer_load_dwordx4 v4, s[36:39], s68 offen offset:0 sc1 lds
    buffer_load_dwordx4 v4, s[36:39], s68 offen offset:1024 sc1 lds
    buffer_load_dwordx4 v4, s[36:39], s68 offen offset:2048 sc1 lds
    s_add_u32 s68, s68, 12288
    s_cmp_eq_u32 s68, 0x2b0000
    s_cselect_b32 s68, 0x280000, s68
    buffer_load_dwordx4 v[128:131], v11, s[36:39], s85 offen offset:0 sc1
    buffer_load_dwordx4 v[132:135], v11, s[36:39], s85 offen offset:1024 sc1
    buffer_load_dwordx4 v[160:163], v11, s[36:39], s85 offen offset:2048 sc1
    buffer_load_dwordx4 v[164:167], v11, s[36:39], s85 offen offset:3072 sc1
    s_barrier
    v_lshlrev_b32 v253, 7, v0
    buffer_load_dword v254, v253, s[36:39], s78 offen sc1
    s_add_u32 m0, s69, 12288
    s_nop 0
    buffer_load_dwordx4 v4, s[36:39], s68 offen offset:0 sc1 lds
    buffer_load_dwordx4 v4, s[36:39], s68 offen offset:1024 sc1 lds
    buffer_load_dwordx4 v4, s[36:39], s68 offen offset:2048 sc1 lds
    s_add_u32 s68, s68, 12288
    s_cmp_eq_u32 s68, 0x2b0000
    s_cselect_b32 s68, 0x280000, s68
gated_mix__grouped_kv_mqa__mixer_gmlp__prompt_kernel_schk:
    s_waitcnt vmcnt(4)
    v_max3_u32 v170, v129, v131, s59
    v_max3_u32 v170, v133, v135, v170
    v_max3_u32 v170, v161, v163, v170
    v_max3_u32 v170, v165, v167, v170
    v_min3_u32 v171, v129, v131, s59
    v_min3_u32 v171, v133, v135, v171
    v_min3_u32 v171, v161, v163, v171
    v_min3_u32 v171, v165, v167, v171
    v_cmp_ne_u32 vcc, v170, v171
    s_cbranch_vccnz gated_mix__grouped_kv_mqa__mixer_gmlp__prompt_kernel_sretry
gated_mix__grouped_kv_mqa__mixer_gmlp__prompt_kernel_sok:
    v_add_f32 v170, v128, v132
    v_add_f32 v171, v160, v164
    v_add_f32 v188, v170, v171
    v_add_f32 v170, v130, v134
    v_add_f32 v171, v162, v166
    v_add_f32 v189, v170, v171
    v_mov_b64 v[170:171], v[188:189]
    s_nop 1
    v_permlane32_swap_b32 v188, v170
    v_permlane32_swap_b32 v189, v171
    v_add_f32 v188, v188, v170
    v_add_f32 v189, v189, v171
    v_mul_f32 v188, 0x3aaaaaab, v188
    v_mul_f32 v189, 0x3aaaaaab, v189
    v_fma_f32 v189, -v188, v188, v189
    v_max_f32 v189, 0, v189
    v_add_f32 v189, 0x3727c5ac, v189
    v_rsq_f32 v189, v189
    s_nop 0
    v_mul_f32 v188, v188, v189
    v_fma_f32 v104, v104, v189, -v188
    v_fma_f32 v105, v105, v189, -v188
    v_fma_f32 v106, v106, v189, -v188
    v_fma_f32 v107, v107, v189, -v188
    v_cvt_pk_bf16_f32 v104, v104, v105
    v_cvt_pk_bf16_f32 v105, v106, v107
    ds_write_b64 v208, v[104:105] offset:0
    v_fma_f32 v108, v108, v189, -v188
    v_fma_f32 v109, v109, v189, -v188
    v_fma_f32 v110, v110, v189, -v188
    v_fma_f32 v111, v111, v189, -v188
    v_cvt_pk_bf16_f32 v108, v108, v109
    v_cvt_pk_bf16_f32 v109, v110, v111
    ds_write_b64 v208, v[108:109] offset:16
    ds_read_b64_tr_b16 v[104:105], v209
    ds_read_b64_tr_b16 v[106:107], v209 offset:128
    v_fma_f32 v112, v112, v189, -v188
    v_fma_f32 v113, v113, v189, -v188
    v_fma_f32 v114, v114, v189, -v188
    v_fma_f32 v115, v115, v189, -v188
    v_cvt_pk_bf16_f32 v112, v112, v113
    v_cvt_pk_bf16_f32 v113, v114, v115
    ds_write_b64 v208, v[112:113] offset:0
    s_waitcnt lgkmcnt(1)
    buffer_store_dwordx4 v[104:107], v210, s[36:39], s84 offen offset:0 sc1
    v_fma_f32 v116, v116, v189, -v188
    v_fma_f32 v117, v117, v189, -v188
    v_fma_f32 v118, v118, v189, -v188
    v_fma_f32 v119, v119, v189, -v188
    v_cvt_pk_bf16_f32 v116, v116, v117
    v_cvt_pk_bf16_f32 v117, v118, v119
    ds_write_b64 v208, v[116:117] offset:16
    ds_read_b64_tr_b16 v[112:113], v209
    ds_read_b64_tr_b16 v[114:115], v209 offset:128
    v_fma_f32 v120, v120, v189, -v188
    v_fma_f32 v121, v121, v189, -v188
    v_fma_f32 v122, v122, v189, -v188
    v_fma_f32 v123, v123, v189, -v188
    v_cvt_pk_bf16_f32 v120, v120, v121
    v_cvt_pk_bf16_f32 v121, v122, v123
    ds_write_b64 v208, v[120:121] offset:0
    s_waitcnt lgkmcnt(1)
    buffer_store_dwordx4 v[112:115], v210, s[36:39], s84 offen offset:1024 sc1
    v_fma_f32 v124, v124, v189, -v188
    v_fma_f32 v125, v125, v189, -v188
    v_fma_f32 v126, v126, v189, -v188
    v_fma_f32 v127, v127, v189, -v188
    v_cvt_pk_bf16_f32 v124, v124, v125
    v_cvt_pk_bf16_f32 v125, v126, v127
    ds_write_b64 v208, v[124:125] offset:16
    ds_read_b64_tr_b16 v[120:121], v209
    ds_read_b64_tr_b16 v[122:123], v209 offset:128
    s_waitcnt lgkmcnt(0)
    buffer_store_dwordx4 v[120:123], v210, s[36:39], s84 offen offset:2048 sc1
    s_setprio 0
    s_barrier
    ds_read_b128 v[76:79], v30 offset:0
    ds_read_b128 v[80:83], v30 offset:1024
    ds_read_b128 v[84:87], v30 offset:2048
    ds_read_b128 v[88:91], v1 offset:26624
    ds_read_b128 v[92:95], v2 offset:29184
    ds_read_b128 v[96:99], v3 offset:32768
    v_mov_b32 v251, 0xdddddddd
    v_mov_b32 v44, 0
    v_mov_b32 v45, 0
    v_mov_b32 v46, 0
    v_mov_b32 v47, 0
    v_mov_b32 v48, 0
    v_mov_b32 v49, 0
    v_mov_b32 v50, 0
    v_mov_b32 v51, 0
    v_mov_b32 v52, 0
    v_mov_b32 v53, 0
    v_mov_b32 v54, 0
    v_mov_b32 v55, 0
    v_mov_b32 v56, 0
    v_mov_b32 v57, 0
    v_mov_b32 v58, 0
    v_mov_b32 v59, 0
    s_waitcnt lgkmcnt(1)
    v_mfma_f32_32x32x16_bf16 v[12:27], v[88:91], v[76:79], 0
    v_mfma_f32_32x32x8bf16_1k v[12:27], v[92:93], v[84:85], v[12:27]
    v_mov_b32 v60, 0
    v_mov_b32 v61, 0
    v_mov_b32 v62, 0
    v_mov_b32 v63, 0
    v_mov_b32 v64, 0
    v_mov_b32 v65, 0
    v_mov_b32 v66, 0
    v_mov_b32 v67, 0
    v_mov_b32 v68, 0
    v_mov_b32 v69, 0
    v_mov_b32 v70, 0
    v_mov_b32 v71, 0
    v_mov_b32 v72, 0
    v_mov_b32 v73, 0
    v_mov_b32 v74, 0
    v_mov_b32 v75, 0
    v_exp_f32 v12, v12
    v_exp_f32 v13, v13
    ds_read_b128 v[100:103], v3 offset:33536
    v_mfma_f32_32x32x16_bf16 v[28:43], v[88:91], v[80:83], 0
    ds_read_b128 v[88:91], v1 offset:27648
    v_exp_f32 v14, v14
    v_exp_f32 v15, v15
    v_exp_f32 v16, v16
    v_mfma_f32_32x32x8bf16_1k v[28:43], v[92:93], v[86:87], v[28:43]
    v_exp_f32 v17, v17
    v_exp_f32 v18, v18
    v_exp_f32 v19, v19
    v_exp_f32 v20, v20
    v_exp_f32 v21, v21
    v_exp_f32 v22, v22
    v_exp_f32 v23, v23
    v_exp_f32 v24, v24
    s_waitcnt lgkmcnt(2)
    v_smfmac_f32_32x32x32_bf16 v[44:59], v[96:99], v[12:19], v251
    v_exp_f32 v25, v25
    v_exp_f32 v26, v26
    v_exp_f32 v27, v27
    v_exp_f32 v28, v28
    v_exp_f32 v29, v29
    s_waitcnt lgkmcnt(1)
    v_smfmac_f32_32x32x32_bf16 v[44:59], v[100:103], v[20:27], v251
    s_waitcnt lgkmcnt(0)
    v_mfma_f32_32x32x16_bf16 v[12:27], v[88:91], v[76:79], 0
    v_exp_f32 v30, v30
    v_exp_f32 v31, v31
    v_exp_f32 v32, v32
    v_mfma_f32_32x32x8bf16_1k v[12:27], v[94:95], v[84:85], v[12:27]
    v_exp_f32 v33, v33
    v_exp_f32 v34, v34
    v_exp_f32 v35, v35
    v_exp_f32 v36, v36
    v_exp_f32 v37, v37
    v_exp_f32 v38, v38
    v_exp_f32 v39, v39
    v_exp_f32 v40, v40
    v_smfmac_f32_32x32x32_bf16 v[60:75], v[96:99], v[28:35], v251
    ds_read_b128 v[96:99], v3 offset:34304
    v_exp_f32 v41, v41
    v_exp_f32 v42, v42
    v_exp_f32 v43, v43
    v_exp_f32 v12, v12
    v_exp_f32 v13, v13
    v_smfmac_f32_32x32x32_bf16 v[60:75], v[100:103], v[36:43], v251
    ds_read_b128 v[100:103], v3 offset:35072
    v_mfma_f32_32x32x16_bf16 v[28:43], v[88:91], v[80:83], 0
    v_exp_f32 v14, v14
    v_exp_f32 v15, v15
    v_exp_f32 v16, v16
    v_mfma_f32_32x32x8bf16_1k v[28:43], v[94:95], v[86:87], v[28:43]
    v_exp_f32 v17, v17
gated_mix__grouped_kv_mqa__mixer_gmlp__prompt_kernel_lpoll:
    s_waitcnt vmcnt(6)
    v_cmp_ne_u32 vcc, s59, v254
    s_cbranch_vccnz gated_mix__grouped_kv_mqa__mixer_gmlp__prompt_kernel_lretry
gated_mix__grouped_kv_mqa__mixer_gmlp__prompt_kernel_lok:
    s_waitcnt lgkmcnt(0)
    s_barrier
    s_mov_b64 exec, 1
    s_waitcnt vmcnt(0)
    buffer_store_dword v245, off, s[36:39], s86 sc1
    s_mov_b64 exec, -1
    ds_read_b128 v[88:91], v1 offset:2048
    ds_read_b128 v[92:95], v2 offset:4608
    v_exp_f32 v18, v18
    v_exp_f32 v19, v19
    s_add_u32 m0, s69, 24576
    s_nop 0
    buffer_load_dwordx4 v4, s[36:39], s68 offen offset:0 sc1 lds
    v_exp_f32 v20, v20
    v_exp_f32 v21, v21
    v_exp_f32 v22, v22
    buffer_load_dwordx4 v4, s[36:39], s68 offen offset:1024 sc1 lds
    v_exp_f32 v23, v23
    v_exp_f32 v24, v24
    v_smfmac_f32_32x32x32_bf16 v[44:59], v[96:99], v[12:19], v251
    v_exp_f32 v25, v25
    buffer_load_dwordx4 v4, s[36:39], s68 offen offset:2048 sc1 lds
    s_add_u32 s68, s68, 12288
    s_cmp_eq_u32 s68, 0x2b0000
    s_cselect_b32 s68, 0x280000, s68
    v_exp_f32 v26, v26
    v_exp_f32 v27, v27
    v_exp_f32 v28, v28
    v_exp_f32 v29, v29
    v_smfmac_f32_32x32x32_bf16 v[44:59], v[100:103], v[20:27], v251
    s_waitcnt lgkmcnt(1)
    v_mfma_f32_32x32x16_bf16 v[12:27], v[88:91], v[76:79], 0
    v_exp_f32 v30, v30
    v_exp_f32 v31, v31
    v_exp_f32 v32, v32
    s_waitcnt lgkmcnt(0)
    v_mfma_f32_32x32x8bf16_1k v[12:27], v[92:93], v[84:85], v[12:27]
    v_exp_f32 v33, v33
    v_exp_f32 v34, v34
    v_exp_f32 v35, v35
    v_exp_f32 v36, v36
    v_exp_f32 v37, v37
    v_exp_f32 v38, v38
    v_exp_f32 v39, v39
    v_exp_f32 v40, v40
    v_smfmac_f32_32x32x32_bf16 v[60:75], v[96:99], v[28:35], v251
    ds_read_b128 v[96:99], v3 offset:8192
    v_exp_f32 v41, v41
    v_exp_f32 v42, v42
    v_exp_f32 v43, v43
    v_exp_f32 v12, v12
    v_exp_f32 v13, v13
    v_smfmac_f32_32x32x32_bf16 v[60:75], v[100:103], v[36:43], v251
    ds_read_b128 v[100:103], v3 offset:8960
    v_mfma_f32_32x32x16_bf16 v[28:43], v[88:91], v[80:83], 0
    ds_read_b128 v[88:91], v1 offset:3072
    v_exp_f32 v14, v14
    v_exp_f32 v15, v15
    v_exp_f32 v16, v16
    v_mfma_f32_32x32x8bf16_1k v[28:43], v[92:93], v[86:87], v[28:43]
    v_exp_f32 v17, v17
    v_exp_f32 v18, v18
    v_exp_f32 v19, v19
    v_exp_f32 v20, v20
    v_exp_f32 v21, v21
    v_exp_f32 v22, v22
    v_exp_f32 v23, v23
    v_exp_f32 v24, v24
    s_waitcnt lgkmcnt(2)
    v_smfmac_f32_32x32x32_bf16 v[44:59], v[96:99], v[12:19], v251
    v_exp_f32 v25, v25
    v_exp_f32 v26, v26
    v_exp_f32 v27, v27
    v_exp_f32 v28, v28
    v_exp_f32 v29, v29
    s_waitcnt lgkmcnt(1)
    v_smfmac_f32_32x32x32_bf16 v[44:59], v[100:103], v[20:27], v251
    s_waitcnt lgkmcnt(0)
    v_mfma_f32_32x32x16_bf16 v[12:27], v[88:91], v[76:79], 0
    v_exp_f32 v30, v30
    v_exp_f32 v31, v31
    v_exp_f32 v32, v32
    v_mfma_f32_32x32x8bf16_1k v[12:27], v[94:95], v[84:85], v[12:27]
    v_exp_f32 v33, v33
    v_exp_f32 v34, v34
    v_exp_f32 v35, v35
    v_exp_f32 v36, v36
    v_exp_f32 v37, v37
    v_exp_f32 v38, v38
    v_exp_f32 v39, v39
    v_exp_f32 v40, v40
    v_smfmac_f32_32x32x32_bf16 v[60:75], v[96:99], v[28:35], v251
    ds_read_b128 v[96:99], v3 offset:9728
    v_exp_f32 v41, v41
    v_exp_f32 v42, v42
    v_exp_f32 v43, v43
    v_exp_f32 v12, v12
    v_exp_f32 v13, v13
    v_smfmac_f32_32x32x32_bf16 v[60:75], v[100:103], v[36:43], v251
    ds_read_b128 v[100:103], v3 offset:10496
    v_mfma_f32_32x32x16_bf16 v[28:43], v[88:91], v[80:83], 0
    v_exp_f32 v14, v14
    v_exp_f32 v15, v15
    v_exp_f32 v16, v16
    v_mfma_f32_32x32x8bf16_1k v[28:43], v[94:95], v[86:87], v[28:43]
    v_exp_f32 v17, v17
    s_waitcnt lgkmcnt(0)
    s_barrier
    ds_read_b128 v[88:91], v1 offset:14336
    ds_read_b128 v[92:95], v2 offset:16896
    v_exp_f32 v18, v18
    v_exp_f32 v19, v19
    s_add_u32 m0, s69, 0
    s_nop 0
    buffer_load_dwordx4 v4, s[36:39], s68 offen offset:0 sc1 lds
    v_exp_f32 v20, v20
    v_exp_f32 v21, v21
    v_exp_f32 v22, v22
    buffer_load_dwordx4 v4, s[36:39], s68 offen offset:1024 sc1 lds
    v_exp_f32 v23, v23
    v_exp_f32 v24, v24
    v_smfmac_f32_32x32x32_bf16 v[44:59], v[96:99], v[12:19], v251
    v_exp_f32 v25, v25
    buffer_load_dwordx4 v4, s[36:39], s68 offen offset:2048 sc1 lds
    s_add_u32 s68, s68, 12288
    s_cmp_eq_u32 s68, 0x2b0000
    s_cselect_b32 s68, 0x280000, s68
    v_exp_f32 v26, v26
    v_exp_f32 v27, v27
    v_exp_f32 v28, v28
    v_exp_f32 v29, v29
    v_smfmac_f32_32x32x32_bf16 v[44:59], v[100:103], v[20:27], v251
    s_waitcnt lgkmcnt(1)
    v_mfma_f32_32x32x16_bf16 v[12:27], v[88:91], v[76:79], 0
    v_exp_f32 v30, v30
    v_exp_f32 v31, v31
    v_exp_f32 v32, v32
    s_waitcnt lgkmcnt(0)
    v_mfma_f32_32x32x8bf16_1k v[12:27], v[92:93], v[84:85], v[12:27]
    v_exp_f32 v33, v33
    v_exp_f32 v34, v34
    v_exp_f32 v35, v35
    v_exp_f32 v36, v36
    v_exp_f32 v37, v37
    v_exp_f32 v38, v38
    v_exp_f32 v39, v39
    v_exp_f32 v40, v40
    v_smfmac_f32_32x32x32_bf16 v[60:75], v[96:99], v[28:35], v251
    ds_read_b128 v[96:99], v3 offset:20480
    v_exp_f32 v41, v41
    v_exp_f32 v42, v42
    v_exp_f32 v43, v43
    v_exp_f32 v12, v12
    v_exp_f32 v13, v13
    v_smfmac_f32_32x32x32_bf16 v[60:75], v[100:103], v[36:43], v251
    ds_read_b128 v[100:103], v3 offset:21248
    v_mfma_f32_32x32x16_bf16 v[28:43], v[88:91], v[80:83], 0
    ds_read_b128 v[88:91], v1 offset:15360
    v_exp_f32 v14, v14
    v_exp_f32 v15, v15
    v_exp_f32 v16, v16
    v_mfma_f32_32x32x8bf16_1k v[28:43], v[92:93], v[86:87], v[28:43]
    v_exp_f32 v17, v17
    v_exp_f32 v18, v18
    v_exp_f32 v19, v19
    v_exp_f32 v20, v20
    v_exp_f32 v21, v21
    v_exp_f32 v22, v22
    v_exp_f32 v23, v23
    v_exp_f32 v24, v24
    s_waitcnt lgkmcnt(2)
    v_smfmac_f32_32x32x32_bf16 v[44:59], v[96:99], v[12:19], v251
    v_exp_f32 v25, v25
    v_exp_f32 v26, v26
    v_exp_f32 v27, v27
    v_exp_f32 v28, v28
    v_exp_f32 v29, v29
    s_waitcnt lgkmcnt(1)
    v_smfmac_f32_32x32x32_bf16 v[44:59], v[100:103], v[20:27], v251
    s_waitcnt lgkmcnt(0)
    v_mfma_f32_32x32x16_bf16 v[12:27], v[88:91], v[76:79], 0
    v_exp_f32 v30, v30
    v_exp_f32 v31, v31
    v_exp_f32 v32, v32
    v_mfma_f32_32x32x8bf16_1k v[12:27], v[94:95], v[84:85], v[12:27]
    v_exp_f32 v33, v33
    v_exp_f32 v34, v34
    v_exp_f32 v35, v35
    v_exp_f32 v36, v36
    v_exp_f32 v37, v37
    v_exp_f32 v38, v38
    v_exp_f32 v39, v39
    v_exp_f32 v40, v40
    v_smfmac_f32_32x32x32_bf16 v[60:75], v[96:99], v[28:35], v251
    ds_read_b128 v[96:99], v3 offset:22016
    v_exp_f32 v41, v41
    v_exp_f32 v42, v42
    v_exp_f32 v43, v43
    v_exp_f32 v12, v12
    v_exp_f32 v13, v13
    v_smfmac_f32_32x32x32_bf16 v[60:75], v[100:103], v[36:43], v251
    ds_read_b128 v[100:103], v3 offset:22784
    v_mfma_f32_32x32x16_bf16 v[28:43], v[88:91], v[80:83], 0
    v_exp_f32 v14, v14
    v_exp_f32 v15, v15
    v_exp_f32 v16, v16
    v_mfma_f32_32x32x8bf16_1k v[28:43], v[94:95], v[86:87], v[28:43]
    v_exp_f32 v17, v17
    s_waitcnt vmcnt(3) lgkmcnt(0)
    s_barrier
    ds_read_b128 v[88:91], v1 offset:26624
    ds_read_b128 v[92:95], v2 offset:29184
    v_exp_f32 v18, v18
    v_exp_f32 v19, v19
    s_add_u32 m0, s69, 12288
    s_nop 0
    buffer_load_dwordx4 v4, s[36:39], s68 offen offset:0 sc1 lds
    v_exp_f32 v20, v20
    v_exp_f32 v21, v21
    v_exp_f32 v22, v22
    buffer_load_dwordx4 v4, s[36:39], s68 offen offset:1024 sc1 lds
    v_exp_f32 v23, v23
    v_exp_f32 v24, v24
    v_smfmac_f32_32x32x32_bf16 v[44:59], v[96:99], v[12:19], v251
    v_exp_f32 v25, v25
    buffer_load_dwordx4 v4, s[36:39], s68 offen offset:2048 sc1 lds
    s_add_u32 s68, s68, 12288
    s_cmp_eq_u32 s68, 0x2b0000
    s_cselect_b32 s68, 0x280000, s68
    v_exp_f32 v26, v26
    v_exp_f32 v27, v27
    v_exp_f32 v28, v28
    v_exp_f32 v29, v29
    v_smfmac_f32_32x32x32_bf16 v[44:59], v[100:103], v[20:27], v251
    s_waitcnt lgkmcnt(1)
    v_mfma_f32_32x32x16_bf16 v[12:27], v[88:91], v[76:79], 0
    v_exp_f32 v30, v30
    v_exp_f32 v31, v31
    v_exp_f32 v32, v32
    s_waitcnt lgkmcnt(0)
    v_mfma_f32_32x32x8bf16_1k v[12:27], v[92:93], v[84:85], v[12:27]
    v_exp_f32 v33, v33
    v_exp_f32 v34, v34
    v_exp_f32 v35, v35
    v_exp_f32 v36, v36
    v_exp_f32 v37, v37
    v_exp_f32 v38, v38
    v_exp_f32 v39, v39
    v_exp_f32 v40, v40
    v_smfmac_f32_32x32x32_bf16 v[60:75], v[96:99], v[28:35], v251
    ds_read_b128 v[96:99], v3 offset:32768
    v_exp_f32 v41, v41
    v_exp_f32 v42, v42
    v_exp_f32 v43, v43
    v_exp_f32 v12, v12
    v_exp_f32 v13, v13
    v_smfmac_f32_32x32x32_bf16 v[60:75], v[100:103], v[36:43], v251
    ds_read_b128 v[100:103], v3 offset:33536
    v_mfma_f32_32x32x16_bf16 v[28:43], v[88:91], v[80:83], 0
    ds_read_b128 v[88:91], v1 offset:27648
    v_exp_f32 v14, v14
    v_exp_f32 v15, v15
    v_exp_f32 v16, v16
    v_mfma_f32_32x32x8bf16_1k v[28:43], v[92:93], v[86:87], v[28:43]
    v_exp_f32 v17, v17
    v_exp_f32 v18, v18
    v_exp_f32 v19, v19
    v_exp_f32 v20, v20
    v_exp_f32 v21, v21
    v_exp_f32 v22, v22
    v_exp_f32 v23, v23
    v_exp_f32 v24, v24
    s_waitcnt lgkmcnt(2)
    v_smfmac_f32_32x32x32_bf16 v[44:59], v[96:99], v[12:19], v251
    v_exp_f32 v25, v25
    v_exp_f32 v26, v26
    v_exp_f32 v27, v27
    v_exp_f32 v28, v28
    v_exp_f32 v29, v29
    s_waitcnt lgkmcnt(1)
    v_smfmac_f32_32x32x32_bf16 v[44:59], v[100:103], v[20:27], v251
    s_waitcnt lgkmcnt(0)
    v_mfma_f32_32x32x16_bf16 v[12:27], v[88:91], v[76:79], 0
    v_exp_f32 v30, v30
    v_exp_f32 v31, v31
    v_exp_f32 v32, v32
    v_mfma_f32_32x32x8bf16_1k v[12:27], v[94:95], v[84:85], v[12:27]
    v_exp_f32 v33, v33
    v_exp_f32 v34, v34
    v_exp_f32 v35, v35
    v_exp_f32 v36, v36
    v_exp_f32 v37, v37
    v_exp_f32 v38, v38
    v_exp_f32 v39, v39
    v_exp_f32 v40, v40
    v_smfmac_f32_32x32x32_bf16 v[60:75], v[96:99], v[28:35], v251
    ds_read_b128 v[96:99], v3 offset:34304
    v_exp_f32 v41, v41
    v_exp_f32 v42, v42
    v_exp_f32 v43, v43
    v_exp_f32 v12, v12
    v_exp_f32 v13, v13
    v_smfmac_f32_32x32x32_bf16 v[60:75], v[100:103], v[36:43], v251
    ds_read_b128 v[100:103], v3 offset:35072
    v_mfma_f32_32x32x16_bf16 v[28:43], v[88:91], v[80:83], 0
    v_exp_f32 v14, v14
    v_exp_f32 v15, v15
    v_exp_f32 v16, v16
    v_mfma_f32_32x32x8bf16_1k v[28:43], v[94:95], v[86:87], v[28:43]
    v_exp_f32 v17, v17
    s_waitcnt vmcnt(3) lgkmcnt(0)
    s_barrier
    ds_read_b128 v[88:91], v1 offset:2048
    ds_read_b128 v[92:95], v2 offset:4608
    v_exp_f32 v18, v18
    v_exp_f32 v19, v19
    s_add_u32 m0, s69, 24576
    s_nop 0
    buffer_load_dwordx4 v4, s[36:39], s68 offen offset:0 sc1 lds
    v_exp_f32 v20, v20
    v_exp_f32 v21, v21
    v_exp_f32 v22, v22
    buffer_load_dwordx4 v4, s[36:39], s68 offen offset:1024 sc1 lds
    v_exp_f32 v23, v23
    v_exp_f32 v24, v24
    v_smfmac_f32_32x32x32_bf16 v[44:59], v[96:99], v[12:19], v251
    v_exp_f32 v25, v25
    buffer_load_dwordx4 v4, s[36:39], s68 offen offset:2048 sc1 lds
    s_add_u32 s68, s68, 12288
    s_cmp_eq_u32 s68, 0x2b0000
    s_cselect_b32 s68, 0x280000, s68
    v_exp_f32 v26, v26
    v_exp_f32 v27, v27
    v_exp_f32 v28, v28
    v_exp_f32 v29, v29
    v_smfmac_f32_32x32x32_bf16 v[44:59], v[100:103], v[20:27], v251
    s_waitcnt lgkmcnt(1)
    v_mfma_f32_32x32x16_bf16 v[12:27], v[88:91], v[76:79], 0
    v_exp_f32 v30, v30
    v_exp_f32 v31, v31
    v_exp_f32 v32, v32
    s_waitcnt lgkmcnt(0)
    v_mfma_f32_32x32x8bf16_1k v[12:27], v[92:93], v[84:85], v[12:27]
    v_exp_f32 v33, v33
    v_exp_f32 v34, v34
    v_exp_f32 v35, v35
    v_exp_f32 v36, v36
    v_exp_f32 v37, v37
    v_exp_f32 v38, v38
    v_exp_f32 v39, v39
    v_exp_f32 v40, v40
    v_smfmac_f32_32x32x32_bf16 v[60:75], v[96:99], v[28:35], v251
    ds_read_b128 v[96:99], v3 offset:8192
    v_exp_f32 v41, v41
    v_exp_f32 v42, v42
    v_exp_f32 v43, v43
    v_exp_f32 v12, v12
    v_exp_f32 v13, v13
    v_smfmac_f32_32x32x32_bf16 v[60:75], v[100:103], v[36:43], v251
    ds_read_b128 v[100:103], v3 offset:8960
    v_mfma_f32_32x32x16_bf16 v[28:43], v[88:91], v[80:83], 0
    ds_read_b128 v[88:91], v1 offset:3072
    v_exp_f32 v14, v14
    v_exp_f32 v15, v15
    v_exp_f32 v16, v16
    v_mfma_f32_32x32x8bf16_1k v[28:43], v[92:93], v[86:87], v[28:43]
    v_exp_f32 v17, v17
    v_exp_f32 v18, v18
    v_exp_f32 v19, v19
    v_exp_f32 v20, v20
    v_exp_f32 v21, v21
    v_exp_f32 v22, v22
    v_exp_f32 v23, v23
    v_exp_f32 v24, v24
    s_waitcnt lgkmcnt(2)
    v_smfmac_f32_32x32x32_bf16 v[44:59], v[96:99], v[12:19], v251
    v_exp_f32 v25, v25
    v_exp_f32 v26, v26
    v_exp_f32 v27, v27
    v_exp_f32 v28, v28
    v_exp_f32 v29, v29
    s_waitcnt lgkmcnt(1)
    v_smfmac_f32_32x32x32_bf16 v[44:59], v[100:103], v[20:27], v251
    s_waitcnt lgkmcnt(0)
    v_mfma_f32_32x32x16_bf16 v[12:27], v[88:91], v[76:79], 0
    v_exp_f32 v30, v30
    v_exp_f32 v31, v31
    v_exp_f32 v32, v32
    v_mfma_f32_32x32x8bf16_1k v[12:27], v[94:95], v[84:85], v[12:27]
    v_exp_f32 v33, v33
    v_exp_f32 v34, v34
    v_exp_f32 v35, v35
    v_exp_f32 v36, v36
    v_exp_f32 v37, v37
    v_exp_f32 v38, v38
    v_exp_f32 v39, v39
    v_exp_f32 v40, v40
    v_smfmac_f32_32x32x32_bf16 v[60:75], v[96:99], v[28:35], v251
    ds_read_b128 v[96:99], v3 offset:9728
    v_exp_f32 v41, v41
    v_exp_f32 v42, v42
    v_exp_f32 v43, v43
    v_exp_f32 v12, v12
    v_exp_f32 v13, v13
    v_smfmac_f32_32x32x32_bf16 v[60:75], v[100:103], v[36:43], v251
    ds_read_b128 v[100:103], v3 offset:10496
    v_mfma_f32_32x32x16_bf16 v[28:43], v[88:91], v[80:83], 0
    v_exp_f32 v14, v14
    v_exp_f32 v15, v15
    v_exp_f32 v16, v16
    v_mfma_f32_32x32x8bf16_1k v[28:43], v[94:95], v[86:87], v[28:43]
    v_exp_f32 v17, v17
    s_waitcnt vmcnt(3) lgkmcnt(0)
    s_barrier
    ds_read_b128 v[88:91], v1 offset:14336
    ds_read_b128 v[92:95], v2 offset:16896
    v_exp_f32 v18, v18
    v_exp_f32 v19, v19
    s_add_u32 m0, s69, 0
    s_nop 0
    buffer_load_dwordx4 v4, s[36:39], s68 offen offset:0 sc1 lds
    v_exp_f32 v20, v20
    v_exp_f32 v21, v21
    v_exp_f32 v22, v22
    buffer_load_dwordx4 v4, s[36:39], s68 offen offset:1024 sc1 lds
    v_exp_f32 v23, v23
    v_exp_f32 v24, v24
    v_smfmac_f32_32x32x32_bf16 v[44:59], v[96:99], v[12:19], v251
    v_exp_f32 v25, v25
    buffer_load_dwordx4 v4, s[36:39], s68 offen offset:2048 sc1 lds
    s_add_u32 s68, s68, 12288
    s_cmp_eq_u32 s68, 0x2b0000
    s_cselect_b32 s68, 0x280000, s68
    v_exp_f32 v26, v26
    v_exp_f32 v27, v27
    v_exp_f32 v28, v28
    v_exp_f32 v29, v29
    v_smfmac_f32_32x32x32_bf16 v[44:59], v[100:103], v[20:27], v251
    s_waitcnt lgkmcnt(1)
    v_mfma_f32_32x32x16_bf16 v[12:27], v[88:91], v[76:79], 0
    v_exp_f32 v30, v30
    v_exp_f32 v31, v31
    v_exp_f32 v32, v32
    s_waitcnt lgkmcnt(0)
    v_mfma_f32_32x32x8bf16_1k v[12:27], v[92:93], v[84:85], v[12:27]
    v_exp_f32 v33, v33
    v_exp_f32 v34, v34
    s_mov_b32 s60, s22
    s_mov_b32 s61, s23
    s_add_u32 m0, s77, 0
    s_mov_b32 s62, 983040
    buffer_load_dwordx4 v217, s[60:63], 0 offen lds
    v_exp_f32 v35, v35
    v_exp_f32 v36, v36
    v_exp_f32 v37, v37
    v_exp_f32 v38, v38
    v_exp_f32 v39, v39
    v_exp_f32 v40, v40
    v_smfmac_f32_32x32x32_bf16 v[60:75], v[96:99], v[28:35], v251
    ds_read_b128 v[96:99], v3 offset:20480
    v_exp_f32 v41, v41
    v_exp_f32 v42, v42
    v_exp_f32 v43, v43
    v_exp_f32 v12, v12
    v_exp_f32 v13, v13
    s_mov_b32 s60, s12
    s_mov_b32 s61, s13
    s_add_u32 m0, s77, 1024
    s_mov_b32 s62, 819200
    buffer_load_dwordx4 v218, s[60:63], 0 offen lds
    v_smfmac_f32_32x32x32_bf16 v[60:75], v[100:103], v[36:43], v251
    ds_read_b128 v[100:103], v3 offset:21248
    v_mfma_f32_32x32x16_bf16 v[28:43], v[88:91], v[80:83], 0
    ds_read_b128 v[88:91], v1 offset:15360
    v_exp_f32 v14, v14
    v_exp_f32 v15, v15
    v_exp_f32 v16, v16
    v_mfma_f32_32x32x8bf16_1k v[28:43], v[92:93], v[86:87], v[28:43]
    v_exp_f32 v17, v17
    v_exp_f32 v18, v18
    v_exp_f32 v19, v19
    v_exp_f32 v20, v20
    v_exp_f32 v21, v21
    v_exp_f32 v22, v22
    v_exp_f32 v23, v23
    v_exp_f32 v24, v24
    s_waitcnt lgkmcnt(2)
    v_smfmac_f32_32x32x32_bf16 v[44:59], v[96:99], v[12:19], v251
    v_exp_f32 v25, v25
    v_exp_f32 v26, v26
    v_exp_f32 v27, v27
    v_exp_f32 v28, v28
    v_exp_f32 v29, v29
    s_waitcnt lgkmcnt(1)
    v_smfmac_f32_32x32x32_bf16 v[44:59], v[100:103], v[20:27], v251
    s_waitcnt lgkmcnt(0)
    v_mfma_f32_32x32x16_bf16 v[12:27], v[88:91], v[76:79], 0
    v_exp_f32 v30, v30
    v_exp_f32 v31, v31
    v_exp_f32 v32, v32
    v_mfma_f32_32x32x8bf16_1k v[12:27], v[94:95], v[84:85], v[12:27]
    v_exp_f32 v33, v33
    v_exp_f32 v34, v34
    v_exp_f32 v35, v35
    v_exp_f32 v36, v36
    v_exp_f32 v37, v37
    v_exp_f32 v38, v38
    v_exp_f32 v39, v39
    v_exp_f32 v40, v40
    v_smfmac_f32_32x32x32_bf16 v[60:75], v[96:99], v[28:35], v251
    ds_read_b128 v[96:99], v3 offset:22016
    v_exp_f32 v41, v41
    v_exp_f32 v42, v42
    v_exp_f32 v43, v43
    v_exp_f32 v12, v12
    v_exp_f32 v13, v13
    v_smfmac_f32_32x32x32_bf16 v[60:75], v[100:103], v[36:43], v251
    ds_read_b128 v[100:103], v3 offset:22784
    v_mfma_f32_32x32x16_bf16 v[28:43], v[88:91], v[80:83], 0
    v_exp_f32 v14, v14
    v_exp_f32 v15, v15
    v_exp_f32 v16, v16
    v_mfma_f32_32x32x8bf16_1k v[28:43], v[94:95], v[86:87], v[28:43]
    v_exp_f32 v17, v17
    s_waitcnt vmcnt(5) lgkmcnt(0)
    s_barrier
    ds_read_b128 v[88:91], v1 offset:26624
    ds_read_b128 v[92:95], v2 offset:29184
    v_exp_f32 v18, v18
    v_exp_f32 v19, v19
    s_add_u32 m0, s69, 12288
    s_nop 0
    buffer_load_dwordx4 v4, s[36:39], s68 offen offset:0 sc1 lds
    v_exp_f32 v20, v20
    v_exp_f32 v21, v21
    v_exp_f32 v22, v22
    buffer_load_dwordx4 v4, s[36:39], s68 offen offset:1024 sc1 lds
    v_exp_f32 v23, v23
    v_exp_f32 v24, v24
    v_smfmac_f32_32x32x32_bf16 v[44:59], v[96:99], v[12:19], v251
    v_exp_f32 v25, v25
    buffer_load_dwordx4 v4, s[36:39], s68 offen offset:2048 sc1 lds
    s_add_u32 s68, s68, 12288
    s_cmp_eq_u32 s68, 0x2b0000
    s_cselect_b32 s68, 0x280000, s68
    v_exp_f32 v26, v26
    v_exp_f32 v27, v27
    v_exp_f32 v28, v28
    v_exp_f32 v29, v29
    v_smfmac_f32_32x32x32_bf16 v[44:59], v[100:103], v[20:27], v251
    s_waitcnt lgkmcnt(1)
    v_mfma_f32_32x32x16_bf16 v[12:27], v[88:91], v[76:79], 0
    v_exp_f32 v30, v30
    v_exp_f32 v31, v31
    v_exp_f32 v32, v32
    s_waitcnt lgkmcnt(0)
    v_mfma_f32_32x32x8bf16_1k v[12:27], v[92:93], v[84:85], v[12:27]
    v_exp_f32 v33, v33
    v_exp_f32 v34, v34
    v_exp_f32 v35, v35
    v_exp_f32 v36, v36
    v_exp_f32 v37, v37
    v_exp_f32 v38, v38
    v_exp_f32 v39, v39
    v_exp_f32 v40, v40
    v_smfmac_f32_32x32x32_bf16 v[60:75], v[96:99], v[28:35], v251
    ds_read_b128 v[96:99], v3 offset:32768
    v_exp_f32 v41, v41
    v_exp_f32 v42, v42
    v_exp_f32 v43, v43
    v_exp_f32 v12, v12
    v_exp_f32 v13, v13
    v_smfmac_f32_32x32x32_bf16 v[60:75], v[100:103], v[36:43], v251
    ds_read_b128 v[100:103], v3 offset:33536
    v_mfma_f32_32x32x16_bf16 v[28:43], v[88:91], v[80:83], 0
    ds_read_b128 v[88:91], v1 offset:27648
    v_exp_f32 v14, v14
    v_exp_f32 v15, v15
    v_exp_f32 v16, v16
    v_mfma_f32_32x32x8bf16_1k v[28:43], v[92:93], v[86:87], v[28:43]
    v_exp_f32 v17, v17
    v_exp_f32 v18, v18
    v_exp_f32 v19, v19
    v_exp_f32 v20, v20
    v_exp_f32 v21, v21
    s_waitcnt vmcnt(3)
    ds_read_b64_tr_b16 v[224:225], v216 offset:0
    ds_read_b64_tr_b16 v[226:227], v216 offset:512
    ds_read_b64_tr_b16 v[228:229], v216 offset:1024
    ds_read_b64_tr_b16 v[230:231], v216 offset:1536
    v_exp_f32 v22, v22
    v_exp_f32 v23, v23
    v_exp_f32 v24, v24
    s_waitcnt lgkmcnt(6)
    v_smfmac_f32_32x32x32_bf16 v[44:59], v[96:99], v[12:19], v251
    v_exp_f32 v25, v25
    v_exp_f32 v26, v26
    v_exp_f32 v27, v27
    v_exp_f32 v28, v28
    s_waitcnt lgkmcnt(0)
    buffer_store_dwordx4 v[224:227], v11, s[36:39], s89 offen sc1
    v_exp_f32 v29, v29
    v_smfmac_f32_32x32x32_bf16 v[44:59], v[100:103], v[20:27], v251
    v_mfma_f32_32x32x16_bf16 v[12:27], v[88:91], v[76:79], 0
    v_exp_f32 v30, v30
    v_exp_f32 v31, v31
    v_exp_f32 v32, v32
    v_mfma_f32_32x32x8bf16_1k v[12:27], v[94:95], v[84:85], v[12:27]
    v_exp_f32 v33, v33
    buffer_store_dwordx4 v[228:231], v11, s[36:39], s90 offen sc1
    v_exp_f32 v34, v34
    v_exp_f32 v35, v35
    v_exp_f32 v36, v36
    v_exp_f32 v37, v37
    v_exp_f32 v38, v38
    v_exp_f32 v39, v39
    v_exp_f32 v40, v40
    v_smfmac_f32_32x32x32_bf16 v[60:75], v[96:99], v[28:35], v251
    ds_read_b128 v[96:99], v3 offset:34304
    v_exp_f32 v41, v41
    v_exp_f32 v42, v42
    v_exp_f32 v43, v43
    v_exp_f32 v12, v12
    v_exp_f32 v13, v13
    v_smfmac_f32_32x32x32_bf16 v[60:75], v[100:103], v[36:43], v251
    ds_read_b128 v[100:103], v3 offset:35072
    v_mfma_f32_32x32x16_bf16 v[28:43], v[88:91], v[80:83], 0
    v_exp_f32 v14, v14
    v_exp_f32 v15, v15
    v_exp_f32 v16, v16
    v_mfma_f32_32x32x8bf16_1k v[28:43], v[94:95], v[86:87], v[28:43]
    v_exp_f32 v17, v17
    s_waitcnt lgkmcnt(0)
    s_barrier
    ds_read_b128 v[88:91], v1 offset:2048
    ds_read_b128 v[92:95], v2 offset:4608
    v_exp_f32 v18, v18
    v_exp_f32 v19, v19
    s_add_u32 m0, s69, 24576
    s_nop 0
    buffer_load_dwordx4 v4, s[36:39], s68 offen offset:0 sc1 lds
    v_exp_f32 v20, v20
    v_exp_f32 v21, v21
    v_exp_f32 v22, v22
    buffer_load_dwordx4 v4, s[36:39], s68 offen offset:1024 sc1 lds
    v_exp_f32 v23, v23
    v_exp_f32 v24, v24
    v_smfmac_f32_32x32x32_bf16 v[44:59], v[96:99], v[12:19], v251
    v_exp_f32 v25, v25
    buffer_load_dwordx4 v4, s[36:39], s68 offen offset:2048 sc1 lds
    s_add_u32 s68, s68, 12288
    s_cmp_eq_u32 s68, 0x2b0000
    s_cselect_b32 s68, 0x280000, s68
    v_exp_f32 v26, v26
    v_exp_f32 v27, v27
    v_exp_f32 v28, v28
    v_exp_f32 v29, v29
    v_smfmac_f32_32x32x32_bf16 v[44:59], v[100:103], v[20:27], v251
    s_waitcnt lgkmcnt(1)
    v_mfma_f32_32x32x16_bf16 v[12:27], v[88:91], v[76:79], 0
    s_add_u32 s86, s86, 0x20000
    s_mov_b64 exec, 1
    s_waitcnt vmcnt(3)
    buffer_store_dword v245, off, s[36:39], s86 sc1
    s_mov_b64 exec, -1
    v_exp_f32 v30, v30
    v_exp_f32 v31, v31
    v_exp_f32 v32, v32
    s_waitcnt lgkmcnt(0)
    v_mfma_f32_32x32x8bf16_1k v[12:27], v[92:93], v[84:85], v[12:27]
    v_exp_f32 v33, v33
    v_exp_f32 v34, v34
    v_exp_f32 v35, v35
    v_exp_f32 v36, v36
    v_exp_f32 v37, v37
    v_exp_f32 v38, v38
    v_exp_f32 v39, v39
    v_exp_f32 v40, v40
    v_smfmac_f32_32x32x32_bf16 v[60:75], v[96:99], v[28:35], v251
    ds_read_b128 v[96:99], v3 offset:8192
    v_exp_f32 v41, v41
    v_exp_f32 v42, v42
    v_exp_f32 v43, v43
    v_exp_f32 v12, v12
    v_exp_f32 v13, v13
    v_smfmac_f32_32x32x32_bf16 v[60:75], v[100:103], v[36:43], v251
    ds_read_b128 v[100:103], v3 offset:8960
    v_mfma_f32_32x32x16_bf16 v[28:43], v[88:91], v[80:83], 0
    ds_read_b128 v[88:91], v1 offset:3072
    v_exp_f32 v14, v14
    v_exp_f32 v15, v15
    v_exp_f32 v16, v16
    v_mfma_f32_32x32x8bf16_1k v[28:43], v[92:93], v[86:87], v[28:43]
    v_exp_f32 v17, v17
    v_exp_f32 v18, v18
    v_exp_f32 v19, v19
    v_exp_f32 v20, v20
    v_exp_f32 v21, v21
    v_exp_f32 v22, v22
    v_exp_f32 v23, v23
    v_exp_f32 v24, v24
    s_waitcnt lgkmcnt(2)
    v_smfmac_f32_32x32x32_bf16 v[44:59], v[96:99], v[12:19], v251
    v_exp_f32 v25, v25
    v_exp_f32 v26, v26
    v_exp_f32 v27, v27
    v_exp_f32 v28, v28
    v_exp_f32 v29, v29
    s_waitcnt lgkmcnt(1)
    v_smfmac_f32_32x32x32_bf16 v[44:59], v[100:103], v[20:27], v251
    s_waitcnt lgkmcnt(0)
    v_mfma_f32_32x32x16_bf16 v[12:27], v[88:91], v[76:79], 0
    v_exp_f32 v30, v30
    v_exp_f32 v31, v31
    v_exp_f32 v32, v32
    v_mfma_f32_32x32x8bf16_1k v[12:27], v[94:95], v[84:85], v[12:27]
    v_exp_f32 v33, v33
    v_exp_f32 v34, v34
    v_exp_f32 v35, v35
    v_exp_f32 v36, v36
    v_exp_f32 v37, v37
    v_exp_f32 v38, v38
    v_exp_f32 v39, v39
    v_exp_f32 v40, v40
    v_smfmac_f32_32x32x32_bf16 v[60:75], v[96:99], v[28:35], v251
    ds_read_b128 v[96:99], v3 offset:9728
    v_exp_f32 v41, v41
    v_exp_f32 v42, v42
    v_exp_f32 v43, v43
    v_exp_f32 v12, v12
    v_exp_f32 v13, v13
    v_smfmac_f32_32x32x32_bf16 v[60:75], v[100:103], v[36:43], v251
    ds_read_b128 v[100:103], v3 offset:10496
    v_mfma_f32_32x32x16_bf16 v[28:43], v[88:91], v[80:83], 0
    v_exp_f32 v14, v14
    v_exp_f32 v15, v15
    v_exp_f32 v16, v16
    v_mfma_f32_32x32x8bf16_1k v[28:43], v[94:95], v[86:87], v[28:43]
    v_exp_f32 v17, v17
    s_waitcnt lgkmcnt(0)
    s_barrier
    ds_read_b128 v[88:91], v1 offset:14336
    ds_read_b128 v[92:95], v2 offset:16896
    v_exp_f32 v18, v18
    v_exp_f32 v19, v19
    s_add_u32 m0, s69, 0
    s_nop 0
    buffer_load_dwordx4 v4, s[36:39], s68 offen offset:0 sc1 lds
    v_exp_f32 v20, v20
    v_exp_f32 v21, v21
    v_exp_f32 v22, v22
    buffer_load_dwordx4 v4, s[36:39], s68 offen offset:1024 sc1 lds
    v_exp_f32 v23, v23
    v_exp_f32 v24, v24
    v_smfmac_f32_32x32x32_bf16 v[44:59], v[96:99], v[12:19], v251
    v_exp_f32 v25, v25
    buffer_load_dwordx4 v4, s[36:39], s68 offen offset:2048 sc1 lds
    s_add_u32 s68, s68, 12288
    s_cmp_eq_u32 s68, 0x2b0000
    s_cselect_b32 s68, 0x280000, s68
    v_exp_f32 v26, v26
    v_exp_f32 v27, v27
    v_exp_f32 v28, v28
    v_exp_f32 v29, v29
    v_smfmac_f32_32x32x32_bf16 v[44:59], v[100:103], v[20:27], v251
    s_waitcnt lgkmcnt(1)
    v_mfma_f32_32x32x16_bf16 v[12:27], v[88:91], v[76:79], 0
    v_exp_f32 v30, v30
    v_exp_f32 v31, v31
    v_exp_f32 v32, v32
    s_waitcnt lgkmcnt(0)
    v_mfma_f32_32x32x8bf16_1k v[12:27], v[92:93], v[84:85], v[12:27]
    v_exp_f32 v33, v33
    v_exp_f32 v34, v34
    v_exp_f32 v35, v35
    v_exp_f32 v36, v36
    v_exp_f32 v37, v37
    v_exp_f32 v38, v38
    v_exp_f32 v39, v39
    v_exp_f32 v40, v40
    v_smfmac_f32_32x32x32_bf16 v[60:75], v[96:99], v[28:35], v251
    ds_read_b128 v[96:99], v3 offset:20480
    v_exp_f32 v41, v41
    v_exp_f32 v42, v42
    v_exp_f32 v43, v43
    v_exp_f32 v12, v12
    v_exp_f32 v13, v13
    v_smfmac_f32_32x32x32_bf16 v[60:75], v[100:103], v[36:43], v251
    ds_read_b128 v[100:103], v3 offset:21248
    v_mfma_f32_32x32x16_bf16 v[28:43], v[88:91], v[80:83], 0
    ds_read_b128 v[88:91], v1 offset:15360
    v_exp_f32 v14, v14
    v_exp_f32 v15, v15
    v_exp_f32 v16, v16
    v_mfma_f32_32x32x8bf16_1k v[28:43], v[92:93], v[86:87], v[28:43]
    v_exp_f32 v17, v17
    v_exp_f32 v18, v18
    v_exp_f32 v19, v19
    v_exp_f32 v20, v20
    v_exp_f32 v21, v21
    v_exp_f32 v22, v22
    v_exp_f32 v23, v23
    v_exp_f32 v24, v24
    s_waitcnt lgkmcnt(2)
    v_smfmac_f32_32x32x32_bf16 v[44:59], v[96:99], v[12:19], v251
    v_exp_f32 v25, v25
    v_exp_f32 v26, v26
    v_exp_f32 v27, v27
    v_exp_f32 v28, v28
    v_exp_f32 v29, v29
    s_waitcnt lgkmcnt(1)
    v_smfmac_f32_32x32x32_bf16 v[44:59], v[100:103], v[20:27], v251
    s_waitcnt lgkmcnt(0)
    v_mfma_f32_32x32x16_bf16 v[12:27], v[88:91], v[76:79], 0
    v_exp_f32 v30, v30
    v_exp_f32 v31, v31
    v_exp_f32 v32, v32
    v_mfma_f32_32x32x8bf16_1k v[12:27], v[94:95], v[84:85], v[12:27]
    v_exp_f32 v33, v33
    v_exp_f32 v34, v34
    v_exp_f32 v35, v35
    v_exp_f32 v36, v36
    v_exp_f32 v37, v37
    v_exp_f32 v38, v38
    v_exp_f32 v39, v39
    v_exp_f32 v40, v40
    v_smfmac_f32_32x32x32_bf16 v[60:75], v[96:99], v[28:35], v251
    ds_read_b128 v[96:99], v3 offset:22016
    v_exp_f32 v41, v41
    v_exp_f32 v42, v42
    v_exp_f32 v43, v43
    v_exp_f32 v12, v12
    v_exp_f32 v13, v13
    v_smfmac_f32_32x32x32_bf16 v[60:75], v[100:103], v[36:43], v251
    ds_read_b128 v[100:103], v3 offset:22784
    v_mfma_f32_32x32x16_bf16 v[28:43], v[88:91], v[80:83], 0
    v_exp_f32 v14, v14
    v_exp_f32 v15, v15
    v_exp_f32 v16, v16
    v_mfma_f32_32x32x8bf16_1k v[28:43], v[94:95], v[86:87], v[28:43]
    v_exp_f32 v17, v17
    s_waitcnt vmcnt(4) lgkmcnt(0)
    s_barrier
    ds_read_b128 v[88:91], v1 offset:26624
    ds_read_b128 v[92:95], v2 offset:29184
    v_exp_f32 v18, v18
    v_exp_f32 v19, v19
    s_add_u32 m0, s69, 12288
    s_nop 0
    buffer_load_dwordx4 v4, s[36:39], s68 offen offset:0 sc1 lds
    v_exp_f32 v20, v20
    v_exp_f32 v21, v21
    v_exp_f32 v22, v22
    buffer_load_dwordx4 v4, s[36:39], s68 offen offset:1024 sc1 lds
    v_exp_f32 v23, v23
    v_exp_f32 v24, v24
    v_smfmac_f32_32x32x32_bf16 v[44:59], v[96:99], v[12:19], v251
    v_exp_f32 v25, v25
    buffer_load_dwordx4 v4, s[36:39], s68 offen offset:2048 sc1 lds
    s_add_u32 s68, s68, 12288
    s_cmp_eq_u32 s68, 0x2b0000
    s_cselect_b32 s68, 0x280000, s68
    v_exp_f32 v26, v26
    v_exp_f32 v27, v27
    v_exp_f32 v28, v28
    v_exp_f32 v29, v29
    v_smfmac_f32_32x32x32_bf16 v[44:59], v[100:103], v[20:27], v251
    s_waitcnt lgkmcnt(1)
    v_mfma_f32_32x32x16_bf16 v[12:27], v[88:91], v[76:79], 0
    v_exp_f32 v30, v30
    v_exp_f32 v31, v31
    v_exp_f32 v32, v32
    s_waitcnt lgkmcnt(0)
    v_mfma_f32_32x32x8bf16_1k v[12:27], v[92:93], v[84:85], v[12:27]
    v_exp_f32 v33, v33
    v_exp_f32 v34, v34
    v_exp_f32 v35, v35
    v_exp_f32 v36, v36
    v_exp_f32 v37, v37
    v_exp_f32 v38, v38
    v_exp_f32 v39, v39
    v_exp_f32 v40, v40
    v_smfmac_f32_32x32x32_bf16 v[60:75], v[96:99], v[28:35], v251
    ds_read_b128 v[96:99], v3 offset:32768
    v_exp_f32 v41, v41
    v_exp_f32 v42, v42
    v_exp_f32 v43, v43
    v_exp_f32 v12, v12
    v_exp_f32 v13, v13
    v_smfmac_f32_32x32x32_bf16 v[60:75], v[100:103], v[36:43], v251
    ds_read_b128 v[100:103], v3 offset:33536
    v_mfma_f32_32x32x16_bf16 v[28:43], v[88:91], v[80:83], 0
    ds_read_b128 v[88:91], v1 offset:27648
    v_exp_f32 v14, v14
    v_exp_f32 v15, v15
    v_exp_f32 v16, v16
    v_mfma_f32_32x32x8bf16_1k v[28:43], v[92:93], v[86:87], v[28:43]
    v_exp_f32 v17, v17
    v_exp_f32 v18, v18
    v_exp_f32 v19, v19
    v_exp_f32 v20, v20
    v_exp_f32 v21, v21
    v_exp_f32 v22, v22
    v_exp_f32 v23, v23
    v_exp_f32 v24, v24
    s_waitcnt lgkmcnt(2)
    v_smfmac_f32_32x32x32_bf16 v[44:59], v[96:99], v[12:19], v251
    v_exp_f32 v25, v25
    v_exp_f32 v26, v26
    v_exp_f32 v27, v27
    v_exp_f32 v28, v28
    v_exp_f32 v29, v29
    s_waitcnt lgkmcnt(1)
    v_smfmac_f32_32x32x32_bf16 v[44:59], v[100:103], v[20:27], v251
    s_waitcnt lgkmcnt(0)
    v_mfma_f32_32x32x16_bf16 v[12:27], v[88:91], v[76:79], 0
    v_exp_f32 v30, v30
    v_exp_f32 v31, v31
    v_exp_f32 v32, v32
    v_mfma_f32_32x32x8bf16_1k v[12:27], v[94:95], v[84:85], v[12:27]
    v_exp_f32 v33, v33
    v_exp_f32 v34, v34
    v_exp_f32 v35, v35
    v_exp_f32 v36, v36
    v_exp_f32 v37, v37
    v_exp_f32 v38, v38
    v_exp_f32 v39, v39
    v_exp_f32 v40, v40
    v_smfmac_f32_32x32x32_bf16 v[60:75], v[96:99], v[28:35], v251
    ds_read_b128 v[96:99], v3 offset:34304
    v_exp_f32 v41, v41
    v_exp_f32 v42, v42
    v_exp_f32 v43, v43
    v_exp_f32 v12, v12
    v_exp_f32 v13, v13
    v_smfmac_f32_32x32x32_bf16 v[60:75], v[100:103], v[36:43], v251
    ds_read_b128 v[100:103], v3 offset:35072
    v_mfma_f32_32x32x16_bf16 v[28:43], v[88:91], v[80:83], 0
    v_exp_f32 v14, v14
    v_exp_f32 v15, v15
    v_exp_f32 v16, v16
    v_mfma_f32_32x32x8bf16_1k v[28:43], v[94:95], v[86:87], v[28:43]
    v_exp_f32 v17, v17
    s_waitcnt vmcnt(3) lgkmcnt(0)
    s_barrier
    ds_read_b128 v[88:91], v1 offset:2048
    ds_read_b128 v[92:95], v2 offset:4608
    v_exp_f32 v18, v18
    v_exp_f32 v19, v19
    s_add_u32 m0, s69, 24576
    s_nop 0
    buffer_load_dwordx4 v4, s[36:39], s68 offen offset:0 sc1 lds
    v_exp_f32 v20, v20
    v_exp_f32 v21, v21
    v_exp_f32 v22, v22
    buffer_load_dwordx4 v4, s[36:39], s68 offen offset:1024 sc1 lds
    v_exp_f32 v23, v23
    v_exp_f32 v24, v24
    v_smfmac_f32_32x32x32_bf16 v[44:59], v[96:99], v[12:19], v251
    v_exp_f32 v25, v25
    buffer_load_dwordx4 v4, s[36:39], s68 offen offset:2048 sc1 lds
    s_add_u32 s68, s68, 12288
    s_cmp_eq_u32 s68, 0x2b0000
    s_cselect_b32 s68, 0x280000, s68
    v_exp_f32 v26, v26
    v_exp_f32 v27, v27
    v_exp_f32 v28, v28
    v_exp_f32 v29, v29
    v_smfmac_f32_32x32x32_bf16 v[44:59], v[100:103], v[20:27], v251
    s_waitcnt lgkmcnt(1)
    v_mfma_f32_32x32x16_bf16 v[12:27], v[88:91], v[76:79], 0
    v_exp_f32 v30, v30
    v_exp_f32 v31, v31
    v_exp_f32 v32, v32
    s_waitcnt lgkmcnt(0)
    v_mfma_f32_32x32x8bf16_1k v[12:27], v[92:93], v[84:85], v[12:27]
    v_exp_f32 v33, v33
    v_exp_f32 v34, v34
    v_exp_f32 v35, v35
    v_exp_f32 v36, v36
    v_and_b32 v253, 0xfff, v253
    buffer_load_dword v254, v253, s[36:39], s88 offen sc1
    v_exp_f32 v37, v37
    v_exp_f32 v38, v38
    v_exp_f32 v39, v39
    v_exp_f32 v40, v40
    v_smfmac_f32_32x32x32_bf16 v[60:75], v[96:99], v[28:35], v251
    ds_read_b128 v[96:99], v3 offset:8192
    v_exp_f32 v41, v41
    v_exp_f32 v42, v42
    v_exp_f32 v43, v43
    v_exp_f32 v12, v12
    v_exp_f32 v13, v13
    v_smfmac_f32_32x32x32_bf16 v[60:75], v[100:103], v[36:43], v251
    ds_read_b128 v[100:103], v3 offset:8960
    v_mfma_f32_32x32x16_bf16 v[28:43], v[88:91], v[80:83], 0
    ds_read_b128 v[88:91], v1 offset:3072
    v_exp_f32 v14, v14
    v_exp_f32 v15, v15
    v_exp_f32 v16, v16
    v_mfma_f32_32x32x8bf16_1k v[28:43], v[92:93], v[86:87], v[28:43]
    v_exp_f32 v17, v17
    v_exp_f32 v18, v18
    v_exp_f32 v19, v19
    v_exp_f32 v20, v20
    v_exp_f32 v21, v21
    v_exp_f32 v22, v22
    v_exp_f32 v23, v23
    v_exp_f32 v24, v24
    s_waitcnt lgkmcnt(2)
    v_smfmac_f32_32x32x32_bf16 v[44:59], v[96:99], v[12:19], v251
    v_exp_f32 v25, v25
    v_exp_f32 v26, v26
    v_exp_f32 v27, v27
    v_exp_f32 v28, v28
    v_exp_f32 v29, v29
    s_waitcnt lgkmcnt(1)
    v_smfmac_f32_32x32x32_bf16 v[44:59], v[100:103], v[20:27], v251
    s_waitcnt lgkmcnt(0)
    v_mfma_f32_32x32x16_bf16 v[12:27], v[88:91], v[76:79], 0
    v_exp_f32 v30, v30
    v_exp_f32 v31, v31
    v_exp_f32 v32, v32
    v_mfma_f32_32x32x8bf16_1k v[12:27], v[94:95], v[84:85], v[12:27]
    v_exp_f32 v33, v33
    v_exp_f32 v34, v34
    v_exp_f32 v35, v35
    v_exp_f32 v36, v36
    v_exp_f32 v37, v37
    v_exp_f32 v38, v38
    v_exp_f32 v39, v39
    v_exp_f32 v40, v40
    v_smfmac_f32_32x32x32_bf16 v[60:75], v[96:99], v[28:35], v251
    ds_read_b128 v[96:99], v3 offset:9728
    v_exp_f32 v41, v41
    v_exp_f32 v42, v42
    v_exp_f32 v43, v43
    v_exp_f32 v12, v12
    v_exp_f32 v13, v13
    v_smfmac_f32_32x32x32_bf16 v[60:75], v[100:103], v[36:43], v251
    ds_read_b128 v[100:103], v3 offset:10496
    v_mfma_f32_32x32x16_bf16 v[28:43], v[88:91], v[80:83], 0
    v_exp_f32 v14, v14
    v_exp_f32 v15, v15
    v_exp_f32 v16, v16
    v_mfma_f32_32x32x8bf16_1k v[28:43], v[94:95], v[86:87], v[28:43]
    v_exp_f32 v17, v17
    s_waitcnt vmcnt(4) lgkmcnt(0)
    s_barrier
    ds_read_b128 v[88:91], v1 offset:14336
    ds_read_b128 v[92:95], v2 offset:16896
    v_exp_f32 v18, v18
    v_exp_f32 v19, v19
    s_add_u32 m0, s69, 0
    s_nop 0
    buffer_load_dwordx4 v4, s[36:39], s68 offen offset:0 sc1 lds
    v_exp_f32 v20, v20
    v_exp_f32 v21, v21
    v_exp_f32 v22, v22
    buffer_load_dwordx4 v4, s[36:39], s68 offen offset:1024 sc1 lds
    v_exp_f32 v23, v23
    v_exp_f32 v24, v24
    v_smfmac_f32_32x32x32_bf16 v[44:59], v[96:99], v[12:19], v251
    v_exp_f32 v25, v25
    buffer_load_dwordx4 v4, s[36:39], s68 offen offset:2048 sc1 lds
    s_add_u32 s68, s68, 12288
    s_cmp_eq_u32 s68, 0x2b0000
    s_cselect_b32 s68, 0x280000, s68
    v_exp_f32 v26, v26
    v_exp_f32 v27, v27
    v_exp_f32 v28, v28
    v_exp_f32 v29, v29
gated_mix__grouped_kv_mqa__mixer_gmlp__prompt_kernel_wpoll:
    s_waitcnt vmcnt(3)
    v_cmp_ne_u32 vcc, s59, v254
    s_cbranch_vccnz gated_mix__grouped_kv_mqa__mixer_gmlp__prompt_kernel_wretry
gated_mix__grouped_kv_mqa__mixer_gmlp__prompt_kernel_wok:
    v_smfmac_f32_32x32x32_bf16 v[44:59], v[100:103], v[20:27], v251
    s_waitcnt lgkmcnt(1)
    v_mfma_f32_32x32x16_bf16 v[12:27], v[88:91], v[76:79], 0
    v_exp_f32 v30, v30
    v_exp_f32 v31, v31
    v_exp_f32 v32, v32
    s_waitcnt lgkmcnt(0)
    v_mfma_f32_32x32x8bf16_1k v[12:27], v[92:93], v[84:85], v[12:27]
    v_exp_f32 v33, v33
    buffer_load_dwordx4 v[104:107], v11, s[36:39], s71 offen offset:0 sc1
    v_exp_f32 v34, v34
    v_exp_f32 v35, v35
    v_exp_f32 v36, v36
    v_exp_f32 v37, v37
    v_exp_f32 v38, v38
    v_exp_f32 v39, v39
    v_exp_f32 v40, v40
    v_smfmac_f32_32x32x32_bf16 v[60:75], v[96:99], v[28:35], v251
    ds_read_b128 v[96:99], v3 offset:20480
    v_exp_f32 v41, v41
    buffer_load_dwordx4 v[108:111], v11, s[36:39], s71 offen offset:1024 sc1
    v_exp_f32 v42, v42
    v_exp_f32 v43, v43
    v_exp_f32 v12, v12
    v_exp_f32 v13, v13
    v_smfmac_f32_32x32x32_bf16 v[60:75], v[100:103], v[36:43], v251
    ds_read_b128 v[100:103], v3 offset:21248
    v_mfma_f32_32x32x16_bf16 v[28:43], v[88:91], v[80:83], 0
    ds_read_b128 v[88:91], v1 offset:15360
    v_exp_f32 v14, v14
    v_exp_f32 v15, v15
    v_exp_f32 v16, v16
    v_mfma_f32_32x32x8bf16_1k v[28:43], v[92:93], v[86:87], v[28:43]
    buffer_load_dwordx4 v[112:115], v11, s[36:39], s71 offen offset:2048 sc1
    v_exp_f32 v17, v17
    v_exp_f32 v18, v18
    v_exp_f32 v19, v19
    v_exp_f32 v20, v20
    v_exp_f32 v21, v21
    v_exp_f32 v22, v22
    v_exp_f32 v23, v23
    v_exp_f32 v24, v24
    s_waitcnt lgkmcnt(2)
    v_smfmac_f32_32x32x32_bf16 v[44:59], v[96:99], v[12:19], v251
    buffer_load_dwordx4 v[116:119], v11, s[36:39], s71 offen offset:3072 sc1
    v_exp_f32 v25, v25
    v_exp_f32 v26, v26
    v_exp_f32 v27, v27
    v_exp_f32 v28, v28
    v_exp_f32 v29, v29
    s_waitcnt lgkmcnt(1)
    v_smfmac_f32_32x32x32_bf16 v[44:59], v[100:103], v[20:27], v251
    s_waitcnt lgkmcnt(0)
    v_mfma_f32_32x32x16_bf16 v[12:27], v[88:91], v[76:79], 0
    v_exp_f32 v30, v30
    v_exp_f32 v31, v31
    v_exp_f32 v32, v32
    s_add_u32 s71, s71, 0x1000
    buffer_load_dwordx4 v[120:123], v11, s[36:39], s71 offen offset:0 sc1
    v_mfma_f32_32x32x8bf16_1k v[12:27], v[94:95], v[84:85], v[12:27]
    v_exp_f32 v33, v33
    v_exp_f32 v34, v34
    v_exp_f32 v35, v35
    v_exp_f32 v36, v36
    v_exp_f32 v37, v37
    v_exp_f32 v38, v38
    v_exp_f32 v39, v39
    v_exp_f32 v40, v40
    v_smfmac_f32_32x32x32_bf16 v[60:75], v[96:99], v[28:35], v251
    ds_read_b128 v[96:99], v3 offset:22016
    buffer_load_dwordx4 v[124:127], v11, s[36:39], s71 offen offset:1024 sc1
    v_exp_f32 v41, v41
    v_exp_f32 v42, v42
    v_exp_f32 v43, v43
    v_exp_f32 v12, v12
    v_exp_f32 v13, v13
    v_smfmac_f32_32x32x32_bf16 v[60:75], v[100:103], v[36:43], v251
    ds_read_b128 v[100:103], v3 offset:22784
    v_mfma_f32_32x32x16_bf16 v[28:43], v[88:91], v[80:83], 0
    v_exp_f32 v14, v14
    v_exp_f32 v15, v15
    v_exp_f32 v16, v16
    v_mfma_f32_32x32x8bf16_1k v[28:43], v[94:95], v[86:87], v[28:43]
    v_exp_f32 v17, v17
    s_waitcnt lgkmcnt(0)
    s_barrier
    ds_read_b128 v[88:91], v1 offset:26624
    ds_read_b128 v[92:95], v2 offset:29184
    v_exp_f32 v18, v18
    v_exp_f32 v19, v19
    s_add_u32 m0, s69, 12288
    s_nop 0
    buffer_load_dwordx4 v4, s[36:39], s68 offen offset:0 sc1 lds
    v_exp_f32 v20, v20
    v_exp_f32 v21, v21
    v_exp_f32 v22, v22
    buffer_load_dwordx4 v4, s[36:39], s68 offen offset:1024 sc1 lds
    v_exp_f32 v23, v23
    v_exp_f32 v24, v24
    v_smfmac_f32_32x32x32_bf16 v[44:59], v[96:99], v[12:19], v251
    v_exp_f32 v25, v25
    buffer_load_dwordx4 v4, s[36:39], s68 offen offset:2048 sc1 lds
    s_add_u32 s68, s68, 12288
    s_cmp_eq_u32 s68, 0x2b0000
    s_cselect_b32 s68, 0x280000, s68
    v_exp_f32 v26, v26
    v_exp_f32 v27, v27
    v_exp_f32 v28, v28
    v_exp_f32 v29, v29
    v_smfmac_f32_32x32x32_bf16 v[44:59], v[100:103], v[20:27], v251
    s_waitcnt lgkmcnt(1)
    v_mfma_f32_32x32x16_bf16 v[12:27], v[88:91], v[76:79], 0
    v_exp_f32 v30, v30
    v_exp_f32 v31, v31
    v_exp_f32 v32, v32
    s_waitcnt lgkmcnt(0)
    v_mfma_f32_32x32x8bf16_1k v[12:27], v[92:93], v[84:85], v[12:27]
    v_exp_f32 v33, v33
    buffer_load_dwordx4 v[128:131], v11, s[36:39], s71 offen offset:2048 sc1
    v_exp_f32 v34, v34
    v_exp_f32 v35, v35
    v_exp_f32 v36, v36
    v_exp_f32 v37, v37
    v_exp_f32 v38, v38
    v_exp_f32 v39, v39
    v_exp_f32 v40, v40
    v_smfmac_f32_32x32x32_bf16 v[60:75], v[96:99], v[28:35], v251
    ds_read_b128 v[96:99], v3 offset:32768
    v_exp_f32 v41, v41
    buffer_load_dwordx4 v[132:135], v11, s[36:39], s71 offen offset:3072 sc1
    v_exp_f32 v42, v42
    v_exp_f32 v43, v43
    v_exp_f32 v12, v12
    v_exp_f32 v13, v13
    v_smfmac_f32_32x32x32_bf16 v[60:75], v[100:103], v[36:43], v251
    ds_read_b128 v[100:103], v3 offset:33536
    v_mfma_f32_32x32x16_bf16 v[28:43], v[88:91], v[80:83], 0
    ds_read_b128 v[88:91], v1 offset:27648
    v_exp_f32 v14, v14
    v_exp_f32 v15, v15
    v_exp_f32 v16, v16
    v_mfma_f32_32x32x8bf16_1k v[28:43], v[92:93], v[86:87], v[28:43]
    s_add_u32 s71, s71, 0x1000
    buffer_load_dwordx4 v[136:139], v11, s[36:39], s71 offen offset:0 sc1
    v_exp_f32 v17, v17
    v_exp_f32 v18, v18
    v_exp_f32 v19, v19
    v_exp_f32 v20, v20
    v_exp_f32 v21, v21
    v_exp_f32 v22, v22
    v_exp_f32 v23, v23
    v_exp_f32 v24, v24
    s_waitcnt lgkmcnt(2)
    v_smfmac_f32_32x32x32_bf16 v[44:59], v[96:99], v[12:19], v251
    buffer_load_dwordx4 v[140:143], v11, s[36:39], s71 offen offset:1024 sc1
    v_exp_f32 v25, v25
    v_exp_f32 v26, v26
    v_exp_f32 v27, v27
    v_exp_f32 v28, v28
    v_exp_f32 v29, v29
    s_waitcnt lgkmcnt(1)
    v_smfmac_f32_32x32x32_bf16 v[44:59], v[100:103], v[20:27], v251
    s_waitcnt lgkmcnt(0)
    v_mfma_f32_32x32x16_bf16 v[12:27], v[88:91], v[76:79], 0
    v_exp_f32 v30, v30
    v_exp_f32 v31, v31
    v_exp_f32 v32, v32
    buffer_load_dwordx4 v[144:147], v11, s[36:39], s71 offen offset:2048 sc1
    v_mfma_f32_32x32x8bf16_1k v[12:27], v[94:95], v[84:85], v[12:27]
    v_exp_f32 v33, v33
    v_exp_f32 v34, v34
    v_exp_f32 v35, v35
    v_exp_f32 v36, v36
    v_exp_f32 v37, v37
    v_exp_f32 v38, v38
    v_exp_f32 v39, v39
    v_exp_f32 v40, v40
    v_smfmac_f32_32x32x32_bf16 v[60:75], v[96:99], v[28:35], v251
    ds_read_b128 v[96:99], v3 offset:34304
    buffer_load_dwordx4 v[148:151], v11, s[36:39], s71 offen offset:3072 sc1
    v_exp_f32 v41, v41
    v_exp_f32 v42, v42
    v_exp_f32 v43, v43
    v_exp_f32 v12, v12
    v_exp_f32 v13, v13
    v_smfmac_f32_32x32x32_bf16 v[60:75], v[100:103], v[36:43], v251
    ds_read_b128 v[100:103], v3 offset:35072
    v_mfma_f32_32x32x16_bf16 v[28:43], v[88:91], v[80:83], 0
    v_exp_f32 v14, v14
    v_exp_f32 v15, v15
    v_exp_f32 v16, v16
    v_mfma_f32_32x32x8bf16_1k v[28:43], v[94:95], v[86:87], v[28:43]
    v_exp_f32 v17, v17
    s_waitcnt vmcnt(15) lgkmcnt(0)
    s_barrier
    ds_read_b128 v[88:91], v1 offset:2048
    ds_read_b128 v[92:95], v2 offset:4608
    v_exp_f32 v18, v18
    v_exp_f32 v19, v19
    s_add_u32 m0, s69, 24576
    s_nop 0
    buffer_load_dwordx4 v4, s[36:39], s68 offen offset:0 sc1 lds
    v_exp_f32 v20, v20
    v_exp_f32 v21, v21
    v_exp_f32 v22, v22
    buffer_load_dwordx4 v4, s[36:39], s68 offen offset:1024 sc1 lds
    v_exp_f32 v23, v23
    v_exp_f32 v24, v24
    v_smfmac_f32_32x32x32_bf16 v[44:59], v[96:99], v[12:19], v251
    v_exp_f32 v25, v25
    buffer_load_dwordx4 v4, s[36:39], s68 offen offset:2048 sc1 lds
    s_add_u32 s68, s68, 12288
    s_cmp_eq_u32 s68, 0x2b0000
    s_cselect_b32 s68, 0x280000, s68
    v_exp_f32 v26, v26
    v_exp_f32 v27, v27
    v_exp_f32 v28, v28
    v_exp_f32 v29, v29
    v_smfmac_f32_32x32x32_bf16 v[44:59], v[100:103], v[20:27], v251
    s_waitcnt lgkmcnt(1)
    v_mfma_f32_32x32x16_bf16 v[12:27], v[88:91], v[76:79], 0
    v_exp_f32 v30, v30
    v_exp_f32 v31, v31
    v_exp_f32 v32, v32
    s_waitcnt lgkmcnt(0)
    v_mfma_f32_32x32x8bf16_1k v[12:27], v[92:93], v[84:85], v[12:27]
    v_exp_f32 v33, v33
    s_add_u32 s71, s71, 0x1000
    buffer_load_dwordx4 v[152:155], v11, s[36:39], s71 offen offset:0 sc1
    v_exp_f32 v34, v34
    v_exp_f32 v35, v35
    v_exp_f32 v36, v36
    v_exp_f32 v37, v37
    v_exp_f32 v38, v38
    v_exp_f32 v39, v39
    v_exp_f32 v40, v40
    v_smfmac_f32_32x32x32_bf16 v[60:75], v[96:99], v[28:35], v251
    ds_read_b128 v[96:99], v3 offset:8192
    v_exp_f32 v41, v41
    buffer_load_dwordx4 v[156:159], v11, s[36:39], s71 offen offset:1024 sc1
    v_exp_f32 v42, v42
    v_exp_f32 v43, v43
    v_exp_f32 v12, v12
    v_exp_f32 v13, v13
    v_smfmac_f32_32x32x32_bf16 v[60:75], v[100:103], v[36:43], v251
    ds_read_b128 v[100:103], v3 offset:8960
    v_mfma_f32_32x32x16_bf16 v[28:43], v[88:91], v[80:83], 0
    ds_read_b128 v[88:91], v1 offset:3072
    v_exp_f32 v14, v14
    v_exp_f32 v15, v15
    v_exp_f32 v16, v16
    v_mfma_f32_32x32x8bf16_1k v[28:43], v[92:93], v[86:87], v[28:43]
    buffer_load_dwordx4 v[160:163], v11, s[36:39], s71 offen offset:2048 sc1
    v_exp_f32 v17, v17
    v_exp_f32 v18, v18
    v_exp_f32 v19, v19
    v_exp_f32 v20, v20
    v_exp_f32 v21, v21
    v_exp_f32 v22, v22
    v_exp_f32 v23, v23
    v_exp_f32 v24, v24
    s_waitcnt lgkmcnt(2)
    v_smfmac_f32_32x32x32_bf16 v[44:59], v[96:99], v[12:19], v251
    buffer_load_dwordx4 v[164:167], v11, s[36:39], s71 offen offset:3072 sc1
    v_exp_f32 v25, v25
    v_exp_f32 v26, v26
    v_exp_f32 v27, v27
    v_exp_f32 v28, v28
    v_exp_f32 v29, v29
    s_waitcnt lgkmcnt(1)
    v_smfmac_f32_32x32x32_bf16 v[44:59], v[100:103], v[20:27], v251
    s_waitcnt lgkmcnt(0)
    v_mfma_f32_32x32x16_bf16 v[12:27], v[88:91], v[76:79], 0
    v_exp_f32 v30, v30
    v_exp_f32 v31, v31
    v_exp_f32 v32, v32
    s_add_u32 s71, s71, 0x1000
    buffer_load_dwordx4 v[168:171], v11, s[36:39], s71 offen offset:0 sc1
    v_mfma_f32_32x32x8bf16_1k v[12:27], v[94:95], v[84:85], v[12:27]
    v_exp_f32 v33, v33
    v_exp_f32 v34, v34
    v_exp_f32 v35, v35
    v_exp_f32 v36, v36
    v_exp_f32 v37, v37
    v_exp_f32 v38, v38
    v_exp_f32 v39, v39
    v_exp_f32 v40, v40
    v_smfmac_f32_32x32x32_bf16 v[60:75], v[96:99], v[28:35], v251
    ds_read_b128 v[96:99], v3 offset:9728
    buffer_load_dwordx4 v[172:175], v11, s[36:39], s71 offen offset:1024 sc1
    v_exp_f32 v41, v41
    v_exp_f32 v42, v42
    v_exp_f32 v43, v43
    v_exp_f32 v12, v12
    v_exp_f32 v13, v13
    v_smfmac_f32_32x32x32_bf16 v[60:75], v[100:103], v[36:43], v251
    ds_read_b128 v[100:103], v3 offset:10496
    v_mfma_f32_32x32x16_bf16 v[28:43], v[88:91], v[80:83], 0
    v_exp_f32 v14, v14
    v_exp_f32 v15, v15
    v_exp_f32 v16, v16
    v_mfma_f32_32x32x8bf16_1k v[28:43], v[94:95], v[86:87], v[28:43]
    v_exp_f32 v17, v17
    s_waitcnt vmcnt(15) lgkmcnt(0)
    s_barrier
    ds_read_b128 v[88:91], v1 offset:14336
    ds_read_b128 v[92:95], v2 offset:16896
    v_exp_f32 v18, v18
    v_exp_f32 v19, v19
    v_exp_f32 v20, v20
    v_exp_f32 v21, v21
    v_exp_f32 v22, v22
    v_exp_f32 v23, v23
    v_exp_f32 v24, v24
    v_smfmac_f32_32x32x32_bf16 v[44:59], v[96:99], v[12:19], v251
    v_exp_f32 v25, v25
    v_exp_f32 v26, v26
    v_exp_f32 v27, v27
    v_exp_f32 v28, v28
    v_exp_f32 v29, v29
    v_smfmac_f32_32x32x32_bf16 v[44:59], v[100:103], v[20:27], v251
    s_waitcnt lgkmcnt(1)
    v_mfma_f32_32x32x16_bf16 v[12:27], v[88:91], v[76:79], 0
    v_exp_f32 v30, v30
    v_exp_f32 v31, v31
    v_exp_f32 v32, v32
    s_waitcnt lgkmcnt(0)
    v_mfma_f32_32x32x8bf16_1k v[12:27], v[92:93], v[84:85], v[12:27]
    v_exp_f32 v33, v33
    buffer_load_dwordx4 v[176:179], v11, s[36:39], s71 offen offset:2048 sc1
    v_exp_f32 v34, v34
    v_exp_f32 v35, v35
    v_exp_f32 v36, v36
    v_exp_f32 v37, v37
    v_exp_f32 v38, v38
    v_exp_f32 v39, v39
    v_exp_f32 v40, v40
    v_smfmac_f32_32x32x32_bf16 v[60:75], v[96:99], v[28:35], v251
    ds_read_b128 v[96:99], v3 offset:20480
    v_exp_f32 v41, v41
    buffer_load_dwordx4 v[180:183], v11, s[36:39], s71 offen offset:3072 sc1
    v_exp_f32 v42, v42
    v_exp_f32 v43, v43
    v_exp_f32 v12, v12
    v_exp_f32 v13, v13
    v_smfmac_f32_32x32x32_bf16 v[60:75], v[100:103], v[36:43], v251
    ds_read_b128 v[100:103], v3 offset:21248
    v_mfma_f32_32x32x16_bf16 v[28:43], v[88:91], v[80:83], 0
    ds_read_b128 v[88:91], v1 offset:15360
    v_exp_f32 v14, v14
    v_exp_f32 v15, v15
    v_exp_f32 v16, v16
    v_mfma_f32_32x32x8bf16_1k v[28:43], v[92:93], v[86:87], v[28:43]
    s_add_u32 s71, s71, 0x1000
    buffer_load_dwordx4 v[184:187], v11, s[36:39], s71 offen offset:0 sc1
    v_exp_f32 v17, v17
    v_exp_f32 v18, v18
    v_exp_f32 v19, v19
    v_exp_f32 v20, v20
    v_exp_f32 v21, v21
    v_exp_f32 v22, v22
    v_exp_f32 v23, v23
    v_exp_f32 v24, v24
    s_waitcnt lgkmcnt(2)
    v_smfmac_f32_32x32x32_bf16 v[44:59], v[96:99], v[12:19], v251
    buffer_load_dwordx4 v[188:191], v11, s[36:39], s71 offen offset:1024 sc1
    v_exp_f32 v25, v25
    v_exp_f32 v26, v26
    v_exp_f32 v27, v27
    v_exp_f32 v28, v28
    v_exp_f32 v29, v29
    s_waitcnt lgkmcnt(1)
    v_smfmac_f32_32x32x32_bf16 v[44:59], v[100:103], v[20:27], v251
    s_waitcnt lgkmcnt(0)
    v_mfma_f32_32x32x16_bf16 v[12:27], v[88:91], v[76:79], 0
    v_exp_f32 v30, v30
    v_exp_f32 v31, v31
    v_exp_f32 v32, v32
    buffer_load_dwordx4 v[192:195], v11, s[36:39], s71 offen offset:2048 sc1
    v_mfma_f32_32x32x8bf16_1k v[12:27], v[94:95], v[84:85], v[12:27]
    v_exp_f32 v33, v33
    v_exp_f32 v34, v34
    v_exp_f32 v35, v35
    v_exp_f32 v36, v36
    v_exp_f32 v37, v37
    v_exp_f32 v38, v38
    v_exp_f32 v39, v39
    v_exp_f32 v40, v40
    v_smfmac_f32_32x32x32_bf16 v[60:75], v[96:99], v[28:35], v251
    ds_read_b128 v[96:99], v3 offset:22016
    buffer_load_dwordx4 v[196:199], v11, s[36:39], s71 offen offset:3072 sc1
    v_exp_f32 v41, v41
    v_exp_f32 v42, v42
    v_exp_f32 v43, v43
    v_exp_f32 v12, v12
    v_exp_f32 v13, v13
    v_smfmac_f32_32x32x32_bf16 v[60:75], v[100:103], v[36:43], v251
    ds_read_b128 v[100:103], v3 offset:22784
    v_mfma_f32_32x32x16_bf16 v[28:43], v[88:91], v[80:83], 0
    v_exp_f32 v14, v14
    v_exp_f32 v15, v15
    v_exp_f32 v16, v16
    v_mfma_f32_32x32x8bf16_1k v[28:43], v[94:95], v[86:87], v[28:43]
    v_exp_f32 v17, v17
    s_waitcnt vmcnt(12) lgkmcnt(0)
    s_barrier
    ds_read_b128 v[88:91], v1 offset:26624
    ds_read_b128 v[92:95], v2 offset:29184
    v_exp_f32 v18, v18
    v_exp_f32 v19, v19
    v_exp_f32 v20, v20
    v_exp_f32 v21, v21
    v_exp_f32 v22, v22
    v_exp_f32 v23, v23
    v_exp_f32 v24, v24
    v_smfmac_f32_32x32x32_bf16 v[44:59], v[96:99], v[12:19], v251
    v_exp_f32 v25, v25
    v_exp_f32 v26, v26
    v_exp_f32 v27, v27
    v_exp_f32 v28, v28
    v_exp_f32 v29, v29
    v_smfmac_f32_32x32x32_bf16 v[44:59], v[100:103], v[20:27], v251
    s_waitcnt lgkmcnt(1)
    v_mfma_f32_32x32x16_bf16 v[12:27], v[88:91], v[76:79], 0
    v_exp_f32 v30, v30
    v_exp_f32 v31, v31
    v_exp_f32 v32, v32
    s_waitcnt lgkmcnt(0)
    v_mfma_f32_32x32x8bf16_1k v[12:27], v[92:93], v[84:85], v[12:27]
    v_exp_f32 v33, v33
    s_add_u32 s71, s71, 0x1000
    buffer_load_dwordx4 v[200:203], v11, s[36:39], s71 offen offset:0 sc1
    v_exp_f32 v34, v34
    v_exp_f32 v35, v35
    v_exp_f32 v36, v36
    v_exp_f32 v37, v37
    v_exp_f32 v38, v38
    v_exp_f32 v39, v39
    v_exp_f32 v40, v40
    s_mul_i32 s48, s52, 6144
    v_add_u32 v10, s48, v1
    s_mul_i32 s48, s52, 5120
    v_add_u32 v9, s48, v1
    v_smfmac_f32_32x32x32_bf16 v[60:75], v[96:99], v[28:35], v251
    ds_read_b128 v[96:99], v3 offset:32768
    v_exp_f32 v41, v41
    buffer_load_dwordx4 v[204:207], v11, s[36:39], s71 offen offset:1024 sc1
    v_exp_f32 v42, v42
    v_exp_f32 v43, v43
    v_exp_f32 v12, v12
    v_exp_f32 v13, v13
    v_smfmac_f32_32x32x32_bf16 v[60:75], v[100:103], v[36:43], v251
    ds_read_b128 v[100:103], v3 offset:33536
    v_mfma_f32_32x32x16_bf16 v[28:43], v[88:91], v[80:83], 0
    ds_read_b128 v[88:91], v1 offset:27648
    s_xor_b32 s48, s52, 0
    s_mul_i32 s48, s48, 15360
    s_add_u32 s48, s48, 98816
    v_add_u32 v5, s48, v11
    v_exp_f32 v14, v14
    v_exp_f32 v15, v15
    v_exp_f32 v16, v16
    v_mfma_f32_32x32x8bf16_1k v[28:43], v[92:93], v[86:87], v[28:43]
    buffer_load_dwordx4 v[208:211], v11, s[36:39], s71 offen offset:2048 sc1
    v_exp_f32 v17, v17
    v_exp_f32 v18, v18
    v_exp_f32 v19, v19
    v_exp_f32 v20, v20
    v_exp_f32 v21, v21
    s_xor_b32 s48, s52, 1
    s_mul_i32 s48, s48, 15360
    s_add_u32 s48, s48, 98816
    v_add_u32 v6, s48, v11
    v_exp_f32 v22, v22
    v_exp_f32 v23, v23
    v_exp_f32 v24, v24
    s_waitcnt lgkmcnt(2)
    v_smfmac_f32_32x32x32_bf16 v[44:59], v[96:99], v[12:19], v251
    buffer_load_dwordx4 v[212:215], v11, s[36:39], s71 offen offset:3072 sc1
    v_exp_f32 v25, v25
    v_exp_f32 v26, v26
    v_exp_f32 v27, v27
    v_exp_f32 v28, v28
    s_xor_b32 s48, s52, 2
    s_mul_i32 s48, s48, 15360
    s_add_u32 s48, s48, 98816
    v_add_u32 v7, s48, v11
    v_exp_f32 v29, v29
    s_waitcnt lgkmcnt(1)
    v_smfmac_f32_32x32x32_bf16 v[44:59], v[100:103], v[20:27], v251
    s_waitcnt lgkmcnt(0)
    v_mfma_f32_32x32x16_bf16 v[12:27], v[88:91], v[76:79], 0
    v_exp_f32 v30, v30
    v_and_b32 v253, 0x3ff, v253
    buffer_load_dword v254, v253, s[36:39], s87 offen sc1
    v_exp_f32 v31, v31
    v_exp_f32 v32, v32
    s_add_u32 s71, s71, 0x1000
    buffer_load_dwordx4 v[216:219], v11, s[36:39], s71 offen offset:0 sc1
    v_mfma_f32_32x32x8bf16_1k v[12:27], v[94:95], v[84:85], v[12:27]
    v_exp_f32 v33, v33
    s_xor_b32 s48, s52, 3
    s_mul_i32 s48, s48, 15360
    s_add_u32 s48, s48, 98816
    v_add_u32 v8, s48, v11
    v_exp_f32 v34, v34
    v_exp_f32 v35, v35
    v_exp_f32 v36, v36
    v_exp_f32 v37, v37
    v_exp_f32 v38, v38
    v_exp_f32 v39, v39
    v_exp_f32 v40, v40
    v_smfmac_f32_32x32x32_bf16 v[60:75], v[96:99], v[28:35], v251
    ds_read_b128 v[96:99], v3 offset:34304
    buffer_load_dwordx4 v[220:223], v11, s[36:39], s71 offen offset:1024 sc1
    v_exp_f32 v41, v41
    v_exp_f32 v42, v42
    v_exp_f32 v43, v43
    v_exp_f32 v12, v12
    v_exp_f32 v13, v13
    v_smfmac_f32_32x32x32_bf16 v[60:75], v[100:103], v[36:43], v251
    ds_read_b128 v[100:103], v3 offset:35072
    v_mfma_f32_32x32x16_bf16 v[28:43], v[88:91], v[80:83], 0
    v_exp_f32 v14, v14
    v_exp_f32 v15, v15
    v_exp_f32 v16, v16
    v_mfma_f32_32x32x8bf16_1k v[28:43], v[94:95], v[86:87], v[28:43]
    v_exp_f32 v17, v17
    s_waitcnt lgkmcnt(0)
    s_barrier
    v_exp_f32 v18, v18
    v_exp_f32 v19, v19
    v_exp_f32 v20, v20
    v_exp_f32 v21, v21
    v_exp_f32 v22, v22
    v_exp_f32 v23, v23
    v_exp_f32 v24, v24
    v_smfmac_f32_32x32x32_bf16 v[44:59], v[96:99], v[12:19], v251
    v_exp_f32 v25, v25
    v_exp_f32 v26, v26
    v_exp_f32 v27, v27
    v_exp_f32 v28, v28
    v_exp_f32 v29, v29
    v_smfmac_f32_32x32x32_bf16 v[44:59], v[100:103], v[20:27], v251
    v_exp_f32 v30, v30
gated_mix__grouped_kv_mqa__mixer_gmlp__prompt_kernel_upoll:
    s_waitcnt vmcnt(2)
    v_cmp_ne_u32 vcc, s59, v254
    s_cbranch_vccnz gated_mix__grouped_kv_mqa__mixer_gmlp__prompt_kernel_uretry
gated_mix__grouped_kv_mqa__mixer_gmlp__prompt_kernel_uok:
    v_exp_f32 v31, v31
    v_exp_f32 v32, v32
    buffer_load_dwordx4 v[224:227], v11, s[36:39], s44 offen offset:0 sc1
    v_exp_f32 v33, v33
    v_exp_f32 v34, v34
    buffer_load_dwordx4 v[228:231], v11, s[36:39], s44 offen offset:1024 sc1
    v_exp_f32 v35, v35
    v_exp_f32 v36, v36
    buffer_load_dwordx4 v[232:235], v11, s[36:39], s44 offen offset:2048 sc1
    v_exp_f32 v37, v37
    v_exp_f32 v38, v38
    buffer_load_dwordx4 v[236:239], v11, s[36:39], s44 offen offset:3072 sc1
    v_exp_f32 v39, v39
    v_exp_f32 v40, v40
    buffer_load_dwordx4 v[240:243], v252, s[36:39], s44 offen offset:0 sc1
    v_smfmac_f32_32x32x32_bf16 v[60:75], v[96:99], v[28:35], v251
    v_exp_f32 v41, v41
    buffer_load_dwordx4 v[244:247], v252, s[36:39], s44 offen offset:1024 sc1
    v_exp_f32 v42, v42
    v_exp_f32 v43, v43
    s_nop 1
    v_smfmac_f32_32x32x32_bf16 v[60:75], v[100:103], v[36:43], v251
    ds_write_b128 v10, v[44:47] offset:0
    ds_write_b128 v10, v[48:51] offset:1024
    ds_write_b128 v10, v[52:55] offset:2048
    s_nop 8
    ds_write_b128 v10, v[60:63] offset:3072
    ds_write_b128 v10, v[64:67] offset:4096
    ds_write_b128 v10, v[68:71] offset:5120
    s_waitcnt lgkmcnt(0)
    s_barrier
    buffer_load_dwordx4 v[12:15], v11, s[36:39], s45 offen offset:0 sc1
    buffer_load_dwordx4 v[16:19], v11, s[36:39], s45 offen offset:1024 sc1
    buffer_load_dwordx4 v[20:23], v11, s[36:39], s45 offen offset:2048 sc1
    buffer_load_dwordx4 v[24:27], v11, s[36:39], s45 offen offset:3072 sc1
    buffer_load_dwordx4 v[28:31], v252, s[36:39], s45 offen offset:0 sc1
    buffer_load_dwordx4 v[32:35], v252, s[36:39], s45 offen offset:1024 sc1
    s_barrier
    s_waitcnt vmcnt(6)
    v_mfma_f32_16x16x32_bf16 v[84:87], v[104:107], v[224:227], 0
    v_mfma_f32_16x16x32_bf16 v[88:91], v[108:111], v[224:227], 0
    v_mfma_f32_16x16x32_bf16 v[92:95], v[112:115], v[224:227], 0
    v_mfma_f32_16x16x32_bf16 v[96:99], v[116:119], v[224:227], 0
    v_mfma_f32_16x16x32_bf16 v[100:103], v[120:123], v[224:227], 0
    v_mfma_f32_16x16x32_bf16 v[84:87], v[124:127], v[228:231], v[84:87]
    v_mfma_f32_16x16x32_bf16 v[88:91], v[128:131], v[228:231], v[88:91]
    v_mfma_f32_16x16x32_bf16 v[92:95], v[132:135], v[228:231], v[92:95]
    v_mfma_f32_16x16x32_bf16 v[96:99], v[136:139], v[228:231], v[96:99]
    v_mfma_f32_16x16x32_bf16 v[100:103], v[140:143], v[228:231], v[100:103]
    v_mfma_f32_16x16x32_bf16 v[84:87], v[144:147], v[232:235], v[84:87]
    v_mfma_f32_16x16x32_bf16 v[88:91], v[148:151], v[232:235], v[88:91]
    v_mfma_f32_16x16x32_bf16 v[92:95], v[152:155], v[232:235], v[92:95]
    v_mfma_f32_16x16x32_bf16 v[96:99], v[156:159], v[232:235], v[96:99]
    v_mfma_f32_16x16x32_bf16 v[100:103], v[160:163], v[232:235], v[100:103]
    v_mfma_f32_16x16x32_bf16 v[84:87], v[164:167], v[236:239], v[84:87]
    v_mfma_f32_16x16x32_bf16 v[88:91], v[168:171], v[236:239], v[88:91]
    v_mfma_f32_16x16x32_bf16 v[92:95], v[172:175], v[236:239], v[92:95]
    v_mfma_f32_16x16x32_bf16 v[96:99], v[176:179], v[236:239], v[96:99]
    v_mfma_f32_16x16x32_bf16 v[100:103], v[180:183], v[236:239], v[100:103]
    buffer_load_dwordx4 v[36:39], v11, s[36:39], s46 offen offset:0 sc1
    buffer_load_dwordx4 v[40:43], v11, s[36:39], s46 offen offset:1024 sc1
    buffer_load_dwordx4 v[44:47], v11, s[36:39], s46 offen offset:2048 sc1
    buffer_load_dwordx4 v[48:51], v11, s[36:39], s46 offen offset:3072 sc1
    buffer_load_dwordx4 v[52:55], v252, s[36:39], s46 offen offset:0 sc1
    buffer_load_dwordx4 v[56:59], v252, s[36:39], s46 offen offset:1024 sc1
    v_mfma_f32_16x16x32_bf16 v[84:87], v[184:187], v[240:243], v[84:87]
    v_mfma_f32_16x16x32_bf16 v[88:91], v[188:191], v[240:243], v[88:91]
    v_mfma_f32_16x16x32_bf16 v[92:95], v[192:195], v[240:243], v[92:95]
    v_mfma_f32_16x16x32_bf16 v[96:99], v[196:199], v[240:243], v[96:99]
    v_mfma_f32_16x16x32_bf16 v[100:103], v[200:203], v[240:243], v[100:103]
    v_mfma_f32_16x16x32_bf16 v[84:87], v[204:207], v[244:247], v[84:87]
    v_mfma_f32_16x16x32_bf16 v[88:91], v[208:211], v[244:247], v[88:91]
    v_mfma_f32_16x16x32_bf16 v[92:95], v[212:215], v[244:247], v[92:95]
    v_mfma_f32_16x16x32_bf16 v[96:99], v[216:219], v[244:247], v[96:99]
    v_mfma_f32_16x16x32_bf16 v[100:103], v[220:223], v[244:247], v[100:103]
    s_waitcnt vmcnt(6)
    v_mfma_f32_16x16x32_bf16 v[224:227], v[104:107], v[12:15], 0
    v_mfma_f32_16x16x32_bf16 v[228:231], v[108:111], v[12:15], 0
    v_mfma_f32_16x16x32_bf16 v[232:235], v[112:115], v[12:15], 0
    ds_write_b128 v5, v[84:87] offset:0
    v_mfma_f32_16x16x32_bf16 v[236:239], v[116:119], v[12:15], 0
    ds_write_b128 v5, v[88:91] offset:1024
    v_mfma_f32_16x16x32_bf16 v[240:243], v[120:123], v[12:15], 0
    ds_write_b128 v5, v[92:95] offset:2048
    v_mfma_f32_16x16x32_bf16 v[224:227], v[124:127], v[16:19], v[224:227]
    ds_write_b128 v5, v[96:99] offset:3072
    v_mfma_f32_16x16x32_bf16 v[228:231], v[128:131], v[16:19], v[228:231]
    ds_write_b128 v5, v[100:103] offset:4096
    v_mfma_f32_16x16x32_bf16 v[232:235], v[132:135], v[16:19], v[232:235]
    v_mfma_f32_16x16x32_bf16 v[236:239], v[136:139], v[16:19], v[236:239]
    v_mfma_f32_16x16x32_bf16 v[240:243], v[140:143], v[16:19], v[240:243]
    v_mfma_f32_16x16x32_bf16 v[224:227], v[144:147], v[20:23], v[224:227]
    v_mfma_f32_16x16x32_bf16 v[228:231], v[148:151], v[20:23], v[228:231]
    v_mfma_f32_16x16x32_bf16 v[232:235], v[152:155], v[20:23], v[232:235]
    v_mfma_f32_16x16x32_bf16 v[236:239], v[156:159], v[20:23], v[236:239]
    v_mfma_f32_16x16x32_bf16 v[240:243], v[160:163], v[20:23], v[240:243]
    buffer_load_dwordx4 v[60:63], v11, s[36:39], s47 offen offset:0 sc1
    buffer_load_dwordx4 v[64:67], v11, s[36:39], s47 offen offset:1024 sc1
    buffer_load_dwordx4 v[68:71], v11, s[36:39], s47 offen offset:2048 sc1
    buffer_load_dwordx4 v[72:75], v11, s[36:39], s47 offen offset:3072 sc1
    buffer_load_dwordx4 v[76:79], v252, s[36:39], s47 offen offset:0 sc1
    buffer_load_dwordx4 v[80:83], v252, s[36:39], s47 offen offset:1024 sc1
    v_mfma_f32_16x16x32_bf16 v[224:227], v[164:167], v[24:27], v[224:227]
    v_mfma_f32_16x16x32_bf16 v[228:231], v[168:171], v[24:27], v[228:231]
    v_mfma_f32_16x16x32_bf16 v[232:235], v[172:175], v[24:27], v[232:235]
    v_mfma_f32_16x16x32_bf16 v[236:239], v[176:179], v[24:27], v[236:239]
    v_mfma_f32_16x16x32_bf16 v[240:243], v[180:183], v[24:27], v[240:243]
    v_mfma_f32_16x16x32_bf16 v[224:227], v[184:187], v[28:31], v[224:227]
    v_mfma_f32_16x16x32_bf16 v[228:231], v[188:191], v[28:31], v[228:231]
    v_mfma_f32_16x16x32_bf16 v[232:235], v[192:195], v[28:31], v[232:235]
    v_mfma_f32_16x16x32_bf16 v[236:239], v[196:199], v[28:31], v[236:239]
    v_mfma_f32_16x16x32_bf16 v[240:243], v[200:203], v[28:31], v[240:243]
    v_mfma_f32_16x16x32_bf16 v[224:227], v[204:207], v[32:35], v[224:227]
    v_mfma_f32_16x16x32_bf16 v[228:231], v[208:211], v[32:35], v[228:231]
    v_mfma_f32_16x16x32_bf16 v[232:235], v[212:215], v[32:35], v[232:235]
    v_mfma_f32_16x16x32_bf16 v[236:239], v[216:219], v[32:35], v[236:239]
    v_mfma_f32_16x16x32_bf16 v[240:243], v[220:223], v[32:35], v[240:243]
    s_waitcnt vmcnt(6)
    v_mfma_f32_16x16x32_bf16 v[84:87], v[104:107], v[36:39], 0
    v_mfma_f32_16x16x32_bf16 v[88:91], v[108:111], v[36:39], 0
    v_mfma_f32_16x16x32_bf16 v[92:95], v[112:115], v[36:39], 0
    ds_write_b128 v5, v[224:227] offset:5120
    v_mfma_f32_16x16x32_bf16 v[96:99], v[116:119], v[36:39], 0
    ds_write_b128 v5, v[228:231] offset:6144
    v_mfma_f32_16x16x32_bf16 v[100:103], v[120:123], v[36:39], 0
    ds_write_b128 v5, v[232:235] offset:7168
    v_mfma_f32_16x16x32_bf16 v[84:87], v[124:127], v[40:43], v[84:87]
    ds_write_b128 v5, v[236:239] offset:8192
    v_mfma_f32_16x16x32_bf16 v[88:91], v[128:131], v[40:43], v[88:91]
    ds_write_b128 v5, v[240:243] offset:9216
    v_mfma_f32_16x16x32_bf16 v[92:95], v[132:135], v[40:43], v[92:95]
    v_mfma_f32_16x16x32_bf16 v[96:99], v[136:139], v[40:43], v[96:99]
    v_mfma_f32_16x16x32_bf16 v[100:103], v[140:143], v[40:43], v[100:103]
    s_barrier
    v_mfma_f32_16x16x32_bf16 v[84:87], v[144:147], v[44:47], v[84:87]
    v_mfma_f32_16x16x32_bf16 v[88:91], v[148:151], v[44:47], v[88:91]
    v_mfma_f32_16x16x32_bf16 v[92:95], v[152:155], v[44:47], v[92:95]
    v_mfma_f32_16x16x32_bf16 v[96:99], v[156:159], v[44:47], v[96:99]
    v_mfma_f32_16x16x32_bf16 v[100:103], v[160:163], v[44:47], v[100:103]
    v_mfma_f32_16x16x32_bf16 v[84:87], v[164:167], v[48:51], v[84:87]
    v_mfma_f32_16x16x32_bf16 v[88:91], v[168:171], v[48:51], v[88:91]
    v_mfma_f32_16x16x32_bf16 v[92:95], v[172:175], v[48:51], v[92:95]
    v_mfma_f32_16x16x32_bf16 v[96:99], v[176:179], v[48:51], v[96:99]
    v_mfma_f32_16x16x32_bf16 v[100:103], v[180:183], v[48:51], v[100:103]
    v_mfma_f32_16x16x32_bf16 v[84:87], v[184:187], v[52:55], v[84:87]
    v_mfma_f32_16x16x32_bf16 v[88:91], v[188:191], v[52:55], v[88:91]
    v_mfma_f32_16x16x32_bf16 v[92:95], v[192:195], v[52:55], v[92:95]
    v_mfma_f32_16x16x32_bf16 v[96:99], v[196:199], v[52:55], v[96:99]
    v_mfma_f32_16x16x32_bf16 v[100:103], v[200:203], v[52:55], v[100:103]
    v_mfma_f32_16x16x32_bf16 v[84:87], v[204:207], v[56:59], v[84:87]
    v_mfma_f32_16x16x32_bf16 v[88:91], v[208:211], v[56:59], v[88:91]
    v_mfma_f32_16x16x32_bf16 v[92:95], v[212:215], v[56:59], v[92:95]
    v_mfma_f32_16x16x32_bf16 v[96:99], v[216:219], v[56:59], v[96:99]
    v_mfma_f32_16x16x32_bf16 v[100:103], v[220:223], v[56:59], v[100:103]
    s_waitcnt vmcnt(0)
    v_mfma_f32_16x16x32_bf16 v[224:227], v[104:107], v[60:63], 0
    v_mfma_f32_16x16x32_bf16 v[228:231], v[108:111], v[60:63], 0
    v_mfma_f32_16x16x32_bf16 v[232:235], v[112:115], v[60:63], 0
    ds_write_b128 v5, v[84:87] offset:10240
    v_mfma_f32_16x16x32_bf16 v[236:239], v[116:119], v[60:63], 0
    ds_write_b128 v5, v[88:91] offset:11264
    v_mfma_f32_16x16x32_bf16 v[240:243], v[120:123], v[60:63], 0
    ds_write_b128 v5, v[92:95] offset:12288
    v_mfma_f32_16x16x32_bf16 v[224:227], v[124:127], v[64:67], v[224:227]
    ds_write_b128 v5, v[96:99] offset:13312
    v_mfma_f32_16x16x32_bf16 v[228:231], v[128:131], v[64:67], v[228:231]
    ds_write_b128 v5, v[100:103] offset:14336
    v_mfma_f32_16x16x32_bf16 v[232:235], v[132:135], v[64:67], v[232:235]
    v_mfma_f32_16x16x32_bf16 v[236:239], v[136:139], v[64:67], v[236:239]
    v_mfma_f32_16x16x32_bf16 v[240:243], v[140:143], v[64:67], v[240:243]
    s_waitcnt lgkmcnt(0)
    s_barrier
    v_mfma_f32_16x16x32_bf16 v[224:227], v[144:147], v[68:71], v[224:227]
    ds_read_b128 v[12:15], v6 offset:0
    v_mfma_f32_16x16x32_bf16 v[228:231], v[148:151], v[68:71], v[228:231]
    ds_read_b128 v[36:39], v7 offset:5120
    v_mfma_f32_16x16x32_bf16 v[232:235], v[152:155], v[68:71], v[232:235]
    ds_read_b128 v[84:87], v8 offset:10240
    v_mfma_f32_16x16x32_bf16 v[236:239], v[156:159], v[68:71], v[236:239]
    ds_read_b128 v[16:19], v6 offset:1024
    v_mfma_f32_16x16x32_bf16 v[240:243], v[160:163], v[68:71], v[240:243]
    ds_read_b128 v[40:43], v7 offset:6144
    v_mfma_f32_16x16x32_bf16 v[224:227], v[164:167], v[72:75], v[224:227]
    ds_read_b128 v[88:91], v8 offset:11264
    v_mfma_f32_16x16x32_bf16 v[228:231], v[168:171], v[72:75], v[228:231]
    ds_read_b128 v[20:23], v6 offset:2048
    v_mfma_f32_16x16x32_bf16 v[232:235], v[172:175], v[72:75], v[232:235]
    ds_read_b128 v[44:47], v7 offset:7168
    v_mfma_f32_16x16x32_bf16 v[236:239], v[176:179], v[72:75], v[236:239]
    ds_read_b128 v[92:95], v8 offset:12288
    v_mfma_f32_16x16x32_bf16 v[240:243], v[180:183], v[72:75], v[240:243]
    ds_read_b128 v[24:27], v6 offset:3072
    v_mfma_f32_16x16x32_bf16 v[224:227], v[184:187], v[76:79], v[224:227]
    ds_read_b128 v[48:51], v7 offset:8192
    v_mfma_f32_16x16x32_bf16 v[228:231], v[188:191], v[76:79], v[228:231]
    ds_read_b128 v[96:99], v8 offset:13312
    v_mfma_f32_16x16x32_bf16 v[232:235], v[192:195], v[76:79], v[232:235]
    ds_read_b128 v[28:31], v6 offset:4096
    v_mfma_f32_16x16x32_bf16 v[236:239], v[196:199], v[76:79], v[236:239]
    ds_read_b128 v[52:55], v7 offset:9216
    v_mfma_f32_16x16x32_bf16 v[240:243], v[200:203], v[76:79], v[240:243]
    ds_read_b128 v[100:103], v8 offset:14336
    v_mfma_f32_16x16x32_bf16 v[224:227], v[204:207], v[80:83], v[224:227]
    v_mfma_f32_16x16x32_bf16 v[228:231], v[208:211], v[80:83], v[228:231]
    v_mfma_f32_16x16x32_bf16 v[232:235], v[212:215], v[80:83], v[232:235]
    v_mfma_f32_16x16x32_bf16 v[236:239], v[216:219], v[80:83], v[236:239]
    v_mfma_f32_16x16x32_bf16 v[240:243], v[220:223], v[80:83], v[240:243]
    s_waitcnt lgkmcnt(12)
    v_add_f32 v12, v12, v36
    v_add_f32 v13, v13, v37
    v_add_f32 v14, v14, v38
    v_add_f32 v15, v15, v39
    v_add_f32 v12, v12, v84
    v_add_f32 v13, v13, v85
    v_add_f32 v14, v14, v86
    v_add_f32 v15, v15, v87
    v_add_f32 v224, v224, v12
    v_add_f32 v225, v225, v13
    v_add_f32 v226, v226, v14
    v_add_f32 v227, v227, v15
    ds_write_b128 v9, v[224:227] offset:0
    s_waitcnt lgkmcnt(10)
    v_add_f32 v16, v16, v40
    v_add_f32 v17, v17, v41
    v_add_f32 v18, v18, v42
    v_add_f32 v19, v19, v43
    v_add_f32 v16, v16, v88
    v_add_f32 v17, v17, v89
    v_add_f32 v18, v18, v90
    v_add_f32 v19, v19, v91
    v_add_f32 v228, v228, v16
    v_add_f32 v229, v229, v17
    v_add_f32 v230, v230, v18
    v_add_f32 v231, v231, v19
    ds_write_b128 v9, v[228:231] offset:1024
    s_waitcnt lgkmcnt(8)
    v_add_f32 v20, v20, v44
    v_add_f32 v21, v21, v45
    v_add_f32 v22, v22, v46
    v_add_f32 v23, v23, v47
    v_add_f32 v20, v20, v92
    v_add_f32 v21, v21, v93
    v_add_f32 v22, v22, v94
    v_add_f32 v23, v23, v95
    v_add_f32 v232, v232, v20
    v_add_f32 v233, v233, v21
    v_add_f32 v234, v234, v22
    v_add_f32 v235, v235, v23
    ds_write_b128 v9, v[232:235] offset:2048
    s_waitcnt lgkmcnt(6)
    v_add_f32 v24, v24, v48
    v_add_f32 v25, v25, v49
    v_add_f32 v26, v26, v50
    v_add_f32 v27, v27, v51
    v_add_f32 v24, v24, v96
    v_add_f32 v25, v25, v97
    v_add_f32 v26, v26, v98
    v_add_f32 v27, v27, v99
    v_add_f32 v236, v236, v24
    v_add_f32 v237, v237, v25
    v_add_f32 v238, v238, v26
    v_add_f32 v239, v239, v27
    ds_write_b128 v9, v[236:239] offset:3072
    s_waitcnt lgkmcnt(4)
    v_add_f32 v28, v28, v52
    v_add_f32 v29, v29, v53
    v_add_f32 v30, v30, v54
    v_add_f32 v31, v31, v55
    v_add_f32 v28, v28, v100
    v_add_f32 v29, v29, v101
    v_add_f32 v30, v30, v102
    v_add_f32 v31, v31, v103
    v_add_f32 v240, v240, v28
    v_add_f32 v241, v241, v29
    v_add_f32 v242, v242, v30
    v_add_f32 v243, v243, v31
    ds_write_b128 v9, v[240:243] offset:4096
    s_waitcnt lgkmcnt(0)
    s_barrier
    s_barrier
    s_barrier
    s_endpgm
gated_mix__grouped_kv_mqa__mixer_gmlp__prompt_kernel_kretry:
    s_cmp_eq_u32 s70, 0
    s_cbranch_scc1 gated_mix__grouped_kv_mqa__mixer_gmlp__prompt_kernel_kok
    s_sub_u32 s70, s70, 1
    buffer_load_dword v254, v253, s[36:39], s78 offen sc1
    s_waitcnt vmcnt(0)
    s_branch gated_mix__grouped_kv_mqa__mixer_gmlp__prompt_kernel_kpoll
gated_mix__grouped_kv_mqa__mixer_gmlp__prompt_kernel_lretry:
    s_cmp_eq_u32 s70, 0
    s_cbranch_scc1 gated_mix__grouped_kv_mqa__mixer_gmlp__prompt_kernel_lok
    s_sub_u32 s70, s70, 1
    buffer_load_dword v254, v253, s[36:39], s78 offen sc1
    s_waitcnt vmcnt(0)
    s_branch gated_mix__grouped_kv_mqa__mixer_gmlp__prompt_kernel_lpoll
gated_mix__grouped_kv_mqa__mixer_gmlp__prompt_kernel_wretry:
    s_cmp_eq_u32 s70, 0
    s_cbranch_scc1 gated_mix__grouped_kv_mqa__mixer_gmlp__prompt_kernel_wok
    s_sub_u32 s70, s70, 1
    buffer_load_dword v254, v253, s[36:39], s88 offen sc1
    s_waitcnt vmcnt(0)
    s_branch gated_mix__grouped_kv_mqa__mixer_gmlp__prompt_kernel_wpoll
gated_mix__grouped_kv_mqa__mixer_gmlp__prompt_kernel_uretry:
    s_cmp_eq_u32 s70, 0
    s_cbranch_scc1 gated_mix__grouped_kv_mqa__mixer_gmlp__prompt_kernel_uok
    s_sub_u32 s70, s70, 1
    buffer_load_dword v254, v253, s[36:39], s87 offen sc1
    s_waitcnt vmcnt(0)
    s_branch gated_mix__grouped_kv_mqa__mixer_gmlp__prompt_kernel_upoll
gated_mix__grouped_kv_mqa__mixer_gmlp__prompt_kernel_sretry:
    s_cmp_eq_u32 s70, 0
    s_cbranch_scc1 gated_mix__grouped_kv_mqa__mixer_gmlp__prompt_kernel_sok
    s_sub_u32 s70, s70, 1
    buffer_load_dwordx4 v[128:131], v11, s[36:39], s85 offen offset:0 sc1
    buffer_load_dwordx4 v[132:135], v11, s[36:39], s85 offen offset:1024 sc1
    buffer_load_dwordx4 v[160:163], v11, s[36:39], s85 offen offset:2048 sc1
    buffer_load_dwordx4 v[164:167], v11, s[36:39], s85 offen offset:3072 sc1
    s_waitcnt vmcnt(0)
    s_branch gated_mix__grouped_kv_mqa__mixer_gmlp__prompt_kernel_schk
gated_mix__grouped_kv_mqa__mixer_gmlp__prompt_kernel_A:
    v_lshlrev_b32 v195, 4, v0
    s_setprio 1
    s_and_b32 s53, s34, 1
    s_bfe_u32 s54, s34, 0x10001
    s_xor_b32 s58, s52, s33
    s_and_b32 s58, s58, 3
    s_xor_b32 s48, s58, 1
    s_lshl_b32 s49, s32, 2
    s_add_u32 s48, s48, s49
    s_mul_i32 s44, s48, 45056
    s_xor_b32 s48, s58, 2
    s_lshl_b32 s49, s32, 2
    s_add_u32 s48, s48, s49
    s_mul_i32 s45, s48, 45056
    s_xor_b32 s48, s58, 3
    s_lshl_b32 s49, s32, 2
    s_add_u32 s48, s48, s49
    s_mul_i32 s46, s48, 45056
    s_xor_b32 s48, s58, 0
    s_lshl_b32 s49, s32, 2
    s_add_u32 s48, s48, s49
    s_mul_i32 s47, s48, 45056
    v_lshlrev_b32 v1, 4, v0
    v_and_b32 v16, 31, v0
    v_lshrrev_b32 v17, 5, v0
    v_lshlrev_b32 v2, 4, v16
    v_min_u32 v3, 23, v16
    v_mul_u32_u24 v17, 0x180, v17
    v_lshl_add_u32 v3, v3, 4, v17
    v_add_u32 v1, 74240, v1
    v_add_u32 v2, 74240, v2
    v_add_u32 v3, 74240, v3
    v_mov_b32 v12, v195
    s_mul_i32 s68, s52, 18432
    s_lshl_b32 s48, s32, 1
    s_add_u32 s48, s48, s53
    s_lshl_b32 s49, s52, 10
    s_lshl_b32 s69, s48, 17
    s_add_u32 s69, s69, s49
    s_xor_b32 s70, s69, 0x20000
    s_mul_i32 s71, s33, 2
    s_add_u32 s71, s71, s32
    s_and_b32 s71, s71, 7
    s_lshl_b32 s71, s71, 7
    s_mov_b32 s74, s71
    s_mul_i32 s78, s48, 90112
    s_add_u32 s78, s78, 0xbd0000
    s_lshl_b32 s48, s33, 2
    s_add_u32 s48, s48, s52
    s_mul_i32 s73, s48, 98304
    s_add_u32 s73, s73, 0x8d0000
    s_lshl_b32 s76, s48, 12
    v_lshrrev_b32 v16, 3, v0
    v_lshlrev_b32 v16, 12, v16
    v_lshrrev_b32 v17, 4, v0
    v_and_b32 v18, 7, v0
    v_xor_b32 v17, v17, v18
    v_lshl_add_u32 v9, v17, 4, v16
    v_xor_b32 v17, 64, v9
    v_add_u32 v10, 31744, v17
    v_add_u32 v11, 63488, v9
    v_add_u32 v252, 95232, v17
    v_lshrrev_b32 v16, 5, v0
    v_bfe_u32 v17, v0, 1, 3
    v_xor_b32 v17, v17, v16
    v_lshlrev_b32 v17, 4, v17
    v_and_b32 v18, 31, v0
    v_lshl_add_u32 v17, v18, 7, v17
    v_lshlrev_b32 v253, 7, v18
    s_lshl_b32 s48, s54, 7
    v_xor_b32 v8, s48, v12
    s_mov_b32 s77, 0x8000
    v_xor_b32 v4, 0x0, v17
    v_add_u32 v4, s68, v4
    v_xor_b32 v5, 0x20, v17
    v_add_u32 v5, s68, v5
    v_xor_b32 v6, 0x40, v17
    v_add_u32 v6, s68, v6
    v_xor_b32 v7, 0x60, v17
    v_add_u32 v7, s68, v7
    s_lshr_b32 s48, s33, 1
    s_mul_i32 s48, s48, 5120
    s_add_u32 s79, s78, s48
    s_and_b32 s48, s33, 1
    s_lshl_b32 s48, s48, 1
    s_add_u32 s48, s48, s54
    s_lshl_b32 s49, s48, 8
    s_add_u32 s80, s79, s49
    s_add_u32 s80, s80, 4096
    s_lshl_b32 s48, s48, 10
    s_add_u32 s79, s79, s48
    s_mul_i32 s48, s33, 3072
    s_add_u32 s78, s78, s48
    s_lshl_b32 s48, s54, 9
    s_add_u32 s78, s78, s48
    s_add_u32 s78, s78, 20480
    s_lshl_b32 s48, s32, 2
    s_add_u32 s48, s48, s52
    s_mul_i32 s78, s48, 45056
    s_mul_i32 s48, s33, 3072
    s_add_u32 s78, s78, s48
    s_add_u32 s78, s78, 0xbd5000
    s_mul_i32 s48, s52, 5120
    s_add_u32 s48, s48, 0xbd0000
    s_add_u32 s44, s44, s48
    s_add_u32 s45, s45, s48
    s_add_u32 s46, s46, s48
    s_add_u32 s47, s47, s48
    v_lshrrev_b32 v13, 5, v0
    v_bfe_u32 v14, v0, 2, 2
    v_and_b32 v16, 31, v0
    v_bfe_u32 v15, v0, 4, 1
    v_and_b32 v17, 3, v0
    v_lshlrev_b32 v17, 3, v17
    v_lshl_add_u32 v15, v15, 5, v17
    v_lshl_add_u32 v18, v13, 3, v14
    s_mul_i32 s48, s54, 96
    v_mul_u32_u24 v92, 192, v18
    v_add3_u32 v92, v92, v15, s48
    v_mad_u32_u24 v19, v18, 40, v17
    v_add_u32 v18, v18, v14
    s_mul_i32 s48, s54, 40
    v_mul_u32_u24 v94, 160, v18
    v_add3_u32 v94, v94, v15, s48
    v_add_u32 v93, 0x8000, v92
    v_lshlrev_b32 v98, 4, v13
    v_add_u32 v98, 156160, v98
    s_lshl_b32 s48, s53, 12
    s_add_u32 s48, s48, 74240
    s_sub_u32 s48, s48, s68
    s_mov_b32 s82, 0x100000
    s_mov_b32 s83, 0x100000
    v_mov_b64 v[84:85], 0
    v_mov_b64 v[86:87], 0
    v_add_u32 v88, s48, v4
    v_add_u32 v72, 0x10000, v88
    v_add_u32 v89, s48, v5
    v_add_u32 v73, 0x10000, v89
    v_add_u32 v90, s48, v6
    v_add_u32 v74, 0x10000, v90
    v_add_u32 v91, s48, v7
    v_add_u32 v75, 0x10000, v91
    s_cmp_lt_u32 s33, 2
    s_cselect_b32 vcc_lo, 0xffff0000, 0
    s_mov_b32 vcc_hi, vcc_lo
    s_lshl_b32 s48, s54, 5
    v_add_u32 v19, s48, v19
    v_add_u32 v20, 64, v92
    v_add_u32 v21, 12288, v19
    v_cndmask_b32 v44, v20, v21, vcc
    v_add_u32 v20, 832, v92
    v_add_u32 v21, 12448, v19
    v_cndmask_b32 v45, v20, v21, vcc
    v_add_u32 v20, 3136, v92
    v_add_u32 v21, 12928, v19
    v_cndmask_b32 v46, v20, v21, vcc
    v_add_u32 v20, 3904, v92
    v_add_u32 v21, 13088, v19
    v_cndmask_b32 v47, v20, v21, vcc
    v_add_u32 v20, 6208, v92
    v_add_u32 v21, 13568, v19
    v_cndmask_b32 v48, v20, v21, vcc
    v_add_u32 v20, 6976, v92
    v_add_u32 v21, 13728, v19
    v_cndmask_b32 v49, v20, v21, vcc
    v_add_u32 v20, 9280, v92
    v_add_u32 v21, 14208, v19
    v_cndmask_b32 v50, v20, v21, vcc
    v_add_u32 v20, 10048, v92
    v_add_u32 v21, 14368, v19
    v_cndmask_b32 v51, v20, v21, vcc
    s_lshl_b32 s48, s52, 10
    s_add_u32 s48, s48, 159488
    v_lshl_add_u32 v192, v16, 5, s48
    v_lshl_add_u32 v192, v13, 4, v192
    s_lshl_b32 s48, s52, 12
    s_add_u32 s48, s48, 127488
    v_add_u32 v197, s48, v195
    s_mul_i32 s48, s52, 3072
    v_add_u32 v99, s48, v195
    v_add_u32 v193, 61952, v99
    v_add_u32 v99, 115200, v99
    s_lshl_b32 s48, s32, 3
    s_add_u32 s48, s48, s33
    s_lshl_b32 s48, s48, 2
    s_add_u32 s48, s48, s52
    s_lshl_b32 s48, s48, 7
    s_add_u32 s84, s48, 0x40000
    s_cmp_eq_u32 s33, 0
    s_cselect_b32 s86, 0x3ea52b5c, 1.0
    s_waitcnt lgkmcnt(0)
    v_lshrrev_b32 v30, 5, v0
    s_lshl_b32 s49, s52, 10
    s_lshl_b32 s48, s32, 1
    s_add_u32 s48, s48, s54
    s_lshl_b32 s48, s48, 17
    s_add_u32 s69, s48, s49
    s_xor_b32 s70, s69, 0x20000
    s_lshl_b32 s48, s53, 11
    v_mul_u32_u24 v8, 0xc00, v30
    v_lshrrev_b32 v30, 4, v0
    v_bfe_u32 v31, v0, 1, 3
    v_and_b32 v32, 15, v0
    v_xor_b32 v31, v31, v30
    v_and_b32 v30, 1, v30
    v_lshl_add_u32 v31, v31, 4, s48
    v_lshl_add_u32 v8, v30, 9, v8
    v_lshl_add_u32 v31, v32, 7, v31
    v_lshl_add_u32 v8, v32, 4, v8
    v_xor_b32 v4, 0x0, v31
    v_add_u32 v4, s68, v4
    v_xor_b32 v5, 0x40, v31
    v_add_u32 v5, s68, v5
    v_xor_b32 v6, 0x800, v31
    v_add_u32 v6, s68, v6
    v_xor_b32 v7, 0x840, v31
    v_add_u32 v7, s68, v7
    s_mov_b32 s36, s30
    s_mov_b32 s37, s31
    s_mov_b32 s38, 0x135c000
    s_mov_b32 s39, 0x20000
    s_mov_b32 s60, s18
    s_mov_b32 s61, s19
    s_mov_b32 s62, 0x800000
    s_mov_b32 s63, 0x20000
    s_mov_b32 s64, s20
    s_mov_b32 s65, s21
    s_mov_b32 s66, 0x1000
    s_mov_b32 s67, 0x20000
    s_mov_b32 s48, 0x135b000
    buffer_load_dword v162, off, s[36:39], s48
    s_barrier
    ds_read_b128 v[60:63], v88 offset:24576
    ds_read_b64_tr_b16 v[208:209], v92 offset:0
    ds_read_b64_tr_b16 v[210:211], v92 offset:768
    ds_read_b64_tr_b16 v[212:213], v44 offset:0
    ds_read_b64_tr_b16 v[214:215], v45 offset:0
    ds_read_b128 v[64:67], v89 offset:24576
    ds_read_b64_tr_b16 v[220:221], v92 offset:3072
    ds_read_b64_tr_b16 v[222:223], v92 offset:3840
    ds_read_b64_tr_b16 v[224:225], v46 offset:0
    ds_read_b64_tr_b16 v[226:227], v47 offset:0
    s_waitcnt lgkmcnt(7)
    v_mfma_f32_32x32x16_bf16 v[104:119], v[208:211], v[60:63], 0
    ds_read_b128 v[68:71], v90 offset:24576
    ds_read_b64_tr_b16 v[232:233], v92 offset:6144
    ds_read_b64_tr_b16 v[234:235], v92 offset:6912
    s_waitcnt lgkmcnt(8)
    v_mfma_f32_32x32x16_bf16 v[120:135], v[212:215], v[60:63], 0
    ds_read_b64_tr_b16 v[236:237], v48 offset:0
    ds_read_b64_tr_b16 v[238:239], v49 offset:0
    s_waitcnt lgkmcnt(7)
    v_mfma_f32_32x32x16_bf16 v[104:119], v[220:223], v[64:67], v[104:119]
    ds_read_b128 v[60:63], v91 offset:24576
    ds_read_b64_tr_b16 v[208:209], v92 offset:9216
    ds_read_b64_tr_b16 v[210:211], v92 offset:9984
    s_waitcnt lgkmcnt(8)
    v_mfma_f32_32x32x16_bf16 v[120:135], v[224:227], v[64:67], v[120:135]
    ds_read_b64_tr_b16 v[212:213], v50 offset:0
    ds_read_b64_tr_b16 v[214:215], v51 offset:0
    s_waitcnt lgkmcnt(7)
    v_mfma_f32_32x32x16_bf16 v[104:119], v[232:235], v[68:71], v[104:119]
    s_waitcnt lgkmcnt(5)
    v_mfma_f32_32x32x16_bf16 v[120:135], v[236:239], v[68:71], v[120:135]
    s_waitcnt lgkmcnt(0)
    s_barrier
    ds_read_b128 v[64:67], v88 offset:32768
    ds_read_b64_tr_b16 v[220:221], v92 offset:14848
    ds_read_b64_tr_b16 v[222:223], v92 offset:15616
    ds_read_b64_tr_b16 v[224:225], v44 offset:14848
    ds_read_b64_tr_b16 v[226:227], v45 offset:14848
    s_mov_b32 vcc_lo, 0xcccc0000
    s_mov_b32 vcc_hi, 0xcccc0000
    v_mfma_f32_32x32x16_bf16 v[104:119], v[208:211], v[60:63], v[104:119]
    ds_read_b128 v[68:71], v89 offset:32768
    ds_read_b64_tr_b16 v[232:233], v92 offset:17920
    ds_read_b64_tr_b16 v[234:235], v92 offset:18688
    v_add_u32 v20, 16, v92
    v_add_u32 v21, 3072, v94
    v_cndmask_b32 v52, v21, v20, vcc
    v_add_u32 v56, 0x8000, v52
    v_mfma_f32_32x32x16_bf16 v[120:135], v[212:215], v[60:63], v[120:135]
    ds_read_b64_tr_b16 v[236:237], v46 offset:14848
    ds_read_b64_tr_b16 v[238:239], v47 offset:14848
    s_waitcnt lgkmcnt(7)
    v_mfma_f32_32x32x16_bf16 v[104:119], v[220:223], v[64:67], v[104:119]
    ds_read_b128 v[60:63], v90 offset:32768
    v_add_u32 v20, 784, v92
    v_add_u32 v21, 3232, v94
    v_cndmask_b32 v53, v21, v20, vcc
    v_add_u32 v57, 0x8000, v53
    ds_read_b64_tr_b16 v[208:209], v92 offset:20992
    ds_read_b64_tr_b16 v[210:211], v92 offset:21760
    s_waitcnt lgkmcnt(8)
    v_mfma_f32_32x32x16_bf16 v[120:135], v[224:227], v[64:67], v[120:135]
    ds_read_b64_tr_b16 v[212:213], v48 offset:14848
    ds_read_b64_tr_b16 v[214:215], v49 offset:14848
    v_add_u32 v20, 32, v92
    v_add_u32 v21, 3152, v94
    v_cndmask_b32 v54, v21, v20, vcc
    v_add_u32 v58, 0x8000, v54
    s_waitcnt lgkmcnt(7)
    v_mfma_f32_32x32x16_bf16 v[104:119], v[232:235], v[68:71], v[104:119]
    ds_read_b128 v[64:67], v91 offset:32768
    ds_read_b64_tr_b16 v[220:221], v92 offset:24064
    ds_read_b64_tr_b16 v[222:223], v92 offset:24832
    v_add_u32 v20, 800, v92
    v_add_u32 v21, 3312, v94
    v_cndmask_b32 v55, v21, v20, vcc
    v_add_u32 v59, 0x8000, v55
    s_waitcnt lgkmcnt(8)
    v_mfma_f32_32x32x16_bf16 v[120:135], v[236:239], v[68:71], v[120:135]
    ds_read_b64_tr_b16 v[224:225], v50 offset:14848
    ds_read_b64_tr_b16 v[226:227], v51 offset:14848
    s_waitcnt lgkmcnt(7)
    v_mfma_f32_32x32x16_bf16 v[104:119], v[208:211], v[60:63], v[104:119]
    s_waitcnt lgkmcnt(5)
    v_mfma_f32_32x32x16_bf16 v[120:135], v[212:215], v[60:63], v[120:135]
    s_waitcnt lgkmcnt(0)
    s_barrier
    ds_read_b128 v[68:71], v88 offset:0
    ds_read_b64_tr_b16 v[232:233], v92 offset:29696
    ds_read_b64_tr_b16 v[234:235], v92 offset:30464
    ds_read_b64_tr_b16 v[236:237], v44 offset:29696
    ds_read_b64_tr_b16 v[238:239], v45 offset:29696
    v_mfma_f32_32x32x16_bf16 v[104:119], v[220:223], v[64:67], v[104:119]
    ds_read_b128 v[60:63], v89 offset:0
    ds_read_b64_tr_b16 v[208:209], v92 offset:32768
    ds_read_b64_tr_b16 v[210:211], v92 offset:33536
    v_mfma_f32_32x32x16_bf16 v[120:135], v[224:227], v[64:67], v[120:135]
    ds_read_b64_tr_b16 v[212:213], v46 offset:29696
    ds_read_b64_tr_b16 v[214:215], v47 offset:29696
    s_waitcnt lgkmcnt(7)
    v_mfma_f32_32x32x16_bf16 v[104:119], v[232:235], v[68:71], v[104:119]
    ds_read_b128 v[64:67], v90 offset:0
    ds_read_b64_tr_b16 v[220:221], v92 offset:35840
    ds_read_b64_tr_b16 v[222:223], v92 offset:36608
    s_waitcnt lgkmcnt(8)
    v_mfma_f32_32x32x16_bf16 v[120:135], v[236:239], v[68:71], v[120:135]
    ds_read_b64_tr_b16 v[224:225], v48 offset:29696
    ds_read_b64_tr_b16 v[226:227], v49 offset:29696
    s_waitcnt lgkmcnt(7)
    v_mfma_f32_32x32x16_bf16 v[104:119], v[208:211], v[60:63], v[104:119]
    ds_read_b128 v[68:71], v91 offset:0
    ds_read_b64_tr_b16 v[232:233], v92 offset:38912
    ds_read_b64_tr_b16 v[234:235], v92 offset:39680
    s_waitcnt lgkmcnt(8)
    v_mfma_f32_32x32x16_bf16 v[120:135], v[212:215], v[60:63], v[120:135]
    ds_read_b64_tr_b16 v[236:237], v50 offset:29696
    ds_read_b64_tr_b16 v[238:239], v51 offset:29696
    s_waitcnt lgkmcnt(7)
    v_mfma_f32_32x32x16_bf16 v[104:119], v[220:223], v[64:67], v[104:119]
    s_waitcnt lgkmcnt(5)
    v_mfma_f32_32x32x16_bf16 v[120:135], v[224:227], v[64:67], v[120:135]
    s_waitcnt lgkmcnt(0)
    s_barrier
    ds_read_b128 v[60:63], v88 offset:8192
    ds_read_b64_tr_b16 v[208:209], v93 offset:11776
    ds_read_b64_tr_b16 v[210:211], v93 offset:12544
    ds_read_b64_tr_b16 v[212:213], v44 offset:44544
    ds_read_b64_tr_b16 v[214:215], v45 offset:44544
    v_mfma_f32_32x32x16_bf16 v[104:119], v[232:235], v[68:71], v[104:119]
    ds_read_b128 v[64:67], v89 offset:8192
    ds_read_b64_tr_b16 v[220:221], v93 offset:14848
    ds_read_b64_tr_b16 v[222:223], v93 offset:15616
    v_mfma_f32_32x32x16_bf16 v[120:135], v[236:239], v[68:71], v[120:135]
    ds_read_b64_tr_b16 v[224:225], v46 offset:44544
    ds_read_b64_tr_b16 v[226:227], v47 offset:44544
    s_waitcnt lgkmcnt(7)
    v_mfma_f32_32x32x16_bf16 v[104:119], v[208:211], v[60:63], v[104:119]
    ds_read_b128 v[68:71], v90 offset:8192
    ds_read_b64_tr_b16 v[232:233], v93 offset:17920
    ds_read_b64_tr_b16 v[234:235], v93 offset:18688
    s_waitcnt lgkmcnt(8)
    v_mfma_f32_32x32x16_bf16 v[120:135], v[212:215], v[60:63], v[120:135]
    ds_read_b64_tr_b16 v[236:237], v48 offset:44544
    ds_read_b64_tr_b16 v[238:239], v49 offset:44544
    s_waitcnt lgkmcnt(7)
    v_mfma_f32_32x32x16_bf16 v[104:119], v[220:223], v[64:67], v[104:119]
    ds_read_b128 v[60:63], v91 offset:8192
    ds_read_b64_tr_b16 v[208:209], v93 offset:20992
    ds_read_b64_tr_b16 v[210:211], v93 offset:21760
    s_waitcnt lgkmcnt(8)
    v_mfma_f32_32x32x16_bf16 v[120:135], v[224:227], v[64:67], v[120:135]
    ds_read_b64_tr_b16 v[212:213], v50 offset:44544
    ds_read_b64_tr_b16 v[214:215], v51 offset:44544
    s_waitcnt lgkmcnt(7)
    v_mfma_f32_32x32x16_bf16 v[104:119], v[232:235], v[68:71], v[104:119]
    s_waitcnt lgkmcnt(5)
    v_mfma_f32_32x32x16_bf16 v[120:135], v[236:239], v[68:71], v[120:135]
    s_waitcnt lgkmcnt(0)
    s_barrier
    ds_read_b128 v[64:67], v88 offset:16384
    ds_read_b64_tr_b16 v[220:221], v93 offset:26624
    ds_read_b64_tr_b16 v[222:223], v93 offset:27392
    ds_read_b64_tr_b16 v[224:225], v44 offset:59392
    ds_read_b64_tr_b16 v[226:227], v45 offset:59392
    v_mfma_f32_32x32x16_bf16 v[104:119], v[208:211], v[60:63], v[104:119]
    ds_read_b128 v[68:71], v89 offset:16384
    ds_read_b64_tr_b16 v[232:233], v93 offset:29696
    ds_read_b64_tr_b16 v[234:235], v93 offset:30464
    v_mfma_f32_32x32x16_bf16 v[120:135], v[212:215], v[60:63], v[120:135]
    ds_read_b64_tr_b16 v[236:237], v46 offset:59392
    ds_read_b64_tr_b16 v[238:239], v47 offset:59392
    s_waitcnt lgkmcnt(7)
    v_mfma_f32_32x32x16_bf16 v[104:119], v[220:223], v[64:67], v[104:119]
    ds_read_b128 v[60:63], v90 offset:16384
    ds_read_b64_tr_b16 v[208:209], v93 offset:32768
    ds_read_b64_tr_b16 v[210:211], v93 offset:33536
    s_waitcnt lgkmcnt(8)
    v_mfma_f32_32x32x16_bf16 v[120:135], v[224:227], v[64:67], v[120:135]
    ds_read_b64_tr_b16 v[212:213], v48 offset:59392
    ds_read_b64_tr_b16 v[214:215], v49 offset:59392
    s_waitcnt lgkmcnt(7)
    v_mfma_f32_32x32x16_bf16 v[104:119], v[232:235], v[68:71], v[104:119]
    ds_read_b128 v[64:67], v91 offset:16384
    ds_read_b64_tr_b16 v[220:221], v93 offset:35840
    ds_read_b64_tr_b16 v[222:223], v93 offset:36608
    s_waitcnt lgkmcnt(8)
    v_mfma_f32_32x32x16_bf16 v[120:135], v[236:239], v[68:71], v[120:135]
    ds_read_b64_tr_b16 v[224:225], v50 offset:59392
    ds_read_b64_tr_b16 v[226:227], v51 offset:59392
    s_waitcnt lgkmcnt(7)
    v_mfma_f32_32x32x16_bf16 v[104:119], v[208:211], v[60:63], v[104:119]
    s_waitcnt lgkmcnt(5)
    v_mfma_f32_32x32x16_bf16 v[120:135], v[212:215], v[60:63], v[120:135]
    s_waitcnt lgkmcnt(0)
    s_barrier
    ds_read_b128 v[68:71], v88 offset:40960
    ds_read_b64_tr_b16 v[232:233], v92 offset:0
    ds_read_b64_tr_b16 v[234:235], v92 offset:768
    ds_read_b64_tr_b16 v[236:237], v44 offset:0
    ds_read_b64_tr_b16 v[238:239], v45 offset:0
    v_mfma_f32_32x32x16_bf16 v[104:119], v[220:223], v[64:67], v[104:119]
    ds_read_b128 v[60:63], v89 offset:40960
    ds_read_b64_tr_b16 v[208:209], v92 offset:3072
    ds_read_b64_tr_b16 v[210:211], v92 offset:3840
    v_mfma_f32_32x32x16_bf16 v[120:135], v[224:227], v[64:67], v[120:135]
    ds_read_b64_tr_b16 v[212:213], v46 offset:0
    ds_read_b64_tr_b16 v[214:215], v47 offset:0
    s_waitcnt lgkmcnt(7)
    v_mfma_f32_32x32x16_bf16 v[104:119], v[232:235], v[68:71], v[104:119]
    ds_read_b128 v[64:67], v90 offset:40960
    ds_read_b64_tr_b16 v[220:221], v92 offset:6144
    ds_read_b64_tr_b16 v[222:223], v92 offset:6912
    s_waitcnt lgkmcnt(8)
    v_mfma_f32_32x32x16_bf16 v[120:135], v[236:239], v[68:71], v[120:135]
    ds_read_b64_tr_b16 v[224:225], v48 offset:0
    ds_read_b64_tr_b16 v[226:227], v49 offset:0
    s_waitcnt lgkmcnt(7)
    v_mfma_f32_32x32x16_bf16 v[104:119], v[208:211], v[60:63], v[104:119]
    ds_read_b128 v[68:71], v91 offset:40960
    ds_read_b64_tr_b16 v[232:233], v92 offset:9216
    ds_read_b64_tr_b16 v[234:235], v92 offset:9984
    s_waitcnt lgkmcnt(8)
    v_mfma_f32_32x32x16_bf16 v[120:135], v[212:215], v[60:63], v[120:135]
    ds_read_b64_tr_b16 v[236:237], v50 offset:0
    ds_read_b64_tr_b16 v[238:239], v51 offset:0
    s_waitcnt lgkmcnt(7)
    v_mfma_f32_32x32x16_bf16 v[104:119], v[220:223], v[64:67], v[104:119]
    s_waitcnt lgkmcnt(5)
    v_mfma_f32_32x32x16_bf16 v[120:135], v[224:227], v[64:67], v[120:135]
    s_waitcnt lgkmcnt(0)
    s_barrier
    ds_read_b128 v[60:63], v88 offset:49152
    ds_read_b64_tr_b16 v[208:209], v92 offset:14848
    ds_read_b64_tr_b16 v[210:211], v92 offset:15616
    ds_read_b64_tr_b16 v[212:213], v44 offset:14848
    ds_read_b64_tr_b16 v[214:215], v45 offset:14848
    v_mfma_f32_32x32x16_bf16 v[104:119], v[232:235], v[68:71], v[104:119]
    ds_read_b128 v[64:67], v89 offset:49152
    ds_read_b64_tr_b16 v[220:221], v92 offset:17920
    ds_read_b64_tr_b16 v[222:223], v92 offset:18688
    v_mfma_f32_32x32x16_bf16 v[120:135], v[236:239], v[68:71], v[120:135]
    ds_read_b64_tr_b16 v[224:225], v46 offset:14848
    ds_read_b64_tr_b16 v[226:227], v47 offset:14848
    s_waitcnt lgkmcnt(7)
    v_mfma_f32_32x32x16_bf16 v[104:119], v[208:211], v[60:63], v[104:119]
    ds_read_b128 v[68:71], v90 offset:49152
    ds_read_b64_tr_b16 v[232:233], v92 offset:20992
    ds_read_b64_tr_b16 v[234:235], v92 offset:21760
    s_waitcnt lgkmcnt(8)
    v_mfma_f32_32x32x16_bf16 v[120:135], v[212:215], v[60:63], v[120:135]
    ds_read_b64_tr_b16 v[236:237], v48 offset:14848
    ds_read_b64_tr_b16 v[238:239], v49 offset:14848
    s_waitcnt lgkmcnt(7)
    v_mfma_f32_32x32x16_bf16 v[104:119], v[220:223], v[64:67], v[104:119]
    ds_read_b128 v[60:63], v91 offset:49152
    ds_read_b64_tr_b16 v[208:209], v92 offset:24064
    ds_read_b64_tr_b16 v[210:211], v92 offset:24832
    s_waitcnt lgkmcnt(8)
    v_mfma_f32_32x32x16_bf16 v[120:135], v[224:227], v[64:67], v[120:135]
    ds_read_b64_tr_b16 v[212:213], v50 offset:14848
    ds_read_b64_tr_b16 v[214:215], v51 offset:14848
    s_waitcnt lgkmcnt(7)
    v_mfma_f32_32x32x16_bf16 v[104:119], v[232:235], v[68:71], v[104:119]
    s_waitcnt lgkmcnt(5)
    v_mfma_f32_32x32x16_bf16 v[120:135], v[236:239], v[68:71], v[120:135]
    s_waitcnt lgkmcnt(0)
    s_barrier
    ds_read_b128 v[64:67], v88 offset:57344
    ds_read_b64_tr_b16 v[220:221], v92 offset:29696
    ds_read_b64_tr_b16 v[222:223], v92 offset:30464
    ds_read_b64_tr_b16 v[224:225], v44 offset:29696
    ds_read_b64_tr_b16 v[226:227], v45 offset:29696
    v_mfma_f32_32x32x16_bf16 v[104:119], v[208:211], v[60:63], v[104:119]
    ds_read_b128 v[68:71], v89 offset:57344
    ds_read_b64_tr_b16 v[232:233], v92 offset:32768
    ds_read_b64_tr_b16 v[234:235], v92 offset:33536
    v_mfma_f32_32x32x16_bf16 v[120:135], v[212:215], v[60:63], v[120:135]
    ds_read_b64_tr_b16 v[236:237], v46 offset:29696
    ds_read_b64_tr_b16 v[238:239], v47 offset:29696
    s_waitcnt lgkmcnt(7)
    v_mfma_f32_32x32x16_bf16 v[104:119], v[220:223], v[64:67], v[104:119]
    ds_read_b128 v[60:63], v90 offset:57344
    ds_read_b64_tr_b16 v[208:209], v92 offset:35840
    ds_read_b64_tr_b16 v[210:211], v92 offset:36608
    s_waitcnt lgkmcnt(8)
    v_mfma_f32_32x32x16_bf16 v[120:135], v[224:227], v[64:67], v[120:135]
    ds_read_b64_tr_b16 v[212:213], v48 offset:29696
    ds_read_b64_tr_b16 v[214:215], v49 offset:29696
    s_waitcnt lgkmcnt(7)
    v_mfma_f32_32x32x16_bf16 v[104:119], v[232:235], v[68:71], v[104:119]
    ds_read_b128 v[64:67], v91 offset:57344
    ds_read_b64_tr_b16 v[220:221], v92 offset:38912
    ds_read_b64_tr_b16 v[222:223], v92 offset:39680
    s_waitcnt lgkmcnt(8)
    v_mfma_f32_32x32x16_bf16 v[120:135], v[236:239], v[68:71], v[120:135]
    ds_read_b64_tr_b16 v[224:225], v50 offset:29696
    ds_read_b64_tr_b16 v[226:227], v51 offset:29696
    s_waitcnt lgkmcnt(7)
    v_mfma_f32_32x32x16_bf16 v[104:119], v[208:211], v[60:63], v[104:119]
    s_waitcnt lgkmcnt(5)
    v_mfma_f32_32x32x16_bf16 v[120:135], v[212:215], v[60:63], v[120:135]
    s_waitcnt lgkmcnt(0)
    s_barrier
    ds_read_b128 v[68:71], v72 offset:0
    ds_read_b64_tr_b16 v[232:233], v93 offset:11776
    ds_read_b64_tr_b16 v[234:235], v93 offset:12544
    ds_read_b64_tr_b16 v[236:237], v44 offset:44544
    ds_read_b64_tr_b16 v[238:239], v45 offset:44544
    v_mfma_f32_32x32x16_bf16 v[104:119], v[220:223], v[64:67], v[104:119]
    ds_read_b128 v[60:63], v73 offset:0
    ds_read_b64_tr_b16 v[208:209], v93 offset:14848
    ds_read_b64_tr_b16 v[210:211], v93 offset:15616
    v_mfma_f32_32x32x16_bf16 v[120:135], v[224:227], v[64:67], v[120:135]
    s_waitcnt vmcnt(0)
    v_readfirstlane_b32 s59, v162
    ds_read_b64_tr_b16 v[212:213], v46 offset:44544
    ds_read_b64_tr_b16 v[214:215], v47 offset:44544
    s_waitcnt lgkmcnt(7)
    v_mfma_f32_32x32x16_bf16 v[104:119], v[232:235], v[68:71], v[104:119]
    ds_read_b128 v[64:67], v74 offset:0
    ds_read_b64_tr_b16 v[220:221], v93 offset:17920
    ds_read_b64_tr_b16 v[222:223], v93 offset:18688
    s_waitcnt lgkmcnt(8)
    v_mfma_f32_32x32x16_bf16 v[120:135], v[236:239], v[68:71], v[120:135]
    ds_read_b64_tr_b16 v[224:225], v48 offset:44544
    s_add_u32 s59, s59, 0x9e3779b9
    ds_read_b64_tr_b16 v[226:227], v49 offset:44544
    s_waitcnt lgkmcnt(7)
    v_mfma_f32_32x32x16_bf16 v[104:119], v[208:211], v[60:63], v[104:119]
    ds_read_b128 v[68:71], v75 offset:0
    ds_read_b64_tr_b16 v[232:233], v93 offset:20992
    ds_read_b64_tr_b16 v[234:235], v93 offset:21760
    s_waitcnt lgkmcnt(8)
    v_mfma_f32_32x32x16_bf16 v[120:135], v[212:215], v[60:63], v[120:135]
    ds_read_b64_tr_b16 v[236:237], v50 offset:44544
    ds_read_b64_tr_b16 v[238:239], v51 offset:44544
    s_waitcnt lgkmcnt(7)
    v_mfma_f32_32x32x16_bf16 v[104:119], v[220:223], v[64:67], v[104:119]
    s_waitcnt lgkmcnt(5)
    v_mfma_f32_32x32x16_bf16 v[120:135], v[224:227], v[64:67], v[120:135]
    s_waitcnt lgkmcnt(0)
    s_barrier
    ds_read_b128 v[60:63], v72 offset:8192
    ds_read_b64_tr_b16 v[208:209], v93 offset:26624
    ds_read_b64_tr_b16 v[210:211], v93 offset:27392
    ds_read_b64_tr_b16 v[212:213], v44 offset:59392
    ds_read_b64_tr_b16 v[214:215], v45 offset:59392
    v_mfma_f32_32x32x16_bf16 v[104:119], v[232:235], v[68:71], v[104:119]
    ds_read_b128 v[64:67], v73 offset:8192
    ds_read_b64_tr_b16 v[220:221], v93 offset:29696
    ds_read_b64_tr_b16 v[222:223], v93 offset:30464
    v_mfma_f32_32x32x16_bf16 v[120:135], v[236:239], v[68:71], v[120:135]
    ds_read_b64_tr_b16 v[224:225], v46 offset:59392
    ds_read_b64_tr_b16 v[226:227], v47 offset:59392
    s_waitcnt lgkmcnt(7)
    v_mfma_f32_32x32x16_bf16 v[104:119], v[208:211], v[60:63], v[104:119]
    ds_read_b128 v[68:71], v74 offset:8192
    ds_read_b64_tr_b16 v[232:233], v93 offset:32768
    ds_read_b64_tr_b16 v[234:235], v93 offset:33536
    s_waitcnt lgkmcnt(8)
    v_mfma_f32_32x32x16_bf16 v[120:135], v[212:215], v[60:63], v[120:135]
    ds_read_b64_tr_b16 v[236:237], v48 offset:59392
    ds_read_b64_tr_b16 v[238:239], v49 offset:59392
    s_waitcnt lgkmcnt(7)
    v_mfma_f32_32x32x16_bf16 v[104:119], v[220:223], v[64:67], v[104:119]
    ds_read_b128 v[60:63], v75 offset:8192
    ds_read_b64_tr_b16 v[208:209], v93 offset:35840
    ds_read_b64_tr_b16 v[210:211], v93 offset:36608
    s_waitcnt lgkmcnt(8)
    v_mfma_f32_32x32x16_bf16 v[120:135], v[224:227], v[64:67], v[120:135]
    ds_read_b64_tr_b16 v[212:213], v50 offset:59392
    ds_read_b64_tr_b16 v[214:215], v51 offset:59392
    s_waitcnt lgkmcnt(7)
    v_mfma_f32_32x32x16_bf16 v[104:119], v[232:235], v[68:71], v[104:119]
    s_waitcnt lgkmcnt(5)
    v_mfma_f32_32x32x16_bf16 v[120:135], v[236:239], v[68:71], v[120:135]
    s_waitcnt lgkmcnt(0)
    s_barrier
    ds_read_b128 v[64:67], v88 offset:24576
    ds_read_b64_tr_b16 v[220:221], v92 offset:0
    ds_read_b64_tr_b16 v[222:223], v92 offset:768
    ds_read_b64_tr_b16 v[224:225], v52 offset:0
    ds_read_b64_tr_b16 v[226:227], v53 offset:0
    s_mov_b64 exec, s[82:83]
    ds_read_b128 v[224:227], v98 offset:0
    s_mov_b64 exec, -1
    ds_read_b64_tr_b16 v[228:229], v54 offset:0
    ds_read_b64_tr_b16 v[230:231], v55 offset:0
    v_mfma_f32_32x32x16_bf16 v[104:119], v[208:211], v[60:63], v[104:119]
    ds_read_b128 v[68:71], v89 offset:24576
    ds_read_b64_tr_b16 v[232:233], v92 offset:6144
    ds_read_b64_tr_b16 v[234:235], v92 offset:6912
    ds_read_b64_tr_b16 v[236:237], v52 offset:6144
    v_mfma_f32_32x32x16_bf16 v[120:135], v[212:215], v[60:63], v[120:135]
    ds_read_b64_tr_b16 v[238:239], v53 offset:6144
    s_mov_b64 exec, s[82:83]
    ds_read_b128 v[236:239], v98 offset:32
    s_mov_b64 exec, -1
    ds_read_b64_tr_b16 v[240:241], v54 offset:6144
    ds_read_b64_tr_b16 v[242:243], v55 offset:6144
    s_waitcnt lgkmcnt(13)
    v_mfma_f32_32x32x16_bf16 v[136:151], v[220:223], v[64:67], 0
    s_barrier
    ds_read_b128 v[60:63], v90 offset:24576
    ds_read_b64_tr_b16 v[208:209], v92 offset:12288
    v_cvt_pk_bf16_f32 v104, v104, v105
    ds_read_b64_tr_b16 v[210:211], v92 offset:13056
    v_cvt_pk_bf16_f32 v105, v106, v107
    v_cvt_pk_bf16_f32 v106, v108, v109
    s_waitcnt lgkmcnt(13)
    v_mfma_f32_32x32x16_bf16 v[152:167], v[224:227], v[64:67], 0
    v_cvt_pk_bf16_f32 v107, v110, v111
    ds_read_b64_tr_b16 v[212:213], v52 offset:12288
    v_mul_f32 v128, s86, v128
    v_mul_f32 v129, s86, v129
    v_cvt_pk_bf16_f32 v128, v128, v129
    ds_read_b64_tr_b16 v[214:215], v53 offset:12288
    v_mul_f32 v130, s86, v130
    v_mul_f32 v131, s86, v131
    s_mov_b64 exec, s[82:83]
    ds_read_b128 v[212:215], v98 offset:64
    s_mov_b64 exec, -1
    v_cvt_pk_bf16_f32 v129, v130, v131
    v_mul_f32 v132, s86, v132
    v_mul_f32 v133, s86, v133
    s_waitcnt lgkmcnt(14)
    v_mfma_f32_32x32x16_bf16 v[168:183], v[228:231], v[64:67], 0
    v_cvt_pk_bf16_f32 v130, v132, v133
    ds_read_b64_tr_b16 v[216:217], v54 offset:12288
    v_mul_f32 v134, s86, v134
    v_mul_f32 v135, s86, v135
    v_cvt_pk_bf16_f32 v131, v134, v135
    ds_read_b64_tr_b16 v[218:219], v55 offset:12288
    s_nop 0
    v_permlane32_swap_b32 v128, v130
    v_permlane32_swap_b32 v129, v131
    s_waitcnt lgkmcnt(13)
    v_mfma_f32_32x32x16_bf16 v[136:151], v[232:235], v[68:71], v[136:151]
    ds_write_b128 v193, v[104:107] offset:0
    ds_write_b128 v192, v[128:131]
    ds_read_b128 v[64:67], v91 offset:24576
    ds_read_b64_tr_b16 v[220:221], v92 offset:18432
    ds_read_b64_tr_b16 v[222:223], v92 offset:19200
    s_waitcnt lgkmcnt(15)
    v_mfma_f32_32x32x16_bf16 v[152:167], v[236:239], v[68:71], v[152:167]
    ds_read_b64_tr_b16 v[224:225], v52 offset:18432
    ds_read_b64_tr_b16 v[226:227], v53 offset:18432
    s_mov_b64 exec, s[82:83]
    ds_read_b128 v[224:227], v98 offset:96
    s_mov_b64 exec, -1
    s_waitcnt lgkmcnt(15)
    v_mfma_f32_32x32x16_bf16 v[168:183], v[240:243], v[68:71], v[168:183]
    ds_read_b64_tr_b16 v[228:229], v54 offset:18432
    ds_read_b64_tr_b16 v[230:231], v55 offset:18432
    s_waitcnt lgkmcnt(15)
    v_mfma_f32_32x32x16_bf16 v[136:151], v[208:211], v[60:63], v[136:151]
    s_waitcnt lgkmcnt(8)
    s_barrier
    v_cvt_pk_bf16_f32 v112, v112, v113
    ds_read_b128 v[68:71], v88 offset:32768
    v_cvt_pk_bf16_f32 v113, v114, v115
    ds_read_b64_tr_b16 v[232:233], v92 offset:24576
    v_cvt_pk_bf16_f32 v114, v116, v117
    ds_read_b64_tr_b16 v[234:235], v92 offset:25344
    v_cvt_pk_bf16_f32 v115, v118, v119
    v_mfma_f32_32x32x16_bf16 v[152:167], v[212:215], v[60:63], v[152:167]
    v_cvt_pk_bf16_f32 v120, v120, v121
    ds_read_b64_tr_b16 v[236:237], v52 offset:24576
    v_cvt_pk_bf16_f32 v121, v122, v123
    v_cvt_pk_bf16_f32 v122, v124, v125
    ds_read_b64_tr_b16 v[238:239], v53 offset:24576
    v_cvt_pk_bf16_f32 v123, v126, v127
    s_mov_b64 exec, s[82:83]
    ds_read_b128 v[236:239], v98 offset:128
    s_mov_b64 exec, -1
    ds_write_b128 v193, v[112:115] offset:1024
    ds_write_b128 v193, v[120:123] offset:2048
    v_mfma_f32_32x32x16_bf16 v[168:183], v[216:219], v[60:63], v[168:183]
    ds_read_b64_tr_b16 v[240:241], v54 offset:24576
    ds_read_b64_tr_b16 v[242:243], v55 offset:24576
    s_waitcnt lgkmcnt(15)
    v_mfma_f32_32x32x16_bf16 v[136:151], v[220:223], v[64:67], v[136:151]
    ds_read_b128 v[60:63], v89 offset:32768
    ds_read_b64_tr_b16 v[208:209], v92 offset:30720
    ds_read_b64_tr_b16 v[210:211], v92 offset:31488
    s_waitcnt lgkmcnt(15)
    v_mfma_f32_32x32x16_bf16 v[152:167], v[224:227], v[64:67], v[152:167]
    ds_read_b64_tr_b16 v[212:213], v52 offset:30720
    ds_read_b64_tr_b16 v[214:215], v53 offset:30720
    s_mov_b64 exec, s[82:83]
    ds_read_b128 v[212:215], v98 offset:160
    s_mov_b64 exec, -1
    s_waitcnt lgkmcnt(15)
    v_mfma_f32_32x32x16_bf16 v[168:183], v[228:231], v[64:67], v[168:183]
    ds_read_b64_tr_b16 v[216:217], v54 offset:30720
    ds_read_b64_tr_b16 v[218:219], v55 offset:30720
    s_waitcnt lgkmcnt(15)
    v_mfma_f32_32x32x16_bf16 v[136:151], v[232:235], v[68:71], v[136:151]
    s_waitcnt lgkmcnt(10)
    s_barrier
    ds_read_b128 v[64:67], v90 offset:32768
    ds_read_b64_tr_b16 v[220:221], v93 offset:4096
    ds_read_b64_tr_b16 v[222:223], v93 offset:4864
    v_mfma_f32_32x32x16_bf16 v[152:167], v[236:239], v[68:71], v[152:167]
    ds_read_b64_tr_b16 v[224:225], v56 offset:4096
    ds_read_b64_tr_b16 v[226:227], v57 offset:4096
    s_mov_b64 exec, s[82:83]
    ds_read_b128 v[224:227], v98 offset:192
    s_mov_b64 exec, -1
    s_waitcnt lgkmcnt(14)
    v_mfma_f32_32x32x16_bf16 v[168:183], v[240:243], v[68:71], v[168:183]
    ds_read_b64_tr_b16 v[228:229], v58 offset:4096
    ds_read_b64_tr_b16 v[230:231], v59 offset:4096
    s_waitcnt lgkmcnt(13)
    v_mfma_f32_32x32x16_bf16 v[136:151], v[208:211], v[60:63], v[136:151]
    ds_read_b128 v[68:71], v91 offset:32768
    ds_read_b64_tr_b16 v[232:233], v93 offset:10240
    ds_read_b64_tr_b16 v[234:235], v93 offset:11008
    s_waitcnt lgkmcnt(13)
    v_mfma_f32_32x32x16_bf16 v[152:167], v[212:215], v[60:63], v[152:167]
    ds_read_b64_tr_b16 v[236:237], v56 offset:10240
    ds_read_b64_tr_b16 v[238:239], v57 offset:10240
    s_mov_b64 exec, s[82:83]
    ds_read_b128 v[236:239], v98 offset:224
    s_mov_b64 exec, -1
    s_waitcnt lgkmcnt(14)
    v_mfma_f32_32x32x16_bf16 v[168:183], v[216:219], v[60:63], v[168:183]
    ds_read_b64_tr_b16 v[240:241], v58 offset:10240
    ds_read_b64_tr_b16 v[242:243], v59 offset:10240
    s_waitcnt lgkmcnt(13)
    v_mfma_f32_32x32x16_bf16 v[136:151], v[220:223], v[64:67], v[136:151]
    s_barrier
    ds_read_b128 v[60:63], v88 offset:0
    ds_read_b64_tr_b16 v[208:209], v93 offset:16384
    ds_read_b64_tr_b16 v[210:211], v93 offset:17152
    s_waitcnt lgkmcnt(13)
    v_mfma_f32_32x32x16_bf16 v[152:167], v[224:227], v[64:67], v[152:167]
    ds_read_b64_tr_b16 v[212:213], v56 offset:16384
    ds_read_b64_tr_b16 v[214:215], v57 offset:16384
    s_mov_b64 exec, s[82:83]
    ds_read_b128 v[212:215], v98 offset:256
    s_mov_b64 exec, -1
    s_waitcnt lgkmcnt(14)
    v_mfma_f32_32x32x16_bf16 v[168:183], v[228:231], v[64:67], v[168:183]
    ds_read_b64_tr_b16 v[216:217], v58 offset:16384
    ds_read_b64_tr_b16 v[218:219], v59 offset:16384
    s_waitcnt lgkmcnt(13)
    v_mfma_f32_32x32x16_bf16 v[136:151], v[232:235], v[68:71], v[136:151]
    ds_read_b128 v[64:67], v89 offset:0
    ds_read_b64_tr_b16 v[220:221], v93 offset:22528
    ds_read_b64_tr_b16 v[222:223], v93 offset:23296
    s_waitcnt lgkmcnt(13)
    v_mfma_f32_32x32x16_bf16 v[152:167], v[236:239], v[68:71], v[152:167]
    ds_read_b64_tr_b16 v[224:225], v56 offset:22528
    ds_read_b64_tr_b16 v[226:227], v57 offset:22528
    s_mov_b64 exec, s[82:83]
    ds_read_b128 v[224:227], v98 offset:288
    s_mov_b64 exec, -1
    s_waitcnt lgkmcnt(14)
    v_mfma_f32_32x32x16_bf16 v[168:183], v[240:243], v[68:71], v[168:183]
    ds_read_b64_tr_b16 v[228:229], v58 offset:22528
    ds_read_b64_tr_b16 v[230:231], v59 offset:22528
    s_waitcnt lgkmcnt(13)
    v_mfma_f32_32x32x16_bf16 v[136:151], v[208:211], v[60:63], v[136:151]
    s_barrier
    ds_read_b128 v[68:71], v90 offset:0
    ds_read_b64_tr_b16 v[232:233], v92 offset:0
    ds_read_b64_tr_b16 v[234:235], v92 offset:768
    s_waitcnt lgkmcnt(13)
    v_mfma_f32_32x32x16_bf16 v[152:167], v[212:215], v[60:63], v[152:167]
    ds_read_b64_tr_b16 v[236:237], v52 offset:0
    ds_read_b64_tr_b16 v[238:239], v53 offset:0
    s_mov_b64 exec, s[82:83]
    ds_read_b128 v[236:239], v98 offset:320
    s_mov_b64 exec, -1
    s_waitcnt lgkmcnt(14)
    v_mfma_f32_32x32x16_bf16 v[168:183], v[216:219], v[60:63], v[168:183]
    ds_read_b64_tr_b16 v[240:241], v54 offset:0
    ds_read_b64_tr_b16 v[242:243], v55 offset:0
    s_waitcnt lgkmcnt(13)
    v_mfma_f32_32x32x16_bf16 v[136:151], v[220:223], v[64:67], v[136:151]
    ds_read_b128 v[60:63], v91 offset:0
    ds_read_b64_tr_b16 v[208:209], v92 offset:6144
    ds_read_b64_tr_b16 v[210:211], v92 offset:6912
    s_waitcnt lgkmcnt(13)
    v_mfma_f32_32x32x16_bf16 v[152:167], v[224:227], v[64:67], v[152:167]
    ds_read_b64_tr_b16 v[212:213], v52 offset:6144
    ds_read_b64_tr_b16 v[214:215], v53 offset:6144
    s_mov_b64 exec, s[82:83]
    ds_read_b128 v[212:215], v98 offset:352
    s_mov_b64 exec, -1
    s_waitcnt lgkmcnt(14)
    v_mfma_f32_32x32x16_bf16 v[168:183], v[228:231], v[64:67], v[168:183]
    ds_read_b64_tr_b16 v[216:217], v54 offset:6144
    ds_read_b64_tr_b16 v[218:219], v55 offset:6144
    s_waitcnt lgkmcnt(13)
    v_mfma_f32_32x32x16_bf16 v[136:151], v[232:235], v[68:71], v[136:151]
    s_barrier
    ds_read_b128 v[64:67], v88 offset:8192
    ds_read_b64_tr_b16 v[220:221], v92 offset:12288
    ds_read_b64_tr_b16 v[222:223], v92 offset:13056
    s_waitcnt lgkmcnt(13)
    v_mfma_f32_32x32x16_bf16 v[152:167], v[236:239], v[68:71], v[152:167]
    ds_read_b64_tr_b16 v[224:225], v52 offset:12288
    ds_read_b64_tr_b16 v[226:227], v53 offset:12288
    s_mov_b64 exec, s[82:83]
    ds_read_b128 v[224:227], v98 offset:384
    s_mov_b64 exec, -1
    s_waitcnt lgkmcnt(14)
    v_mfma_f32_32x32x16_bf16 v[168:183], v[240:243], v[68:71], v[168:183]
    ds_read_b64_tr_b16 v[228:229], v54 offset:12288
    ds_read_b64_tr_b16 v[230:231], v55 offset:12288
    s_waitcnt lgkmcnt(13)
    v_mfma_f32_32x32x16_bf16 v[136:151], v[208:211], v[60:63], v[136:151]
    ds_read_b128 v[68:71], v89 offset:8192
    ds_read_b64_tr_b16 v[232:233], v92 offset:18432
    ds_read_b64_tr_b16 v[234:235], v92 offset:19200
    s_waitcnt lgkmcnt(13)
    v_mfma_f32_32x32x16_bf16 v[152:167], v[212:215], v[60:63], v[152:167]
    ds_read_b64_tr_b16 v[236:237], v52 offset:18432
    ds_read_b64_tr_b16 v[238:239], v53 offset:18432
    s_mov_b64 exec, s[82:83]
    ds_read_b128 v[236:239], v98 offset:416
    s_mov_b64 exec, -1
    s_waitcnt lgkmcnt(14)
    v_mfma_f32_32x32x16_bf16 v[168:183], v[216:219], v[60:63], v[168:183]
    ds_read_b64_tr_b16 v[240:241], v54 offset:18432
    ds_read_b64_tr_b16 v[242:243], v55 offset:18432
    s_waitcnt lgkmcnt(13)
    v_mfma_f32_32x32x16_bf16 v[136:151], v[220:223], v[64:67], v[136:151]
    s_barrier
    ds_read_b128 v[60:63], v90 offset:8192
    ds_read_b64_tr_b16 v[208:209], v92 offset:24576
    ds_read_b64_tr_b16 v[210:211], v92 offset:25344
    s_waitcnt lgkmcnt(13)
    v_mfma_f32_32x32x16_bf16 v[152:167], v[224:227], v[64:67], v[152:167]
    ds_read_b64_tr_b16 v[212:213], v52 offset:24576
    ds_read_b64_tr_b16 v[214:215], v53 offset:24576
    s_mov_b64 exec, s[82:83]
    ds_read_b128 v[212:215], v98 offset:448
    s_mov_b64 exec, -1
    s_waitcnt lgkmcnt(14)
    v_mfma_f32_32x32x16_bf16 v[168:183], v[228:231], v[64:67], v[168:183]
    ds_read_b64_tr_b16 v[216:217], v54 offset:24576
    ds_read_b64_tr_b16 v[218:219], v55 offset:24576
    s_waitcnt lgkmcnt(13)
    v_mfma_f32_32x32x16_bf16 v[136:151], v[232:235], v[68:71], v[136:151]
    ds_read_b128 v[64:67], v91 offset:8192
    ds_read_b64_tr_b16 v[220:221], v92 offset:30720
    ds_read_b64_tr_b16 v[222:223], v92 offset:31488
    s_waitcnt lgkmcnt(13)
    v_mfma_f32_32x32x16_bf16 v[152:167], v[236:239], v[68:71], v[152:167]
    ds_read_b64_tr_b16 v[224:225], v52 offset:30720
    ds_read_b64_tr_b16 v[226:227], v53 offset:30720
    s_mov_b64 exec, s[82:83]
    ds_read_b128 v[224:227], v98 offset:480
    s_mov_b64 exec, -1
    s_waitcnt lgkmcnt(14)
    v_mfma_f32_32x32x16_bf16 v[168:183], v[240:243], v[68:71], v[168:183]
    ds_read_b64_tr_b16 v[228:229], v54 offset:30720
    ds_read_b64_tr_b16 v[230:231], v55 offset:30720
    s_waitcnt lgkmcnt(13)
    v_mfma_f32_32x32x16_bf16 v[136:151], v[208:211], v[60:63], v[136:151]
    s_barrier
    ds_read_b128 v[68:71], v88 offset:16384
    ds_read_b64_tr_b16 v[232:233], v93 offset:4096
    ds_read_b64_tr_b16 v[234:235], v93 offset:4864
    s_waitcnt lgkmcnt(13)
    v_mfma_f32_32x32x16_bf16 v[152:167], v[212:215], v[60:63], v[152:167]
    ds_read_b64_tr_b16 v[236:237], v56 offset:4096
    ds_read_b64_tr_b16 v[238:239], v57 offset:4096
    s_mov_b64 exec, s[82:83]
    ds_read_b128 v[236:239], v98 offset:512
    s_mov_b64 exec, -1
    s_waitcnt lgkmcnt(14)
    v_mfma_f32_32x32x16_bf16 v[168:183], v[216:219], v[60:63], v[168:183]
    ds_read_b64_tr_b16 v[240:241], v58 offset:4096
    ds_read_b64_tr_b16 v[242:243], v59 offset:4096
    s_waitcnt lgkmcnt(13)
    v_mfma_f32_32x32x16_bf16 v[136:151], v[220:223], v[64:67], v[136:151]
    ds_read_b128 v[60:63], v89 offset:16384
    ds_read_b64_tr_b16 v[208:209], v93 offset:10240
    ds_read_b64_tr_b16 v[210:211], v93 offset:11008
    s_waitcnt lgkmcnt(13)
    v_mfma_f32_32x32x16_bf16 v[152:167], v[224:227], v[64:67], v[152:167]
    ds_read_b64_tr_b16 v[212:213], v56 offset:10240
    ds_read_b64_tr_b16 v[214:215], v57 offset:10240
    s_mov_b64 exec, s[82:83]
    ds_read_b128 v[212:215], v98 offset:544
    s_mov_b64 exec, -1
    s_waitcnt lgkmcnt(14)
    v_mfma_f32_32x32x16_bf16 v[168:183], v[228:231], v[64:67], v[168:183]
    ds_read_b64_tr_b16 v[216:217], v58 offset:10240
    ds_read_b64_tr_b16 v[218:219], v59 offset:10240
    s_waitcnt lgkmcnt(13)
    v_mfma_f32_32x32x16_bf16 v[136:151], v[232:235], v[68:71], v[136:151]
    s_barrier
    ds_read_b128 v[64:67], v90 offset:16384
    ds_read_b64_tr_b16 v[220:221], v93 offset:28672
    ds_read_b64_tr_b16 v[222:223], v93 offset:29440
    s_waitcnt lgkmcnt(13)
    v_mfma_f32_32x32x16_bf16 v[152:167], v[236:239], v[68:71], v[152:167]
    ds_read_b64_tr_b16 v[224:225], v56 offset:28672
    ds_read_b64_tr_b16 v[226:227], v57 offset:28672
    s_mov_b64 exec, s[82:83]
    ds_read_b128 v[224:227], v98 offset:576
    s_mov_b64 exec, -1
    s_waitcnt lgkmcnt(14)
    v_mfma_f32_32x32x16_bf16 v[168:183], v[240:243], v[68:71], v[168:183]
    ds_read_b64_tr_b16 v[228:229], v58 offset:28672
    ds_read_b64_tr_b16 v[230:231], v59 offset:28672
    s_waitcnt lgkmcnt(13)
    v_mfma_f32_32x32x16_bf16 v[136:151], v[208:211], v[60:63], v[136:151]
    ds_read_b128 v[68:71], v91 offset:16384
    ds_read_b64_tr_b16 v[232:233], v93 offset:34816
    ds_read_b64_tr_b16 v[234:235], v93 offset:35584
    s_waitcnt lgkmcnt(13)
    v_mfma_f32_32x32x16_bf16 v[152:167], v[212:215], v[60:63], v[152:167]
    ds_read_b64_tr_b16 v[236:237], v56 offset:34816
    ds_read_b64_tr_b16 v[238:239], v57 offset:34816
    s_mov_b64 exec, s[82:83]
    ds_read_b128 v[236:239], v98 offset:608
    s_mov_b64 exec, -1
    s_waitcnt lgkmcnt(14)
    v_mfma_f32_32x32x16_bf16 v[168:183], v[216:219], v[60:63], v[168:183]
    ds_read_b64_tr_b16 v[240:241], v58 offset:34816
    ds_read_b64_tr_b16 v[242:243], v59 offset:34816
    s_waitcnt lgkmcnt(13)
    v_mfma_f32_32x32x16_bf16 v[136:151], v[220:223], v[64:67], v[136:151]
    s_barrier
    ds_read_b128 v[60:63], v88 offset:40960
    ds_read_b64_tr_b16 v[208:209], v93 offset:16384
    ds_read_b64_tr_b16 v[210:211], v93 offset:17152
    s_waitcnt lgkmcnt(13)
    v_mfma_f32_32x32x16_bf16 v[152:167], v[224:227], v[64:67], v[152:167]
    ds_read_b64_tr_b16 v[212:213], v56 offset:16384
    ds_read_b64_tr_b16 v[214:215], v57 offset:16384
    s_mov_b64 exec, s[82:83]
    ds_read_b128 v[212:215], v98 offset:640
    s_mov_b64 exec, -1
    s_waitcnt lgkmcnt(14)
    v_mfma_f32_32x32x16_bf16 v[168:183], v[228:231], v[64:67], v[168:183]
    ds_read_b64_tr_b16 v[216:217], v58 offset:16384
    ds_read_b64_tr_b16 v[218:219], v59 offset:16384
    s_waitcnt lgkmcnt(13)
    v_mfma_f32_32x32x16_bf16 v[136:151], v[232:235], v[68:71], v[136:151]
    ds_read_b128 v[64:67], v89 offset:40960
    ds_read_b64_tr_b16 v[220:221], v93 offset:22528
    ds_read_b64_tr_b16 v[222:223], v93 offset:23296
    s_waitcnt lgkmcnt(13)
    v_mfma_f32_32x32x16_bf16 v[152:167], v[236:239], v[68:71], v[152:167]
    ds_read_b64_tr_b16 v[224:225], v56 offset:22528
    ds_read_b64_tr_b16 v[226:227], v57 offset:22528
    s_mov_b64 exec, s[82:83]
    ds_read_b128 v[224:227], v98 offset:672
    s_mov_b64 exec, -1
    s_waitcnt lgkmcnt(14)
    v_mfma_f32_32x32x16_bf16 v[168:183], v[240:243], v[68:71], v[168:183]
    ds_read_b64_tr_b16 v[228:229], v58 offset:22528
    ds_read_b64_tr_b16 v[230:231], v59 offset:22528
    s_waitcnt lgkmcnt(13)
    v_mfma_f32_32x32x16_bf16 v[136:151], v[208:211], v[60:63], v[136:151]
    s_barrier
    ds_read_b128 v[68:71], v90 offset:40960
    ds_read_b64_tr_b16 v[232:233], v92 offset:0
    ds_read_b64_tr_b16 v[234:235], v92 offset:768
    s_waitcnt lgkmcnt(13)
    v_mfma_f32_32x32x16_bf16 v[152:167], v[212:215], v[60:63], v[152:167]
    ds_read_b64_tr_b16 v[236:237], v52 offset:0
    ds_read_b64_tr_b16 v[238:239], v53 offset:0
    s_mov_b64 exec, s[82:83]
    ds_read_b128 v[236:239], v98 offset:704
    s_mov_b64 exec, -1
    s_waitcnt lgkmcnt(14)
    v_mfma_f32_32x32x16_bf16 v[168:183], v[216:219], v[60:63], v[168:183]
    ds_read_b64_tr_b16 v[240:241], v54 offset:0
    ds_read_b64_tr_b16 v[242:243], v55 offset:0
    s_waitcnt lgkmcnt(13)
    v_mfma_f32_32x32x16_bf16 v[136:151], v[220:223], v[64:67], v[136:151]
    ds_read_b128 v[60:63], v91 offset:40960
    ds_read_b64_tr_b16 v[208:209], v92 offset:6144
    ds_read_b64_tr_b16 v[210:211], v92 offset:6912
    s_waitcnt lgkmcnt(13)
    v_mfma_f32_32x32x16_bf16 v[152:167], v[224:227], v[64:67], v[152:167]
    ds_read_b64_tr_b16 v[212:213], v52 offset:6144
    ds_read_b64_tr_b16 v[214:215], v53 offset:6144
    s_mov_b64 exec, s[82:83]
    ds_read_b128 v[212:215], v98 offset:736
    s_mov_b64 exec, -1
    s_waitcnt lgkmcnt(14)
    v_mfma_f32_32x32x16_bf16 v[168:183], v[228:231], v[64:67], v[168:183]
    ds_read_b64_tr_b16 v[216:217], v54 offset:6144
    ds_read_b64_tr_b16 v[218:219], v55 offset:6144
    s_waitcnt lgkmcnt(13)
    v_mfma_f32_32x32x16_bf16 v[136:151], v[232:235], v[68:71], v[136:151]
    s_barrier
    ds_read_b128 v[64:67], v88 offset:49152
    ds_read_b64_tr_b16 v[220:221], v92 offset:12288
    ds_read_b64_tr_b16 v[222:223], v92 offset:13056
    s_waitcnt lgkmcnt(13)
    v_mfma_f32_32x32x16_bf16 v[152:167], v[236:239], v[68:71], v[152:167]
    ds_read_b64_tr_b16 v[224:225], v52 offset:12288
    ds_read_b64_tr_b16 v[226:227], v53 offset:12288
    s_mov_b64 exec, s[82:83]
    ds_read_b128 v[224:227], v98 offset:768
    s_mov_b64 exec, -1
    s_waitcnt lgkmcnt(14)
    v_mfma_f32_32x32x16_bf16 v[168:183], v[240:243], v[68:71], v[168:183]
    ds_read_b64_tr_b16 v[228:229], v54 offset:12288
    ds_read_b64_tr_b16 v[230:231], v55 offset:12288
    s_waitcnt lgkmcnt(13)
    v_mfma_f32_32x32x16_bf16 v[136:151], v[208:211], v[60:63], v[136:151]
    ds_read_b128 v[68:71], v89 offset:49152
    ds_read_b64_tr_b16 v[232:233], v92 offset:18432
    ds_read_b64_tr_b16 v[234:235], v92 offset:19200
    s_waitcnt lgkmcnt(13)
    v_mfma_f32_32x32x16_bf16 v[152:167], v[212:215], v[60:63], v[152:167]
    ds_read_b64_tr_b16 v[236:237], v52 offset:18432
    ds_read_b64_tr_b16 v[238:239], v53 offset:18432
    s_mov_b64 exec, s[82:83]
    ds_read_b128 v[236:239], v98 offset:800
    s_mov_b64 exec, -1
    s_waitcnt lgkmcnt(14)
    v_mfma_f32_32x32x16_bf16 v[168:183], v[216:219], v[60:63], v[168:183]
    ds_read_b64_tr_b16 v[240:241], v54 offset:18432
    ds_read_b64_tr_b16 v[242:243], v55 offset:18432
    s_waitcnt lgkmcnt(13)
    v_mfma_f32_32x32x16_bf16 v[136:151], v[220:223], v[64:67], v[136:151]
    s_barrier
    ds_read_b128 v[60:63], v90 offset:49152
    ds_read_b64_tr_b16 v[208:209], v92 offset:24576
    ds_read_b64_tr_b16 v[210:211], v92 offset:25344
    s_waitcnt lgkmcnt(13)
    v_mfma_f32_32x32x16_bf16 v[152:167], v[224:227], v[64:67], v[152:167]
    ds_read_b64_tr_b16 v[212:213], v52 offset:24576
    ds_read_b64_tr_b16 v[214:215], v53 offset:24576
    s_mov_b64 exec, s[82:83]
    ds_read_b128 v[212:215], v98 offset:832
    s_mov_b64 exec, -1
    s_waitcnt lgkmcnt(14)
    v_mfma_f32_32x32x16_bf16 v[168:183], v[228:231], v[64:67], v[168:183]
    ds_read_b64_tr_b16 v[216:217], v54 offset:24576
    ds_read_b64_tr_b16 v[218:219], v55 offset:24576
    s_waitcnt lgkmcnt(13)
    v_mfma_f32_32x32x16_bf16 v[136:151], v[232:235], v[68:71], v[136:151]
    ds_read_b128 v[64:67], v91 offset:49152
    ds_read_b64_tr_b16 v[220:221], v92 offset:30720
    ds_read_b64_tr_b16 v[222:223], v92 offset:31488
    s_waitcnt lgkmcnt(13)
    v_mfma_f32_32x32x16_bf16 v[152:167], v[236:239], v[68:71], v[152:167]
    ds_read_b64_tr_b16 v[224:225], v52 offset:30720
    ds_read_b64_tr_b16 v[226:227], v53 offset:30720
    s_mov_b64 exec, s[82:83]
    ds_read_b128 v[224:227], v98 offset:864
    s_mov_b64 exec, -1
    s_waitcnt lgkmcnt(14)
    v_mfma_f32_32x32x16_bf16 v[168:183], v[240:243], v[68:71], v[168:183]
    ds_read_b64_tr_b16 v[228:229], v54 offset:30720
    ds_read_b64_tr_b16 v[230:231], v55 offset:30720
    s_waitcnt lgkmcnt(13)
    v_mfma_f32_32x32x16_bf16 v[136:151], v[208:211], v[60:63], v[136:151]
    s_barrier
    ds_read_b128 v[68:71], v88 offset:57344
    ds_read_b64_tr_b16 v[232:233], v93 offset:4096
    ds_read_b64_tr_b16 v[234:235], v93 offset:4864
    s_waitcnt lgkmcnt(13)
    v_mfma_f32_32x32x16_bf16 v[152:167], v[212:215], v[60:63], v[152:167]
    ds_read_b64_tr_b16 v[236:237], v56 offset:4096
    ds_read_b64_tr_b16 v[238:239], v57 offset:4096
    s_mov_b64 exec, s[82:83]
    ds_read_b128 v[236:239], v98 offset:896
    s_mov_b64 exec, -1
    s_waitcnt lgkmcnt(14)
    v_mfma_f32_32x32x16_bf16 v[168:183], v[216:219], v[60:63], v[168:183]
    ds_read_b64_tr_b16 v[240:241], v58 offset:4096
    ds_read_b64_tr_b16 v[242:243], v59 offset:4096
    s_waitcnt lgkmcnt(13)
    v_mfma_f32_32x32x16_bf16 v[136:151], v[220:223], v[64:67], v[136:151]
    ds_read_b128 v[60:63], v89 offset:57344
    ds_read_b64_tr_b16 v[208:209], v93 offset:10240
    ds_read_b64_tr_b16 v[210:211], v93 offset:11008
    s_waitcnt lgkmcnt(13)
    v_mfma_f32_32x32x16_bf16 v[152:167], v[224:227], v[64:67], v[152:167]
    ds_read_b64_tr_b16 v[212:213], v56 offset:10240
    ds_read_b64_tr_b16 v[214:215], v57 offset:10240
    s_mov_b64 exec, s[82:83]
    ds_read_b128 v[212:215], v98 offset:928
    s_mov_b64 exec, -1
    s_waitcnt lgkmcnt(14)
    v_mfma_f32_32x32x16_bf16 v[168:183], v[228:231], v[64:67], v[168:183]
    ds_read_b64_tr_b16 v[216:217], v58 offset:10240
    ds_read_b64_tr_b16 v[218:219], v59 offset:10240
    s_waitcnt lgkmcnt(13)
    v_mfma_f32_32x32x16_bf16 v[136:151], v[232:235], v[68:71], v[136:151]
    s_barrier
    ds_read_b128 v[64:67], v90 offset:57344
    ds_read_b64_tr_b16 v[220:221], v93 offset:28672
    ds_read_b64_tr_b16 v[222:223], v93 offset:29440
    s_waitcnt lgkmcnt(13)
    v_mfma_f32_32x32x16_bf16 v[152:167], v[236:239], v[68:71], v[152:167]
    ds_read_b64_tr_b16 v[224:225], v56 offset:28672
    ds_read_b64_tr_b16 v[226:227], v57 offset:28672
    s_mov_b64 exec, s[82:83]
    ds_read_b128 v[224:227], v98 offset:960
    s_mov_b64 exec, -1
    s_waitcnt lgkmcnt(14)
    v_mfma_f32_32x32x16_bf16 v[168:183], v[240:243], v[68:71], v[168:183]
    ds_read_b64_tr_b16 v[228:229], v58 offset:28672
    ds_read_b64_tr_b16 v[230:231], v59 offset:28672
    s_waitcnt lgkmcnt(13)
    v_mfma_f32_32x32x16_bf16 v[136:151], v[208:211], v[60:63], v[136:151]
    ds_read_b128 v[68:71], v91 offset:57344
    ds_read_b64_tr_b16 v[232:233], v93 offset:34816
    ds_read_b64_tr_b16 v[234:235], v93 offset:35584
    s_waitcnt lgkmcnt(13)
    v_mfma_f32_32x32x16_bf16 v[152:167], v[212:215], v[60:63], v[152:167]
    ds_read_b64_tr_b16 v[236:237], v56 offset:34816
    ds_read_b64_tr_b16 v[238:239], v57 offset:34816
    s_mov_b64 exec, s[82:83]
    ds_read_b128 v[236:239], v98 offset:992
    s_mov_b64 exec, -1
    s_waitcnt lgkmcnt(14)
    v_mfma_f32_32x32x16_bf16 v[168:183], v[216:219], v[60:63], v[168:183]
    ds_read_b64_tr_b16 v[240:241], v58 offset:34816
    ds_read_b64_tr_b16 v[242:243], v59 offset:34816
    s_waitcnt lgkmcnt(13)
    v_mfma_f32_32x32x16_bf16 v[136:151], v[220:223], v[64:67], v[136:151]
    s_barrier
    ds_read_b128 v[60:63], v72 offset:0
    ds_read_b64_tr_b16 v[208:209], v93 offset:16384
    ds_read_b64_tr_b16 v[210:211], v93 offset:17152
    s_waitcnt lgkmcnt(13)
    v_mfma_f32_32x32x16_bf16 v[152:167], v[224:227], v[64:67], v[152:167]
    ds_read_b64_tr_b16 v[212:213], v56 offset:16384
    ds_read_b64_tr_b16 v[214:215], v57 offset:16384
    s_mov_b64 exec, s[82:83]
    ds_read_b128 v[212:215], v98 offset:1024
    s_mov_b64 exec, -1
    s_waitcnt lgkmcnt(14)
    v_mfma_f32_32x32x16_bf16 v[168:183], v[228:231], v[64:67], v[168:183]
    ds_read_b64_tr_b16 v[216:217], v58 offset:16384
    ds_read_b64_tr_b16 v[218:219], v59 offset:16384
    s_waitcnt lgkmcnt(13)
    v_mfma_f32_32x32x16_bf16 v[136:151], v[232:235], v[68:71], v[136:151]
    ds_read_b128 v[64:67], v73 offset:0
    ds_read_b64_tr_b16 v[220:221], v93 offset:22528
    ds_read_b64_tr_b16 v[222:223], v93 offset:23296
    s_waitcnt lgkmcnt(13)
    v_mfma_f32_32x32x16_bf16 v[152:167], v[236:239], v[68:71], v[152:167]
    ds_read_b64_tr_b16 v[224:225], v56 offset:22528
    ds_read_b64_tr_b16 v[226:227], v57 offset:22528
    s_mov_b64 exec, s[82:83]
    ds_read_b128 v[224:227], v98 offset:1056
    s_mov_b64 exec, -1
    s_waitcnt lgkmcnt(14)
    v_mfma_f32_32x32x16_bf16 v[168:183], v[240:243], v[68:71], v[168:183]
    ds_read_b64_tr_b16 v[228:229], v58 offset:22528
    ds_read_b64_tr_b16 v[230:231], v59 offset:22528
    s_waitcnt lgkmcnt(13)
    v_mfma_f32_32x32x16_bf16 v[136:151], v[208:211], v[60:63], v[136:151]
    s_barrier
    ds_read_b128 v[68:71], v74 offset:0
    ds_read_b64_tr_b16 v[232:233], v92 offset:0
    ds_read_b64_tr_b16 v[234:235], v92 offset:768
    s_waitcnt lgkmcnt(13)
    v_mfma_f32_32x32x16_bf16 v[152:167], v[212:215], v[60:63], v[152:167]
    ds_read_b64_tr_b16 v[236:237], v52 offset:0
    ds_read_b64_tr_b16 v[238:239], v53 offset:0
    s_mov_b64 exec, s[82:83]
    ds_read_b128 v[236:239], v98 offset:1088
    s_mov_b64 exec, -1
    s_waitcnt lgkmcnt(14)
    v_mfma_f32_32x32x16_bf16 v[168:183], v[216:219], v[60:63], v[168:183]
    ds_read_b64_tr_b16 v[240:241], v54 offset:0
    ds_read_b64_tr_b16 v[242:243], v55 offset:0
    s_waitcnt lgkmcnt(13)
    v_mfma_f32_32x32x16_bf16 v[136:151], v[220:223], v[64:67], v[136:151]
    ds_read_b128 v[60:63], v75 offset:0
    ds_read_b64_tr_b16 v[208:209], v92 offset:6144
    ds_read_b64_tr_b16 v[210:211], v92 offset:6912
    s_waitcnt lgkmcnt(13)
    v_mfma_f32_32x32x16_bf16 v[152:167], v[224:227], v[64:67], v[152:167]
    ds_read_b64_tr_b16 v[212:213], v52 offset:6144
    ds_read_b64_tr_b16 v[214:215], v53 offset:6144
    s_mov_b64 exec, s[82:83]
    ds_read_b128 v[212:215], v98 offset:1120
    s_mov_b64 exec, -1
    s_waitcnt lgkmcnt(14)
    v_mfma_f32_32x32x16_bf16 v[168:183], v[228:231], v[64:67], v[168:183]
    ds_read_b64_tr_b16 v[216:217], v54 offset:6144
    ds_read_b64_tr_b16 v[218:219], v55 offset:6144
    s_waitcnt lgkmcnt(13)
    v_mfma_f32_32x32x16_bf16 v[136:151], v[232:235], v[68:71], v[136:151]
    s_barrier
    ds_read_b128 v[64:67], v72 offset:8192
    ds_read_b64_tr_b16 v[220:221], v92 offset:12288
    ds_read_b64_tr_b16 v[222:223], v92 offset:13056
    s_waitcnt lgkmcnt(13)
    v_mfma_f32_32x32x16_bf16 v[152:167], v[236:239], v[68:71], v[152:167]
    ds_read_b64_tr_b16 v[224:225], v52 offset:12288
    ds_read_b64_tr_b16 v[226:227], v53 offset:12288
    s_mov_b64 exec, s[82:83]
    ds_read_b128 v[224:227], v98 offset:1152
    s_mov_b64 exec, -1
    s_waitcnt lgkmcnt(14)
    v_mfma_f32_32x32x16_bf16 v[168:183], v[240:243], v[68:71], v[168:183]
    ds_read_b64_tr_b16 v[228:229], v54 offset:12288
    ds_read_b64_tr_b16 v[230:231], v55 offset:12288
    s_waitcnt lgkmcnt(13)
    v_mfma_f32_32x32x16_bf16 v[136:151], v[208:211], v[60:63], v[136:151]
    ds_read_b128 v[68:71], v73 offset:8192
    ds_read_b64_tr_b16 v[232:233], v92 offset:18432
    ds_read_b64_tr_b16 v[234:235], v92 offset:19200
    s_waitcnt lgkmcnt(13)
    v_mfma_f32_32x32x16_bf16 v[152:167], v[212:215], v[60:63], v[152:167]
    ds_read_b64_tr_b16 v[236:237], v52 offset:18432
    ds_read_b64_tr_b16 v[238:239], v53 offset:18432
    s_mov_b64 exec, s[82:83]
    ds_read_b128 v[236:239], v98 offset:1184
    s_mov_b64 exec, -1
    s_waitcnt lgkmcnt(14)
    v_mfma_f32_32x32x16_bf16 v[168:183], v[216:219], v[60:63], v[168:183]
    ds_read_b64_tr_b16 v[240:241], v54 offset:18432
    ds_read_b64_tr_b16 v[242:243], v55 offset:18432
    s_waitcnt lgkmcnt(13)
    v_mfma_f32_32x32x16_bf16 v[136:151], v[220:223], v[64:67], v[136:151]
    s_barrier
    ds_read_b128 v[60:63], v74 offset:8192
    ds_read_b64_tr_b16 v[208:209], v92 offset:24576
    ds_read_b64_tr_b16 v[210:211], v92 offset:25344
    s_waitcnt lgkmcnt(13)
    v_mfma_f32_32x32x16_bf16 v[152:167], v[224:227], v[64:67], v[152:167]
    ds_read_b64_tr_b16 v[212:213], v52 offset:24576
    ds_read_b64_tr_b16 v[214:215], v53 offset:24576
    s_mov_b64 exec, s[82:83]
    ds_read_b128 v[212:215], v98 offset:1216
    s_mov_b64 exec, -1
    s_waitcnt lgkmcnt(14)
    v_mfma_f32_32x32x16_bf16 v[168:183], v[228:231], v[64:67], v[168:183]
    ds_read_b64_tr_b16 v[216:217], v54 offset:24576
    ds_read_b64_tr_b16 v[218:219], v55 offset:24576
    s_waitcnt lgkmcnt(13)
    v_mfma_f32_32x32x16_bf16 v[136:151], v[232:235], v[68:71], v[136:151]
    ds_read_b128 v[64:67], v75 offset:8192
    ds_read_b64_tr_b16 v[220:221], v92 offset:30720
    ds_read_b64_tr_b16 v[222:223], v92 offset:31488
    s_waitcnt lgkmcnt(13)
    v_mfma_f32_32x32x16_bf16 v[152:167], v[236:239], v[68:71], v[152:167]
    ds_read_b64_tr_b16 v[224:225], v52 offset:30720
    ds_read_b64_tr_b16 v[226:227], v53 offset:30720
    s_mov_b64 exec, s[82:83]
    ds_read_b128 v[224:227], v98 offset:1248
    s_mov_b64 exec, -1
    s_waitcnt lgkmcnt(14)
    v_mfma_f32_32x32x16_bf16 v[168:183], v[240:243], v[68:71], v[168:183]
    ds_read_b64_tr_b16 v[228:229], v54 offset:30720
    ds_read_b64_tr_b16 v[230:231], v55 offset:30720
    s_waitcnt lgkmcnt(13)
    v_mfma_f32_32x32x16_bf16 v[136:151], v[208:211], v[60:63], v[136:151]
    s_waitcnt lgkmcnt(10)
    v_mfma_f32_32x32x16_bf16 v[152:167], v[212:215], v[60:63], v[152:167]
    s_waitcnt lgkmcnt(8)
    v_mfma_f32_32x32x16_bf16 v[168:183], v[216:219], v[60:63], v[168:183]
    s_waitcnt lgkmcnt(2)
    v_mfma_f32_32x32x16_bf16 v[152:167], v[224:227], v[64:67], v[152:167]
    s_waitcnt lgkmcnt(0)
    v_mfma_f32_32x32x16_bf16 v[168:183], v[228:231], v[64:67], v[168:183]
    v_mfma_f32_32x32x16_bf16 v[136:151], v[220:223], v[64:67], v[136:151]
    s_nop 8
    v_cvt_pk_bf16_f32 v76, v152, v153
    v_cvt_pk_bf16_f32 v77, v154, v155
    v_cvt_pk_bf16_f32 v78, v156, v157
    v_cvt_pk_bf16_f32 v79, v158, v159
    ds_write_b128 v99, v[76:79] offset:0
    v_cvt_pk_bf16_f32 v80, v168, v169
    v_cvt_pk_bf16_f32 v81, v170, v171
    v_cvt_pk_bf16_f32 v82, v172, v173
    v_cvt_pk_bf16_f32 v83, v174, v175
    ds_write_b128 v99, v[80:83] offset:1024
    s_mov_b32 exec_hi, 0
    v_cvt_pk_bf16_f32 v84, v160, v161
    v_cvt_pk_bf16_f32 v85, v162, v163
    v_cvt_pk_bf16_f32 v86, v176, v177
    v_cvt_pk_bf16_f32 v87, v178, v179
    s_mov_b32 exec_hi, -1
    ds_write_b128 v99, v[84:87] offset:2048
    v_mul_f32 v190, 0xbfb8aa3b, v160
    v_mov_b32 v186, 0xc0135761
    s_mov_b32 s82, 0xbdd2d3e8
    s_mov_b32 s83, s82
    v_pk_mul_f32 v[104:105], v[136:137], v[136:137]
    v_pk_mul_f32 v[106:107], v[138:139], v[138:139]
    v_pk_mul_f32 v[108:109], v[140:141], v[140:141]
    v_pk_mul_f32 v[110:111], v[142:143], v[142:143]
    v_pk_fma_f32 v[104:105], v[104:105], s[82:83], v[186:187] op_sel_hi:[1,1,0]
    v_pk_fma_f32 v[106:107], v[106:107], s[82:83], v[186:187] op_sel_hi:[1,1,0]
    v_pk_fma_f32 v[108:109], v[108:109], s[82:83], v[186:187] op_sel_hi:[1,1,0]
    v_pk_fma_f32 v[110:111], v[110:111], s[82:83], v[186:187] op_sel_hi:[1,1,0]
    v_pk_mul_f32 v[104:105], v[104:105], v[136:137]
    v_pk_mul_f32 v[106:107], v[106:107], v[138:139]
    v_pk_mul_f32 v[108:109], v[108:109], v[140:141]
    v_pk_mul_f32 v[110:111], v[110:111], v[142:143]
    v_exp_f32 v104, v104
    v_exp_f32 v105, v105
    v_exp_f32 v106, v106
    v_exp_f32 v107, v107
    v_exp_f32 v108, v108
    v_exp_f32 v109, v109
    v_exp_f32 v110, v110
    v_exp_f32 v111, v111
    v_pk_add_f32 v[104:105], 1.0, v[104:105] op_sel_hi:[0,1]
    v_pk_add_f32 v[106:107], 1.0, v[106:107] op_sel_hi:[0,1]
    v_pk_add_f32 v[108:109], 1.0, v[108:109] op_sel_hi:[0,1]
    v_pk_add_f32 v[110:111], 1.0, v[110:111] op_sel_hi:[0,1]
    v_rcp_f32 v104, v104
    v_rcp_f32 v105, v105
    v_rcp_f32 v106, v106
    v_rcp_f32 v107, v107
    v_rcp_f32 v108, v108
    v_rcp_f32 v109, v109
    v_rcp_f32 v110, v110
    v_rcp_f32 v111, v111
    v_pk_mul_f32 v[136:137], v[136:137], v[104:105]
    v_pk_mul_f32 v[138:139], v[138:139], v[106:107]
    v_pk_mul_f32 v[140:141], v[140:141], v[108:109]
    v_pk_mul_f32 v[142:143], v[142:143], v[110:111]
    v_cvt_pk_bf16_f32 v112, v136, v137
    v_cvt_pk_bf16_f32 v113, v138, v139
    v_cvt_pk_bf16_f32 v114, v140, v141
    v_cvt_pk_bf16_f32 v115, v142, v143
    ds_write_b128 v197, v[112:115] offset:0
    v_pk_mul_f32 v[104:105], v[144:145], v[144:145]
    v_pk_mul_f32 v[106:107], v[146:147], v[146:147]
    v_pk_mul_f32 v[108:109], v[148:149], v[148:149]
    v_pk_mul_f32 v[110:111], v[150:151], v[150:151]
    v_pk_fma_f32 v[104:105], v[104:105], s[82:83], v[186:187] op_sel_hi:[1,1,0]
    v_pk_fma_f32 v[106:107], v[106:107], s[82:83], v[186:187] op_sel_hi:[1,1,0]
    v_pk_fma_f32 v[108:109], v[108:109], s[82:83], v[186:187] op_sel_hi:[1,1,0]
    v_pk_fma_f32 v[110:111], v[110:111], s[82:83], v[186:187] op_sel_hi:[1,1,0]
    v_pk_mul_f32 v[104:105], v[104:105], v[144:145]
    v_pk_mul_f32 v[106:107], v[106:107], v[146:147]
    v_pk_mul_f32 v[108:109], v[108:109], v[148:149]
    v_pk_mul_f32 v[110:111], v[110:111], v[150:151]
    v_exp_f32 v104, v104
    v_exp_f32 v105, v105
    v_exp_f32 v106, v106
    v_exp_f32 v107, v107
    v_exp_f32 v108, v108
    v_exp_f32 v109, v109
    v_exp_f32 v110, v110
    v_exp_f32 v111, v111
    v_pk_add_f32 v[104:105], 1.0, v[104:105] op_sel_hi:[0,1]
    v_pk_add_f32 v[106:107], 1.0, v[106:107] op_sel_hi:[0,1]
    v_pk_add_f32 v[108:109], 1.0, v[108:109] op_sel_hi:[0,1]
    v_pk_add_f32 v[110:111], 1.0, v[110:111] op_sel_hi:[0,1]
    v_rcp_f32 v104, v104
    v_rcp_f32 v105, v105
    v_rcp_f32 v106, v106
    v_rcp_f32 v107, v107
    v_rcp_f32 v108, v108
    v_rcp_f32 v109, v109
    v_rcp_f32 v110, v110
    v_rcp_f32 v111, v111
    v_pk_mul_f32 v[144:145], v[144:145], v[104:105]
    v_pk_mul_f32 v[146:147], v[146:147], v[106:107]
    v_pk_mul_f32 v[148:149], v[148:149], v[108:109]
    v_pk_mul_f32 v[150:151], v[150:151], v[110:111]
    v_cvt_pk_bf16_f32 v116, v144, v145
    v_cvt_pk_bf16_f32 v117, v146, v147
    v_cvt_pk_bf16_f32 v118, v148, v149
    v_cvt_pk_bf16_f32 v119, v150, v151
    ds_write_b128 v197, v[116:119] offset:1024
    v_pk_mul_f32 v[104:105], v[164:165], v[164:165]
    v_pk_mul_f32 v[106:107], v[166:167], v[166:167]
    v_pk_mul_f32 v[108:109], v[180:181], v[180:181]
    v_pk_mul_f32 v[110:111], v[182:183], v[182:183]
    v_pk_fma_f32 v[104:105], v[104:105], s[82:83], v[186:187] op_sel_hi:[1,1,0]
    v_pk_fma_f32 v[106:107], v[106:107], s[82:83], v[186:187] op_sel_hi:[1,1,0]
    v_pk_fma_f32 v[108:109], v[108:109], s[82:83], v[186:187] op_sel_hi:[1,1,0]
    v_pk_fma_f32 v[110:111], v[110:111], s[82:83], v[186:187] op_sel_hi:[1,1,0]
    v_pk_mul_f32 v[104:105], v[104:105], v[164:165]
    v_pk_mul_f32 v[106:107], v[106:107], v[166:167]
    v_pk_mul_f32 v[108:109], v[108:109], v[180:181]
    v_pk_mul_f32 v[110:111], v[110:111], v[182:183]
    v_exp_f32 v104, v104
    v_exp_f32 v105, v105
    v_exp_f32 v106, v106
    v_exp_f32 v107, v107
    v_exp_f32 v108, v108
    v_exp_f32 v109, v109
    v_exp_f32 v110, v110
    v_exp_f32 v111, v111
    v_pk_add_f32 v[104:105], 1.0, v[104:105] op_sel_hi:[0,1]
    v_pk_add_f32 v[106:107], 1.0, v[106:107] op_sel_hi:[0,1]
    v_pk_add_f32 v[108:109], 1.0, v[108:109] op_sel_hi:[0,1]
    v_pk_add_f32 v[110:111], 1.0, v[110:111] op_sel_hi:[0,1]
    v_rcp_f32 v104, v104
    v_rcp_f32 v105, v105
    v_rcp_f32 v106, v106
    v_rcp_f32 v107, v107
    v_rcp_f32 v108, v108
    v_rcp_f32 v109, v109
    v_rcp_f32 v110, v110
    v_rcp_f32 v111, v111
    v_pk_mul_f32 v[164:165], v[164:165], v[104:105]
    v_pk_mul_f32 v[166:167], v[166:167], v[106:107]
    v_pk_mul_f32 v[180:181], v[180:181], v[108:109]
    v_pk_mul_f32 v[182:183], v[182:183], v[110:111]
    v_cvt_pk_bf16_f32 v120, v164, v165
    v_cvt_pk_bf16_f32 v121, v166, v167
    v_cvt_pk_bf16_f32 v122, v180, v181
    v_cvt_pk_bf16_f32 v123, v182, v183
    ds_write_b128 v197, v[120:123] offset:2048
    s_waitcnt lgkmcnt(3)
    s_barrier
    ds_read_b128 v[88:91], v1 offset:24576
    ds_read_b128 v[92:95], v2 offset:28672
    ds_read_b128 v[96:99], v3 offset:29696
    v_mov_b32 v254, 0xdddddddd
    v_mov_b32 v44, 0
    v_mov_b32 v45, 0
    v_mov_b32 v46, 0
    v_mov_b32 v47, 0
    v_mov_b32 v48, 0
    v_mov_b32 v49, 0
    v_mov_b32 v50, 0
    v_mov_b32 v51, 0
    v_mov_b32 v52, 0
    v_mov_b32 v53, 0
    v_mov_b32 v54, 0
    v_mov_b32 v55, 0
    v_mov_b32 v56, 0
    v_mov_b32 v57, 0
    v_mov_b32 v58, 0
    v_mov_b32 v59, 0
    s_waitcnt lgkmcnt(1)
    v_mfma_f32_32x32x16_bf16 v[12:27], v[88:91], v[76:79], 0
    v_mfma_f32_32x32x8bf16_1k v[12:27], v[92:93], v[84:85], v[12:27]
    v_mov_b32 v60, 0
    v_mov_b32 v61, 0
    v_mov_b32 v62, 0
    v_mov_b32 v63, 0
    v_mov_b32 v64, 0
    v_mov_b32 v65, 0
    v_mov_b32 v66, 0
    v_mov_b32 v67, 0
    v_mov_b32 v68, 0
    v_mov_b32 v69, 0
    v_mov_b32 v70, 0
    v_mov_b32 v71, 0
    v_mov_b32 v72, 0
    v_mov_b32 v73, 0
    v_mov_b32 v74, 0
    v_mov_b32 v75, 0
    v_exp_f32 v12, v12
    v_mov_b32 v189, v190
    v_exp_f32 v13, v13
    ds_read_b128 v[100:103], v3 offset:30464
    s_nop 0
    v_permlane32_swap_b32 v189, v190
    v_exp_f32 v14, v14
    s_add_u32 m0, s68, 0
    s_add_u32 s72, s69, s71
    buffer_load_dwordx4 v9, s[60:63], s72 offen offset:0  lds
    v_exp_f32 v15, v15
    v_exp_f32 v190, v190
    v_mfma_f32_32x32x16_bf16 v[28:43], v[88:91], v[80:83], 0
    ds_read_b128 v[88:91], v1 offset:25600
    v_exp_f32 v16, v16
    v_add_f32 v190, 1.0, v190
    v_mfma_f32_32x32x8bf16_1k v[28:43], v[92:93], v[86:87], v[28:43]
    v_exp_f32 v17, v17
    v_rcp_f32 v190, v190
    v_exp_f32 v18, v18
    v_exp_f32 v19, v19
    ds_write_b32 v197, v190 offset:3072
    v_exp_f32 v20, v20
    v_exp_f32 v21, v21
    s_waitcnt lgkmcnt(3)
    v_smfmac_f32_32x32x32_bf16 v[44:59], v[96:99], v[12:19], v254
    buffer_load_dwordx4 v10, s[60:63], s72 offen offset:1024  lds
    v_exp_f32 v22, v22
    v_exp_f32 v23, v23
    v_exp_f32 v24, v24
    v_exp_f32 v25, v25
    v_exp_f32 v26, v26
    v_exp_f32 v27, v27
    v_exp_f32 v28, v28
    v_exp_f32 v29, v29
    s_waitcnt lgkmcnt(2)
    v_smfmac_f32_32x32x32_bf16 v[44:59], v[100:103], v[20:27], v254
    v_exp_f32 v30, v30
    v_exp_f32 v31, v31
    buffer_load_dwordx4 v11, s[60:63], s72 offen offset:2048  lds
    s_waitcnt lgkmcnt(1)
    v_mfma_f32_32x32x16_bf16 v[12:27], v[88:91], v[76:79], 0
    v_exp_f32 v32, v32
    v_mfma_f32_32x32x8bf16_1k v[12:27], v[94:95], v[84:85], v[12:27]
    v_exp_f32 v33, v33
    v_exp_f32 v34, v34
    v_exp_f32 v35, v35
    v_exp_f32 v36, v36
    v_exp_f32 v37, v37
    v_smfmac_f32_32x32x32_bf16 v[60:75], v[96:99], v[28:35], v254
    ds_read_b128 v[96:99], v3 offset:31232
    v_exp_f32 v38, v38
    buffer_load_dwordx4 v252, s[60:63], s72 offen offset:3072  lds
    v_exp_f32 v39, v39
    v_exp_f32 v40, v40
    v_exp_f32 v41, v41
    v_exp_f32 v42, v42
    v_exp_f32 v43, v43
    v_exp_f32 v12, v12
    v_exp_f32 v13, v13
    v_smfmac_f32_32x32x32_bf16 v[60:75], v[100:103], v[36:43], v254
    ds_read_b128 v[100:103], v3 offset:32000
    v_exp_f32 v14, v14
    v_exp_f32 v15, v15
    v_mfma_f32_32x32x16_bf16 v[28:43], v[88:91], v[80:83], 0
    s_add_u32 m0, s68, 4096
    s_add_u32 s72, s70, s71
    buffer_load_dwordx4 v9, s[60:63], s72 offen offset:0  lds
    v_exp_f32 v16, v16
    v_mfma_f32_32x32x8bf16_1k v[28:43], v[94:95], v[86:87], v[28:43]
    v_exp_f32 v17, v17
    v_exp_f32 v18, v18
    v_exp_f32 v19, v19
    v_exp_f32 v20, v20
    v_exp_f32 v21, v21
    s_waitcnt lgkmcnt(1)
    v_smfmac_f32_32x32x32_bf16 v[44:59], v[96:99], v[12:19], v254
    v_exp_f32 v22, v22
    v_exp_f32 v23, v23
    buffer_load_dwordx4 v10, s[60:63], s72 offen offset:1024  lds
    v_exp_f32 v24, v24
    v_exp_f32 v25, v25
    v_exp_f32 v26, v26
    v_exp_f32 v27, v27
    s_waitcnt lgkmcnt(0)
    s_barrier
    ds_read_b128 v[88:91], v1 offset:0
    ds_read_b128 v[92:95], v2 offset:4096
    v_exp_f32 v28, v28
    v_exp_f32 v29, v29
    v_smfmac_f32_32x32x32_bf16 v[44:59], v[100:103], v[20:27], v254
    v_exp_f32 v30, v30
    v_exp_f32 v31, v31
    s_waitcnt lgkmcnt(1)
    v_mfma_f32_32x32x16_bf16 v[12:27], v[88:91], v[76:79], 0
    buffer_load_dwordx4 v11, s[60:63], s72 offen offset:2048  lds
    v_exp_f32 v32, v32
    s_waitcnt lgkmcnt(0)
    v_mfma_f32_32x32x8bf16_1k v[12:27], v[92:93], v[84:85], v[12:27]
    v_exp_f32 v33, v33
    v_exp_f32 v34, v34
    v_exp_f32 v35, v35
    v_exp_f32 v36, v36
    v_exp_f32 v37, v37
    v_smfmac_f32_32x32x32_bf16 v[60:75], v[96:99], v[28:35], v254
    ds_read_b128 v[96:99], v3 offset:5120
    v_exp_f32 v38, v38
    v_exp_f32 v39, v39
    v_exp_f32 v40, v40
    v_exp_f32 v41, v41
    v_exp_f32 v42, v42
    v_exp_f32 v43, v43
    buffer_load_dwordx4 v252, s[60:63], s72 offen offset:3072  lds
    s_add_u32 s71, s71, 128
    s_and_b32 s71, s71, 0x3ff
    v_exp_f32 v12, v12
    v_exp_f32 v13, v13
    v_smfmac_f32_32x32x32_bf16 v[60:75], v[100:103], v[36:43], v254
    ds_read_b128 v[100:103], v3 offset:5888
    v_exp_f32 v14, v14
    v_exp_f32 v15, v15
    v_mfma_f32_32x32x16_bf16 v[28:43], v[88:91], v[80:83], 0
    ds_read_b128 v[88:91], v1 offset:1024
    v_exp_f32 v16, v16
    v_mfma_f32_32x32x8bf16_1k v[28:43], v[92:93], v[86:87], v[28:43]
    v_exp_f32 v17, v17
    v_exp_f32 v18, v18
    v_exp_f32 v19, v19
    v_exp_f32 v20, v20
    v_exp_f32 v21, v21
    s_waitcnt lgkmcnt(2)
    v_smfmac_f32_32x32x32_bf16 v[44:59], v[96:99], v[12:19], v254
    s_add_u32 m0, s68, 8192
    s_add_u32 s72, s69, s71
    buffer_load_dwordx4 v9, s[60:63], s72 offen offset:0  lds
    v_exp_f32 v22, v22
    v_exp_f32 v23, v23
    v_exp_f32 v24, v24
    v_exp_f32 v25, v25
    v_exp_f32 v26, v26
    v_exp_f32 v27, v27
    v_exp_f32 v28, v28
    v_exp_f32 v29, v29
    s_waitcnt lgkmcnt(1)
    v_smfmac_f32_32x32x32_bf16 v[44:59], v[100:103], v[20:27], v254
    v_exp_f32 v30, v30
    v_exp_f32 v31, v31
    s_waitcnt lgkmcnt(0)
    v_mfma_f32_32x32x16_bf16 v[12:27], v[88:91], v[76:79], 0
    v_exp_f32 v32, v32
    v_mfma_f32_32x32x8bf16_1k v[12:27], v[94:95], v[84:85], v[12:27]
    buffer_load_dwordx4 v10, s[60:63], s72 offen offset:1024  lds
    v_exp_f32 v33, v33
    v_exp_f32 v34, v34
    v_exp_f32 v35, v35
    v_exp_f32 v36, v36
    v_exp_f32 v37, v37
    v_smfmac_f32_32x32x32_bf16 v[60:75], v[96:99], v[28:35], v254
    ds_read_b128 v[96:99], v3 offset:6656
    v_exp_f32 v38, v38
    v_exp_f32 v39, v39
    v_exp_f32 v40, v40
    v_exp_f32 v41, v41
    v_exp_f32 v42, v42
    v_exp_f32 v43, v43
    v_exp_f32 v12, v12
    v_exp_f32 v13, v13
    buffer_load_dwordx4 v11, s[60:63], s72 offen offset:2048  lds
    v_smfmac_f32_32x32x32_bf16 v[60:75], v[100:103], v[36:43], v254
    ds_read_b128 v[100:103], v3 offset:7424
    v_exp_f32 v14, v14
    v_exp_f32 v15, v15
    v_mfma_f32_32x32x16_bf16 v[28:43], v[88:91], v[80:83], 0
    v_exp_f32 v16, v16
    v_mfma_f32_32x32x8bf16_1k v[28:43], v[94:95], v[86:87], v[28:43]
    v_exp_f32 v17, v17
    v_exp_f32 v18, v18
    v_exp_f32 v19, v19
    v_exp_f32 v20, v20
    v_exp_f32 v21, v21
    s_waitcnt lgkmcnt(1)
    v_smfmac_f32_32x32x32_bf16 v[44:59], v[96:99], v[12:19], v254
    v_exp_f32 v22, v22
    v_exp_f32 v23, v23
    buffer_load_dwordx4 v252, s[60:63], s72 offen offset:3072  lds
    v_exp_f32 v24, v24
    v_exp_f32 v25, v25
    v_exp_f32 v26, v26
    v_exp_f32 v27, v27
    s_waitcnt lgkmcnt(0)
    s_barrier
    ds_read_b128 v[88:91], v1 offset:12288
    ds_read_b128 v[92:95], v2 offset:16384
    v_exp_f32 v28, v28
    v_exp_f32 v29, v29
    v_smfmac_f32_32x32x32_bf16 v[44:59], v[100:103], v[20:27], v254
    v_exp_f32 v30, v30
    v_exp_f32 v31, v31
    s_waitcnt lgkmcnt(1)
    v_mfma_f32_32x32x16_bf16 v[12:27], v[88:91], v[76:79], 0
    v_exp_f32 v32, v32
    s_add_u32 m0, s68, 12288
    s_add_u32 s72, s70, s71
    buffer_load_dwordx4 v9, s[60:63], s72 offen offset:0  lds
    s_waitcnt lgkmcnt(0)
    v_mfma_f32_32x32x8bf16_1k v[12:27], v[92:93], v[84:85], v[12:27]
    v_exp_f32 v33, v33
    v_exp_f32 v34, v34
    v_exp_f32 v35, v35
    v_exp_f32 v36, v36
    v_exp_f32 v37, v37
    v_smfmac_f32_32x32x32_bf16 v[60:75], v[96:99], v[28:35], v254
    ds_read_b128 v[96:99], v3 offset:17408
    v_exp_f32 v38, v38
    v_exp_f32 v39, v39
    v_exp_f32 v40, v40
    v_exp_f32 v41, v41
    v_exp_f32 v42, v42
    v_exp_f32 v43, v43
    v_exp_f32 v12, v12
    buffer_load_dwordx4 v10, s[60:63], s72 offen offset:1024  lds
    v_exp_f32 v13, v13
    v_smfmac_f32_32x32x32_bf16 v[60:75], v[100:103], v[36:43], v254
    ds_read_b128 v[100:103], v3 offset:18176
    v_exp_f32 v14, v14
    v_exp_f32 v15, v15
    v_mfma_f32_32x32x16_bf16 v[28:43], v[88:91], v[80:83], 0
    ds_read_b128 v[88:91], v1 offset:13312
    v_exp_f32 v16, v16
    v_mfma_f32_32x32x8bf16_1k v[28:43], v[92:93], v[86:87], v[28:43]
    v_exp_f32 v17, v17
    v_exp_f32 v18, v18
    v_exp_f32 v19, v19
    v_exp_f32 v20, v20
    v_exp_f32 v21, v21
    s_waitcnt lgkmcnt(2)
    v_smfmac_f32_32x32x32_bf16 v[44:59], v[96:99], v[12:19], v254
    v_exp_f32 v22, v22
    buffer_load_dwordx4 v11, s[60:63], s72 offen offset:2048  lds
    v_exp_f32 v23, v23
    v_exp_f32 v24, v24
    v_exp_f32 v25, v25
    v_exp_f32 v26, v26
    v_exp_f32 v27, v27
    v_exp_f32 v28, v28
    v_exp_f32 v29, v29
    s_waitcnt lgkmcnt(1)
    v_smfmac_f32_32x32x32_bf16 v[44:59], v[100:103], v[20:27], v254
    v_exp_f32 v30, v30
    v_exp_f32 v31, v31
    s_waitcnt lgkmcnt(0)
    v_mfma_f32_32x32x16_bf16 v[12:27], v[88:91], v[76:79], 0
    v_exp_f32 v32, v32
    v_mfma_f32_32x32x8bf16_1k v[12:27], v[94:95], v[84:85], v[12:27]
    v_exp_f32 v33, v33
    buffer_load_dwordx4 v252, s[60:63], s72 offen offset:3072  lds
    s_add_u32 s71, s71, 128
    s_and_b32 s71, s71, 0x3ff
    v_exp_f32 v34, v34
    v_exp_f32 v35, v35
    v_exp_f32 v36, v36
    v_exp_f32 v37, v37
    v_smfmac_f32_32x32x32_bf16 v[60:75], v[96:99], v[28:35], v254
    ds_read_b128 v[96:99], v3 offset:18944
    v_exp_f32 v38, v38
    v_exp_f32 v39, v39
    v_exp_f32 v40, v40
    v_exp_f32 v41, v41
    v_exp_f32 v42, v42
    v_exp_f32 v43, v43
    v_exp_f32 v12, v12
    v_exp_f32 v13, v13
    v_smfmac_f32_32x32x32_bf16 v[60:75], v[100:103], v[36:43], v254
    ds_read_b128 v[100:103], v3 offset:19712
    v_exp_f32 v14, v14
    v_exp_f32 v15, v15
    v_mfma_f32_32x32x16_bf16 v[28:43], v[88:91], v[80:83], 0
    v_exp_f32 v16, v16
    v_mfma_f32_32x32x8bf16_1k v[28:43], v[94:95], v[86:87], v[28:43]
    v_exp_f32 v17, v17
    v_exp_f32 v18, v18
    v_exp_f32 v19, v19
    v_exp_f32 v20, v20
    v_exp_f32 v21, v21
    s_waitcnt lgkmcnt(1)
    v_smfmac_f32_32x32x32_bf16 v[44:59], v[96:99], v[12:19], v254
    v_exp_f32 v22, v22
    v_exp_f32 v23, v23
    v_exp_f32 v24, v24
    v_exp_f32 v25, v25
    v_exp_f32 v26, v26
    v_exp_f32 v27, v27
    s_waitcnt lgkmcnt(0)
    s_barrier
    ds_read_b128 v[88:91], v1 offset:24576
    ds_read_b128 v[92:95], v2 offset:28672
    v_exp_f32 v28, v28
    v_exp_f32 v29, v29
    v_smfmac_f32_32x32x32_bf16 v[44:59], v[100:103], v[20:27], v254
    v_exp_f32 v30, v30
    v_exp_f32 v31, v31
    s_waitcnt lgkmcnt(1)
    v_mfma_f32_32x32x16_bf16 v[12:27], v[88:91], v[76:79], 0
    v_exp_f32 v32, v32
    buffer_load_dword v204, v253, s[36:39], s76 offen sc1
    s_waitcnt lgkmcnt(0)
    v_mfma_f32_32x32x8bf16_1k v[12:27], v[92:93], v[84:85], v[12:27]
    v_exp_f32 v33, v33
    v_exp_f32 v34, v34
    v_exp_f32 v35, v35
    v_exp_f32 v36, v36
    v_exp_f32 v37, v37
    v_smfmac_f32_32x32x32_bf16 v[60:75], v[96:99], v[28:35], v254
    ds_read_b128 v[96:99], v3 offset:29696
    v_exp_f32 v38, v38
    v_exp_f32 v39, v39
    v_exp_f32 v40, v40
    v_exp_f32 v41, v41
    v_exp_f32 v42, v42
    v_exp_f32 v43, v43
    v_exp_f32 v12, v12
    v_exp_f32 v13, v13
    v_smfmac_f32_32x32x32_bf16 v[60:75], v[100:103], v[36:43], v254
    ds_read_b128 v[100:103], v3 offset:30464
    v_exp_f32 v14, v14
    v_exp_f32 v15, v15
    v_mfma_f32_32x32x16_bf16 v[28:43], v[88:91], v[80:83], 0
    ds_read_b128 v[88:91], v1 offset:25600
    v_exp_f32 v16, v16
    v_mfma_f32_32x32x8bf16_1k v[28:43], v[92:93], v[86:87], v[28:43]
    v_exp_f32 v17, v17
    v_exp_f32 v18, v18
    v_exp_f32 v19, v19
    v_exp_f32 v20, v20
    v_exp_f32 v21, v21
    s_waitcnt lgkmcnt(2)
    v_smfmac_f32_32x32x32_bf16 v[44:59], v[96:99], v[12:19], v254
    v_exp_f32 v22, v22
    v_exp_f32 v23, v23
    v_exp_f32 v24, v24
    v_exp_f32 v25, v25
    v_exp_f32 v26, v26
    v_exp_f32 v27, v27
    v_exp_f32 v28, v28
    v_exp_f32 v29, v29
gated_mix__grouped_kv_mqa__mixer_gmlp__prompt_kernel_poll:
    s_waitcnt vmcnt(0)
    v_cmp_ne_u32 vcc, s59, v204
    s_cbranch_vccnz gated_mix__grouped_kv_mqa__mixer_gmlp__prompt_kernel_pretry
gated_mix__grouped_kv_mqa__mixer_gmlp__prompt_kernel_pok:
    s_waitcnt lgkmcnt(1)
    v_smfmac_f32_32x32x32_bf16 v[44:59], v[100:103], v[20:27], v254
    v_exp_f32 v30, v30
    v_exp_f32 v31, v31
    s_waitcnt lgkmcnt(0)
    v_mfma_f32_32x32x16_bf16 v[12:27], v[88:91], v[76:79], 0
    s_mul_i32 s75, s74, 96
    s_add_u32 s74, s74, 128
    s_add_u32 s75, s75, s73
    s_and_b32 s74, s74, 0x3ff
    buffer_load_dwordx4 v[208:211], v8, s[36:39], s75 offen offset:0 sc1
    v_exp_f32 v32, v32
    v_mfma_f32_32x32x8bf16_1k v[12:27], v[94:95], v[84:85], v[12:27]
    v_exp_f32 v33, v33
    v_exp_f32 v34, v34
    buffer_load_dwordx4 v[212:215], v8, s[36:39], s75 offen offset:256 sc1
    v_exp_f32 v35, v35
    v_exp_f32 v36, v36
    v_exp_f32 v37, v37
    v_smfmac_f32_32x32x32_bf16 v[60:75], v[96:99], v[28:35], v254
    ds_read_b128 v[96:99], v3 offset:31232
    buffer_load_dwordx4 v[216:219], v8, s[36:39], s75 offen offset:1024 sc1
    v_exp_f32 v38, v38
    v_exp_f32 v39, v39
    v_exp_f32 v40, v40
    v_exp_f32 v41, v41
    buffer_load_dwordx4 v[220:223], v8, s[36:39], s75 offen offset:1280 sc1
    v_exp_f32 v42, v42
    v_exp_f32 v43, v43
    v_exp_f32 v12, v12
    v_exp_f32 v13, v13
    buffer_load_dwordx4 v[224:227], v8, s[36:39], s75 offen offset:2048 sc1
    v_smfmac_f32_32x32x32_bf16 v[60:75], v[100:103], v[36:43], v254
    ds_read_b128 v[100:103], v3 offset:32000
    v_exp_f32 v14, v14
    v_exp_f32 v15, v15
    v_mfma_f32_32x32x16_bf16 v[28:43], v[88:91], v[80:83], 0
    buffer_load_dwordx4 v[228:231], v8, s[36:39], s75 offen offset:2304 sc1
    v_exp_f32 v16, v16
    v_mfma_f32_32x32x8bf16_1k v[28:43], v[94:95], v[86:87], v[28:43]
    v_exp_f32 v17, v17
    v_exp_f32 v18, v18
    s_add_u32 s75, s75, 6144
    buffer_load_dwordx4 v[232:235], v8, s[36:39], s75 offen offset:0 sc1
    v_exp_f32 v19, v19
    v_exp_f32 v20, v20
    v_exp_f32 v21, v21
    s_waitcnt lgkmcnt(1)
    v_smfmac_f32_32x32x32_bf16 v[44:59], v[96:99], v[12:19], v254
    buffer_load_dwordx4 v[236:239], v8, s[36:39], s75 offen offset:256 sc1
    v_exp_f32 v22, v22
    v_exp_f32 v23, v23
    v_exp_f32 v24, v24
    v_exp_f32 v25, v25
    buffer_load_dwordx4 v[240:243], v8, s[36:39], s75 offen offset:1024 sc1
    v_exp_f32 v26, v26
    v_exp_f32 v27, v27
    s_waitcnt lgkmcnt(0)
    s_barrier
    ds_read_b128 v[88:91], v1 offset:0
    ds_read_b128 v[92:95], v2 offset:4096
    v_exp_f32 v28, v28
    v_exp_f32 v29, v29
    v_smfmac_f32_32x32x32_bf16 v[44:59], v[100:103], v[20:27], v254
    v_exp_f32 v30, v30
    v_exp_f32 v31, v31
    s_waitcnt lgkmcnt(1)
    v_mfma_f32_32x32x16_bf16 v[12:27], v[88:91], v[76:79], 0
    v_exp_f32 v32, v32
    s_waitcnt lgkmcnt(0)
    v_mfma_f32_32x32x8bf16_1k v[12:27], v[92:93], v[84:85], v[12:27]
    v_exp_f32 v33, v33
    v_exp_f32 v34, v34
    ds_read_b128 v[200:203], v4 offset:0
    v_exp_f32 v35, v35
    v_exp_f32 v36, v36
    ds_read_b128 v[204:207], v6 offset:0
    v_exp_f32 v37, v37
    v_smfmac_f32_32x32x32_bf16 v[60:75], v[96:99], v[28:35], v254
    ds_read_b128 v[96:99], v3 offset:5120
    ds_read_b128 v[244:247], v4 offset:4096
    v_exp_f32 v38, v38
    v_exp_f32 v39, v39
    v_exp_f32 v40, v40
    ds_read_b128 v[248:251], v6 offset:4096
    v_exp_f32 v41, v41
    v_exp_f32 v42, v42
    v_exp_f32 v43, v43
    s_waitcnt vmcnt(8) lgkmcnt(4)
    v_mfma_f32_16x16x32_bf16 v[104:107], v[208:211], v[200:203], 0
    s_waitcnt vmcnt(7)
    v_mfma_f32_16x16x32_bf16 v[108:111], v[212:215], v[200:203], 0
    v_exp_f32 v12, v12
    v_exp_f32 v13, v13
    v_smfmac_f32_32x32x32_bf16 v[60:75], v[100:103], v[36:43], v254
    ds_read_b128 v[100:103], v3 offset:5888
    v_mfma_f32_32x32x16_bf16 v[28:43], v[88:91], v[80:83], 0
    ds_read_b128 v[88:91], v1 offset:1024
    v_exp_f32 v14, v14
    v_exp_f32 v15, v15
    v_exp_f32 v16, v16
    v_exp_f32 v17, v17
    s_waitcnt lgkmcnt(5)
    v_mfma_f32_16x16x32_bf16 v[128:131], v[208:211], v[204:207], 0
    v_mfma_f32_16x16x32_bf16 v[132:135], v[212:215], v[204:207], 0
    v_mfma_f32_32x32x8bf16_1k v[28:43], v[92:93], v[86:87], v[28:43]
    v_exp_f32 v18, v18
    v_exp_f32 v19, v19
    v_exp_f32 v20, v20
    v_exp_f32 v21, v21
    s_waitcnt lgkmcnt(3)
    v_mfma_f32_16x16x32_bf16 v[152:155], v[208:211], v[244:247], 0
    v_mfma_f32_16x16x32_bf16 v[156:159], v[212:215], v[244:247], 0
    v_smfmac_f32_32x32x32_bf16 v[44:59], v[96:99], v[12:19], v254
    v_exp_f32 v22, v22
    v_exp_f32 v23, v23
    v_exp_f32 v24, v24
    v_exp_f32 v25, v25
    s_waitcnt lgkmcnt(2)
    v_mfma_f32_16x16x32_bf16 v[176:179], v[208:211], v[248:251], 0
    v_mfma_f32_16x16x32_bf16 v[180:183], v[212:215], v[248:251], 0
    buffer_load_dwordx4 v[208:211], v8, s[36:39], s75 offen offset:1280 sc1
    s_waitcnt vmcnt(7)
    v_mfma_f32_16x16x32_bf16 v[112:115], v[216:219], v[200:203], 0
    s_waitcnt vmcnt(6)
    v_mfma_f32_16x16x32_bf16 v[116:119], v[220:223], v[200:203], 0
    buffer_load_dwordx4 v[212:215], v8, s[36:39], s75 offen offset:2048 sc1
    v_exp_f32 v26, v26
    v_exp_f32 v27, v27
    v_mfma_f32_16x16x32_bf16 v[136:139], v[216:219], v[204:207], 0
    v_mfma_f32_16x16x32_bf16 v[140:143], v[220:223], v[204:207], 0
    v_exp_f32 v28, v28
    v_exp_f32 v29, v29
    s_waitcnt lgkmcnt(1)
    v_smfmac_f32_32x32x32_bf16 v[44:59], v[100:103], v[20:27], v254
    s_waitcnt lgkmcnt(0)
    v_mfma_f32_32x32x16_bf16 v[12:27], v[88:91], v[76:79], 0
    v_exp_f32 v30, v30
    v_exp_f32 v31, v31
    v_exp_f32 v32, v32
    v_exp_f32 v33, v33
    v_mfma_f32_16x16x32_bf16 v[160:163], v[216:219], v[244:247], 0
    v_mfma_f32_16x16x32_bf16 v[164:167], v[220:223], v[244:247], 0
    v_mfma_f32_32x32x8bf16_1k v[12:27], v[94:95], v[84:85], v[12:27]
    v_exp_f32 v34, v34
    v_exp_f32 v35, v35
    v_exp_f32 v36, v36
    v_exp_f32 v37, v37
    v_mfma_f32_16x16x32_bf16 v[184:187], v[216:219], v[248:251], 0
    v_mfma_f32_16x16x32_bf16 v[188:191], v[220:223], v[248:251], 0
    buffer_load_dwordx4 v[216:219], v8, s[36:39], s75 offen offset:2304 sc1
    v_smfmac_f32_32x32x32_bf16 v[60:75], v[96:99], v[28:35], v254
    ds_read_b128 v[96:99], v3 offset:6656
    v_exp_f32 v38, v38
    v_exp_f32 v39, v39
    v_exp_f32 v40, v40
    v_exp_f32 v41, v41
    s_waitcnt vmcnt(7)
    v_mfma_f32_16x16x32_bf16 v[120:123], v[224:227], v[200:203], 0
    s_waitcnt vmcnt(6)
    v_mfma_f32_16x16x32_bf16 v[124:127], v[228:231], v[200:203], 0
    ds_read_b128 v[200:203], v5 offset:0
    s_mul_i32 s75, s74, 96
    s_add_u32 s74, s74, 128
    s_add_u32 s75, s75, s73
    s_and_b32 s74, s74, 0x3ff
    buffer_load_dwordx4 v[220:223], v8, s[36:39], s75 offen offset:0 sc1
    v_mfma_f32_16x16x32_bf16 v[144:147], v[224:227], v[204:207], 0
    v_mfma_f32_16x16x32_bf16 v[148:151], v[228:231], v[204:207], 0
    ds_read_b128 v[204:207], v7 offset:0
    v_exp_f32 v42, v42
    v_exp_f32 v43, v43
    v_mfma_f32_16x16x32_bf16 v[168:171], v[224:227], v[244:247], 0
    v_mfma_f32_16x16x32_bf16 v[172:175], v[228:231], v[244:247], 0
    ds_read_b128 v[244:247], v5 offset:4096
    v_exp_f32 v12, v12
    v_exp_f32 v13, v13
    v_smfmac_f32_32x32x32_bf16 v[60:75], v[100:103], v[36:43], v254
    ds_read_b128 v[100:103], v3 offset:7424
    v_mfma_f32_32x32x16_bf16 v[28:43], v[88:91], v[80:83], 0
    v_exp_f32 v14, v14
    v_exp_f32 v15, v15
    v_exp_f32 v16, v16
    v_mfma_f32_16x16x32_bf16 v[192:195], v[224:227], v[248:251], 0
    v_mfma_f32_16x16x32_bf16 v[196:199], v[228:231], v[248:251], 0
    ds_read_b128 v[248:251], v7 offset:4096
    buffer_load_dwordx4 v[224:227], v8, s[36:39], s75 offen offset:256 sc1
    v_mfma_f32_32x32x8bf16_1k v[28:43], v[94:95], v[86:87], v[28:43]
    v_exp_f32 v17, v17
    v_exp_f32 v18, v18
    v_exp_f32 v19, v19
    v_exp_f32 v20, v20
    s_waitcnt vmcnt(7) lgkmcnt(4)
    v_mfma_f32_16x16x32_bf16 v[104:107], v[232:235], v[200:203], v[104:107]
    s_waitcnt vmcnt(6)
    v_mfma_f32_16x16x32_bf16 v[108:111], v[236:239], v[200:203], v[108:111]
    buffer_load_dwordx4 v[228:231], v8, s[36:39], s75 offen offset:1024 sc1
    v_exp_f32 v21, v21
    v_exp_f32 v22, v22
    s_waitcnt lgkmcnt(3)
    v_mfma_f32_16x16x32_bf16 v[128:131], v[232:235], v[204:207], v[128:131]
    v_mfma_f32_16x16x32_bf16 v[132:135], v[236:239], v[204:207], v[132:135]
    s_add_u32 m0, s68, 0
    s_add_u32 s72, s69, s71
    buffer_load_dwordx4 v9, s[60:63], s72 offen offset:0  lds
    v_smfmac_f32_32x32x32_bf16 v[44:59], v[96:99], v[12:19], v254
    v_exp_f32 v23, v23
    v_exp_f32 v24, v24
    v_exp_f32 v25, v25
    s_waitcnt lgkmcnt(2)
    v_mfma_f32_16x16x32_bf16 v[152:155], v[232:235], v[244:247], v[152:155]
    v_mfma_f32_16x16x32_bf16 v[156:159], v[236:239], v[244:247], v[156:159]
    s_waitcnt lgkmcnt(0)
    v_mfma_f32_16x16x32_bf16 v[176:179], v[232:235], v[248:251], v[176:179]
    v_mfma_f32_16x16x32_bf16 v[180:183], v[236:239], v[248:251], v[180:183]
    buffer_load_dwordx4 v[232:235], v8, s[36:39], s75 offen offset:1280 sc1
    v_exp_f32 v26, v26
    v_exp_f32 v27, v27
    s_barrier
    ds_read_b128 v[88:91], v1 offset:12288
    ds_read_b128 v[92:95], v2 offset:16384
    s_waitcnt vmcnt(8)
    v_mfma_f32_16x16x32_bf16 v[112:115], v[240:243], v[200:203], v[112:115]
    s_waitcnt vmcnt(7)
    v_mfma_f32_16x16x32_bf16 v[116:119], v[208:211], v[200:203], v[116:119]
    buffer_load_dwordx4 v[236:239], v8, s[36:39], s75 offen offset:2048 sc1
    v_exp_f32 v28, v28
    v_exp_f32 v29, v29
    v_smfmac_f32_32x32x32_bf16 v[44:59], v[100:103], v[20:27], v254
    s_waitcnt lgkmcnt(1)
    v_mfma_f32_32x32x16_bf16 v[12:27], v[88:91], v[76:79], 0
    v_exp_f32 v30, v30
    v_exp_f32 v31, v31
    v_exp_f32 v32, v32
    v_exp_f32 v33, v33
    v_mfma_f32_16x16x32_bf16 v[136:139], v[240:243], v[204:207], v[136:139]
    v_mfma_f32_16x16x32_bf16 v[140:143], v[208:211], v[204:207], v[140:143]
    buffer_load_dwordx4 v10, s[60:63], s72 offen offset:1024  lds
    s_waitcnt lgkmcnt(0)
    v_mfma_f32_32x32x8bf16_1k v[12:27], v[92:93], v[84:85], v[12:27]
    v_exp_f32 v34, v34
    v_exp_f32 v35, v35
    v_exp_f32 v36, v36
    v_exp_f32 v37, v37
    v_mfma_f32_16x16x32_bf16 v[160:163], v[240:243], v[244:247], v[160:163]
    v_mfma_f32_16x16x32_bf16 v[164:167], v[208:211], v[244:247], v[164:167]
    buffer_load_dwordx4 v11, s[60:63], s72 offen offset:2048  lds
    v_smfmac_f32_32x32x32_bf16 v[60:75], v[96:99], v[28:35], v254
    ds_read_b128 v[96:99], v3 offset:17408
    v_exp_f32 v38, v38
    v_exp_f32 v39, v39
    v_exp_f32 v40, v40
    v_exp_f32 v41, v41
    v_mfma_f32_16x16x32_bf16 v[184:187], v[240:243], v[248:251], v[184:187]
    v_mfma_f32_16x16x32_bf16 v[188:191], v[208:211], v[248:251], v[188:191]
    buffer_load_dwordx4 v[240:243], v8, s[36:39], s75 offen offset:2304 sc1
    s_waitcnt vmcnt(10)
    v_mfma_f32_16x16x32_bf16 v[120:123], v[212:215], v[200:203], v[120:123]
    s_waitcnt vmcnt(9)
    v_mfma_f32_16x16x32_bf16 v[124:127], v[216:219], v[200:203], v[124:127]
    ds_read_b128 v[200:203], v4 offset:8192
    s_add_u32 s75, s75, 6144
    buffer_load_dwordx4 v[208:211], v8, s[36:39], s75 offen offset:0 sc1
    v_exp_f32 v42, v42
    v_exp_f32 v43, v43
    v_mfma_f32_16x16x32_bf16 v[144:147], v[212:215], v[204:207], v[144:147]
    v_mfma_f32_16x16x32_bf16 v[148:151], v[216:219], v[204:207], v[148:151]
    ds_read_b128 v[204:207], v6 offset:8192
    buffer_load_dwordx4 v252, s[60:63], s72 offen offset:3072  lds
    v_exp_f32 v12, v12
    v_exp_f32 v13, v13
    v_smfmac_f32_32x32x32_bf16 v[60:75], v[100:103], v[36:43], v254
    ds_read_b128 v[100:103], v3 offset:18176
    v_mfma_f32_32x32x16_bf16 v[28:43], v[88:91], v[80:83], 0
    ds_read_b128 v[88:91], v1 offset:13312
    v_exp_f32 v14, v14
    v_exp_f32 v15, v15
    v_exp_f32 v16, v16
    v_exp_f32 v17, v17
    v_mfma_f32_16x16x32_bf16 v[168:171], v[212:215], v[244:247], v[168:171]
    v_mfma_f32_16x16x32_bf16 v[172:175], v[216:219], v[244:247], v[172:175]
    ds_read_b128 v[244:247], v4 offset:12288
    v_mfma_f32_32x32x8bf16_1k v[28:43], v[92:93], v[86:87], v[28:43]
    v_exp_f32 v18, v18
    v_exp_f32 v19, v19
    v_exp_f32 v20, v20
    v_exp_f32 v21, v21
    v_mfma_f32_16x16x32_bf16 v[192:195], v[212:215], v[248:251], v[192:195]
    v_mfma_f32_16x16x32_bf16 v[196:199], v[216:219], v[248:251], v[196:199]
    ds_read_b128 v[248:251], v6 offset:12288
    buffer_load_dwordx4 v[212:215], v8, s[36:39], s75 offen offset:256 sc1
    s_waitcnt lgkmcnt(6)
    v_smfmac_f32_32x32x32_bf16 v[44:59], v[96:99], v[12:19], v254
    v_exp_f32 v22, v22
    v_exp_f32 v23, v23
    v_exp_f32 v24, v24
    v_exp_f32 v25, v25
    s_waitcnt vmcnt(11) lgkmcnt(5)
    v_mfma_f32_16x16x32_bf16 v[104:107], v[220:223], v[200:203], v[104:107]
    s_waitcnt vmcnt(10)
    v_mfma_f32_16x16x32_bf16 v[108:111], v[224:227], v[200:203], v[108:111]
    buffer_load_dwordx4 v[216:219], v8, s[36:39], s75 offen offset:1024 sc1
    s_waitcnt lgkmcnt(4)
    v_mfma_f32_16x16x32_bf16 v[128:131], v[220:223], v[204:207], v[128:131]
    v_mfma_f32_16x16x32_bf16 v[132:135], v[224:227], v[204:207], v[132:135]
    s_add_u32 m0, s68, 4096
    s_add_u32 s72, s70, s71
    buffer_load_dwordx4 v9, s[60:63], s72 offen offset:0  lds
    v_exp_f32 v26, v26
    v_exp_f32 v27, v27
    s_waitcnt lgkmcnt(1)
    v_mfma_f32_16x16x32_bf16 v[152:155], v[220:223], v[244:247], v[152:155]
    v_mfma_f32_16x16x32_bf16 v[156:159], v[224:227], v[244:247], v[156:159]
    buffer_load_dwordx4 v10, s[60:63], s72 offen offset:1024  lds
    v_exp_f32 v28, v28
    v_exp_f32 v29, v29
    v_smfmac_f32_32x32x32_bf16 v[44:59], v[100:103], v[20:27], v254
    v_mfma_f32_32x32x16_bf16 v[12:27], v[88:91], v[76:79], 0
    v_exp_f32 v30, v30
    v_exp_f32 v31, v31
    v_exp_f32 v32, v32
    s_waitcnt lgkmcnt(0)
    v_mfma_f32_16x16x32_bf16 v[176:179], v[220:223], v[248:251], v[176:179]
    v_mfma_f32_16x16x32_bf16 v[180:183], v[224:227], v[248:251], v[180:183]
    buffer_load_dwordx4 v[220:223], v8, s[36:39], s75 offen offset:1280 sc1
    v_mfma_f32_32x32x8bf16_1k v[12:27], v[94:95], v[84:85], v[12:27]
    v_exp_f32 v33, v33
    v_exp_f32 v34, v34
    v_exp_f32 v35, v35
    v_exp_f32 v36, v36
    s_waitcnt vmcnt(13)
    v_mfma_f32_16x16x32_bf16 v[112:115], v[228:231], v[200:203], v[112:115]
    s_waitcnt vmcnt(11)
    v_mfma_f32_16x16x32_bf16 v[116:119], v[232:235], v[200:203], v[116:119]
    buffer_load_dwordx4 v[224:227], v8, s[36:39], s75 offen offset:2048 sc1
    v_exp_f32 v37, v37
    v_exp_f32 v38, v38
    v_mfma_f32_16x16x32_bf16 v[136:139], v[228:231], v[204:207], v[136:139]
    v_mfma_f32_16x16x32_bf16 v[140:143], v[232:235], v[204:207], v[140:143]
    buffer_load_dwordx4 v11, s[60:63], s72 offen offset:2048  lds
    v_smfmac_f32_32x32x32_bf16 v[60:75], v[96:99], v[28:35], v254
    ds_read_b128 v[96:99], v3 offset:18944
    v_exp_f32 v39, v39
    v_exp_f32 v40, v40
    v_exp_f32 v41, v41
    v_mfma_f32_16x16x32_bf16 v[160:163], v[228:231], v[244:247], v[160:163]
    v_mfma_f32_16x16x32_bf16 v[164:167], v[232:235], v[244:247], v[164:167]
    v_mfma_f32_16x16x32_bf16 v[184:187], v[228:231], v[248:251], v[184:187]
    v_mfma_f32_16x16x32_bf16 v[188:191], v[232:235], v[248:251], v[188:191]
    buffer_load_dwordx4 v[228:231], v8, s[36:39], s75 offen offset:2304 sc1
    v_exp_f32 v42, v42
    v_exp_f32 v43, v43
    s_waitcnt vmcnt(13)
    v_mfma_f32_16x16x32_bf16 v[120:123], v[236:239], v[200:203], v[120:123]
    s_waitcnt vmcnt(10)
    v_mfma_f32_16x16x32_bf16 v[124:127], v[240:243], v[200:203], v[124:127]
    ds_read_b128 v[200:203], v5 offset:8192
    s_mul_i32 s75, s74, 96
    s_add_u32 s74, s74, 128
    s_add_u32 s75, s75, s73
    s_and_b32 s74, s74, 0x3ff
    buffer_load_dwordx4 v[232:235], v8, s[36:39], s75 offen offset:0 sc1
    v_exp_f32 v12, v12
    v_exp_f32 v13, v13
    v_smfmac_f32_32x32x32_bf16 v[60:75], v[100:103], v[36:43], v254
    ds_read_b128 v[100:103], v3 offset:19712
    v_mfma_f32_32x32x16_bf16 v[28:43], v[88:91], v[80:83], 0
    v_exp_f32 v14, v14
    v_exp_f32 v15, v15
    v_exp_f32 v16, v16
    v_exp_f32 v17, v17
    v_mfma_f32_16x16x32_bf16 v[144:147], v[236:239], v[204:207], v[144:147]
    v_mfma_f32_16x16x32_bf16 v[148:151], v[240:243], v[204:207], v[148:151]
    ds_read_b128 v[204:207], v7 offset:8192
    buffer_load_dwordx4 v252, s[60:63], s72 offen offset:3072  lds
    s_add_u32 s71, s71, 128
    s_and_b32 s71, s71, 0x3ff
    v_mfma_f32_32x32x8bf16_1k v[28:43], v[94:95], v[86:87], v[28:43]
    v_exp_f32 v18, v18
    v_exp_f32 v19, v19
    v_exp_f32 v20, v20
    v_exp_f32 v21, v21
    v_mfma_f32_16x16x32_bf16 v[168:171], v[236:239], v[244:247], v[168:171]
    v_mfma_f32_16x16x32_bf16 v[172:175], v[240:243], v[244:247], v[172:175]
    ds_read_b128 v[244:247], v5 offset:12288
    s_waitcnt lgkmcnt(4)
    v_smfmac_f32_32x32x32_bf16 v[44:59], v[96:99], v[12:19], v254
    v_exp_f32 v22, v22
    v_exp_f32 v23, v23
    v_exp_f32 v24, v24
    v_exp_f32 v25, v25
    v_mfma_f32_16x16x32_bf16 v[192:195], v[236:239], v[248:251], v[192:195]
    v_mfma_f32_16x16x32_bf16 v[196:199], v[240:243], v[248:251], v[196:199]
    ds_read_b128 v[248:251], v7 offset:12288
    buffer_load_dwordx4 v[236:239], v8, s[36:39], s75 offen offset:256 sc1
    s_waitcnt vmcnt(12) lgkmcnt(4)
    v_mfma_f32_16x16x32_bf16 v[104:107], v[208:211], v[200:203], v[104:107]
    s_waitcnt vmcnt(10)
    v_mfma_f32_16x16x32_bf16 v[108:111], v[212:215], v[200:203], v[108:111]
    buffer_load_dwordx4 v[240:243], v8, s[36:39], s75 offen offset:1024 sc1
    v_exp_f32 v26, v26
    v_exp_f32 v27, v27
    s_waitcnt lgkmcnt(3)
    s_barrier
    ds_read_b128 v[88:91], v1 offset:24576
    ds_read_b128 v[92:95], v2 offset:28672
    s_waitcnt lgkmcnt(4)
    v_mfma_f32_16x16x32_bf16 v[128:131], v[208:211], v[204:207], v[128:131]
    v_mfma_f32_16x16x32_bf16 v[132:135], v[212:215], v[204:207], v[132:135]
    s_add_u32 m0, s68, 8192
    s_add_u32 s72, s69, s71
    buffer_load_dwordx4 v9, s[60:63], s72 offen offset:0  lds
    v_exp_f32 v28, v28
    v_exp_f32 v29, v29
    v_smfmac_f32_32x32x32_bf16 v[44:59], v[100:103], v[20:27], v254
    s_waitcnt lgkmcnt(1)
    v_mfma_f32_32x32x16_bf16 v[12:27], v[88:91], v[76:79], 0
    v_exp_f32 v30, v30
    v_exp_f32 v31, v31
    v_exp_f32 v32, v32
    v_exp_f32 v33, v33
    v_mfma_f32_16x16x32_bf16 v[152:155], v[208:211], v[244:247], v[152:155]
    v_mfma_f32_16x16x32_bf16 v[156:159], v[212:215], v[244:247], v[156:159]
    s_waitcnt lgkmcnt(0)
    v_mfma_f32_32x32x8bf16_1k v[12:27], v[92:93], v[84:85], v[12:27]
    v_exp_f32 v34, v34
    v_exp_f32 v35, v35
    v_exp_f32 v36, v36
    v_exp_f32 v37, v37
    v_mfma_f32_16x16x32_bf16 v[176:179], v[208:211], v[248:251], v[176:179]
    v_mfma_f32_16x16x32_bf16 v[180:183], v[212:215], v[248:251], v[180:183]
    buffer_load_dwordx4 v[208:211], v8, s[36:39], s75 offen offset:1280 sc1
    v_smfmac_f32_32x32x32_bf16 v[60:75], v[96:99], v[28:35], v254
    ds_read_b128 v[96:99], v3 offset:29696
    v_exp_f32 v38, v38
    v_exp_f32 v39, v39
    v_exp_f32 v40, v40
    v_exp_f32 v41, v41
    s_waitcnt vmcnt(12)
    v_mfma_f32_16x16x32_bf16 v[112:115], v[216:219], v[200:203], v[112:115]
    s_waitcnt vmcnt(9)
    v_mfma_f32_16x16x32_bf16 v[116:119], v[220:223], v[200:203], v[116:119]
    buffer_load_dwordx4 v[212:215], v8, s[36:39], s75 offen offset:2048 sc1
    v_mfma_f32_16x16x32_bf16 v[136:139], v[216:219], v[204:207], v[136:139]
    v_mfma_f32_16x16x32_bf16 v[140:143], v[220:223], v[204:207], v[140:143]
    buffer_load_dwordx4 v10, s[60:63], s72 offen offset:1024  lds
    v_exp_f32 v42, v42
    v_exp_f32 v43, v43
    v_mfma_f32_16x16x32_bf16 v[160:163], v[216:219], v[244:247], v[160:163]
    v_mfma_f32_16x16x32_bf16 v[164:167], v[220:223], v[244:247], v[164:167]
    buffer_load_dwordx4 v11, s[60:63], s72 offen offset:2048  lds
    v_exp_f32 v12, v12
    v_exp_f32 v13, v13
    v_smfmac_f32_32x32x32_bf16 v[60:75], v[100:103], v[36:43], v254
    ds_read_b128 v[100:103], v3 offset:30464
    v_mfma_f32_32x32x16_bf16 v[28:43], v[88:91], v[80:83], 0
    ds_read_b128 v[88:91], v1 offset:25600
    v_exp_f32 v14, v14
    v_exp_f32 v15, v15
    v_exp_f32 v16, v16
    v_mfma_f32_16x16x32_bf16 v[184:187], v[216:219], v[248:251], v[184:187]
    v_mfma_f32_16x16x32_bf16 v[188:191], v[220:223], v[248:251], v[188:191]
    buffer_load_dwordx4 v[216:219], v8, s[36:39], s75 offen offset:2304 sc1
    v_mfma_f32_32x32x8bf16_1k v[28:43], v[92:93], v[86:87], v[28:43]
    v_exp_f32 v17, v17
    v_exp_f32 v18, v18
    v_exp_f32 v19, v19
    v_exp_f32 v20, v20
    s_waitcnt vmcnt(12)
    v_mfma_f32_16x16x32_bf16 v[120:123], v[224:227], v[200:203], v[120:123]
    s_waitcnt vmcnt(10)
    v_mfma_f32_16x16x32_bf16 v[124:127], v[228:231], v[200:203], v[124:127]
    ds_read_b128 v[200:203], v4 offset:0
    s_add_u32 s75, s75, 6144
    buffer_load_dwordx4 v[220:223], v8, s[36:39], s75 offen offset:0 sc1
    v_exp_f32 v21, v21
    v_exp_f32 v22, v22
    v_mfma_f32_16x16x32_bf16 v[144:147], v[224:227], v[204:207], v[144:147]
    v_mfma_f32_16x16x32_bf16 v[148:151], v[228:231], v[204:207], v[148:151]
    ds_read_b128 v[204:207], v6 offset:0
    buffer_load_dwordx4 v252, s[60:63], s72 offen offset:3072  lds
    s_waitcnt lgkmcnt(4)
    v_smfmac_f32_32x32x32_bf16 v[44:59], v[96:99], v[12:19], v254
    v_exp_f32 v23, v23
    v_exp_f32 v24, v24
    v_exp_f32 v25, v25
    v_mfma_f32_16x16x32_bf16 v[168:171], v[224:227], v[244:247], v[168:171]
    v_mfma_f32_16x16x32_bf16 v[172:175], v[228:231], v[244:247], v[172:175]
    s_waitcnt vmcnt(10)
    ds_read_b128 v[244:247], v4 offset:4096
    v_mfma_f32_16x16x32_bf16 v[192:195], v[224:227], v[248:251], v[192:195]
    v_mfma_f32_16x16x32_bf16 v[196:199], v[228:231], v[248:251], v[196:199]
    ds_read_b128 v[248:251], v6 offset:4096
    buffer_load_dwordx4 v[224:227], v8, s[36:39], s75 offen offset:256 sc1
    v_exp_f32 v26, v26
    v_exp_f32 v27, v27
    s_waitcnt lgkmcnt(3)
    v_mfma_f32_16x16x32_bf16 v[104:107], v[232:235], v[200:203], v[104:107]
    s_waitcnt vmcnt(10)
    v_mfma_f32_16x16x32_bf16 v[108:111], v[236:239], v[200:203], v[108:111]
    buffer_load_dwordx4 v[228:231], v8, s[36:39], s75 offen offset:1024 sc1
    v_exp_f32 v28, v28
    v_exp_f32 v29, v29
    v_smfmac_f32_32x32x32_bf16 v[44:59], v[100:103], v[20:27], v254
    v_mfma_f32_32x32x16_bf16 v[12:27], v[88:91], v[76:79], 0
    v_exp_f32 v30, v30
    v_exp_f32 v31, v31
    v_exp_f32 v32, v32
    v_exp_f32 v33, v33
    s_waitcnt lgkmcnt(2)
    v_mfma_f32_16x16x32_bf16 v[128:131], v[232:235], v[204:207], v[128:131]
    v_mfma_f32_16x16x32_bf16 v[132:135], v[236:239], v[204:207], v[132:135]
    s_add_u32 m0, s68, 12288
    s_add_u32 s72, s70, s71
    buffer_load_dwordx4 v9, s[60:63], s72 offen offset:0  lds
    v_mfma_f32_32x32x8bf16_1k v[12:27], v[94:95], v[84:85], v[12:27]
    v_exp_f32 v34, v34
    v_exp_f32 v35, v35
    v_exp_f32 v36, v36
    v_exp_f32 v37, v37
    s_waitcnt lgkmcnt(1)
    v_mfma_f32_16x16x32_bf16 v[152:155], v[232:235], v[244:247], v[152:155]
    v_mfma_f32_16x16x32_bf16 v[156:159], v[236:239], v[244:247], v[156:159]
    buffer_load_dwordx4 v10, s[60:63], s72 offen offset:1024  lds
    v_smfmac_f32_32x32x32_bf16 v[60:75], v[96:99], v[28:35], v254
    ds_read_b128 v[96:99], v3 offset:31232
    v_exp_f32 v38, v38
    v_exp_f32 v39, v39
    v_exp_f32 v40, v40
    v_exp_f32 v41, v41
    s_waitcnt lgkmcnt(1)
    v_mfma_f32_16x16x32_bf16 v[176:179], v[232:235], v[248:251], v[176:179]
    v_mfma_f32_16x16x32_bf16 v[180:183], v[236:239], v[248:251], v[180:183]
    buffer_load_dwordx4 v[232:235], v8, s[36:39], s75 offen offset:1280 sc1
    s_waitcnt vmcnt(13)
    v_mfma_f32_16x16x32_bf16 v[112:115], v[240:243], v[200:203], v[112:115]
    s_waitcnt vmcnt(11)
    v_mfma_f32_16x16x32_bf16 v[116:119], v[208:211], v[200:203], v[116:119]
    buffer_load_dwordx4 v[236:239], v8, s[36:39], s75 offen offset:2048 sc1
    v_exp_f32 v42, v42
    v_exp_f32 v43, v43
    v_mfma_f32_16x16x32_bf16 v[136:139], v[240:243], v[204:207], v[136:139]
    v_mfma_f32_16x16x32_bf16 v[140:143], v[208:211], v[204:207], v[140:143]
    buffer_load_dwordx4 v11, s[60:63], s72 offen offset:2048  lds
    v_exp_f32 v12, v12
    v_exp_f32 v13, v13
    v_smfmac_f32_32x32x32_bf16 v[60:75], v[100:103], v[36:43], v254
    ds_read_b128 v[100:103], v3 offset:32000
    v_mfma_f32_32x32x16_bf16 v[28:43], v[88:91], v[80:83], 0
    v_exp_f32 v14, v14
    v_exp_f32 v15, v15
    v_exp_f32 v16, v16
    v_exp_f32 v17, v17
    v_mfma_f32_16x16x32_bf16 v[160:163], v[240:243], v[244:247], v[160:163]
    v_mfma_f32_16x16x32_bf16 v[164:167], v[208:211], v[244:247], v[164:167]
    v_mfma_f32_32x32x8bf16_1k v[28:43], v[94:95], v[86:87], v[28:43]
    v_exp_f32 v18, v18
    v_exp_f32 v19, v19
    v_exp_f32 v20, v20
    v_exp_f32 v21, v21
    v_mfma_f32_16x16x32_bf16 v[184:187], v[240:243], v[248:251], v[184:187]
    v_mfma_f32_16x16x32_bf16 v[188:191], v[208:211], v[248:251], v[188:191]
    buffer_load_dwordx4 v[240:243], v8, s[36:39], s75 offen offset:2304 sc1
    s_waitcnt lgkmcnt(1)
    v_smfmac_f32_32x32x32_bf16 v[44:59], v[96:99], v[12:19], v254
    v_exp_f32 v22, v22
    v_exp_f32 v23, v23
    v_exp_f32 v24, v24
    v_exp_f32 v25, v25
    s_waitcnt vmcnt(13)
    v_mfma_f32_16x16x32_bf16 v[120:123], v[212:215], v[200:203], v[120:123]
    s_waitcnt vmcnt(10)
    v_mfma_f32_16x16x32_bf16 v[124:127], v[216:219], v[200:203], v[124:127]
    ds_read_b128 v[200:203], v5 offset:0
    s_mul_i32 s75, s74, 96
    s_add_u32 s74, s74, 128
    s_add_u32 s75, s75, s73
    s_and_b32 s74, s74, 0x3ff
    buffer_load_dwordx4 v[208:211], v8, s[36:39], s75 offen offset:0 sc1
    v_mfma_f32_16x16x32_bf16 v[144:147], v[212:215], v[204:207], v[144:147]
    v_mfma_f32_16x16x32_bf16 v[148:151], v[216:219], v[204:207], v[148:151]
    ds_read_b128 v[204:207], v7 offset:0
    buffer_load_dwordx4 v252, s[60:63], s72 offen offset:3072  lds
    s_add_u32 s71, s71, 128
    s_and_b32 s71, s71, 0x3ff
    v_exp_f32 v26, v26
    v_exp_f32 v27, v27
    s_waitcnt lgkmcnt(2)
    s_barrier
    ds_read_b128 v[88:91], v1 offset:0
    ds_read_b128 v[92:95], v2 offset:4096
    v_mfma_f32_16x16x32_bf16 v[168:171], v[212:215], v[244:247], v[168:171]
    v_mfma_f32_16x16x32_bf16 v[172:175], v[216:219], v[244:247], v[172:175]
    ds_read_b128 v[244:247], v5 offset:4096
    v_exp_f32 v28, v28
    v_exp_f32 v29, v29
    v_smfmac_f32_32x32x32_bf16 v[44:59], v[100:103], v[20:27], v254
    s_waitcnt lgkmcnt(2)
    v_mfma_f32_32x32x16_bf16 v[12:27], v[88:91], v[76:79], 0
    v_exp_f32 v30, v30
    v_exp_f32 v31, v31
    v_exp_f32 v32, v32
    v_mfma_f32_16x16x32_bf16 v[192:195], v[212:215], v[248:251], v[192:195]
    v_mfma_f32_16x16x32_bf16 v[196:199], v[216:219], v[248:251], v[196:199]
    ds_read_b128 v[248:251], v7 offset:4096
    buffer_load_dwordx4 v[212:215], v8, s[36:39], s75 offen offset:256 sc1
    s_waitcnt lgkmcnt(2)
    v_mfma_f32_32x32x8bf16_1k v[12:27], v[92:93], v[84:85], v[12:27]
    v_exp_f32 v33, v33
    v_exp_f32 v34, v34
    v_exp_f32 v35, v35
    v_exp_f32 v36, v36
    s_waitcnt vmcnt(12)
    v_mfma_f32_16x16x32_bf16 v[104:107], v[220:223], v[200:203], v[104:107]
    s_waitcnt vmcnt(10)
    v_mfma_f32_16x16x32_bf16 v[108:111], v[224:227], v[200:203], v[108:111]
    buffer_load_dwordx4 v[216:219], v8, s[36:39], s75 offen offset:1024 sc1
    v_exp_f32 v37, v37
    v_exp_f32 v38, v38
    v_mfma_f32_16x16x32_bf16 v[128:131], v[220:223], v[204:207], v[128:131]
    v_mfma_f32_16x16x32_bf16 v[132:135], v[224:227], v[204:207], v[132:135]
    s_add_u32 m0, s68, 0
    s_add_u32 s72, s69, s71
    buffer_load_dwordx4 v9, s[60:63], s72 offen offset:0  lds
    v_smfmac_f32_32x32x32_bf16 v[60:75], v[96:99], v[28:35], v254
    ds_read_b128 v[96:99], v3 offset:5120
    v_exp_f32 v39, v39
    v_exp_f32 v40, v40
    v_exp_f32 v41, v41
    s_waitcnt lgkmcnt(2)
    v_mfma_f32_16x16x32_bf16 v[152:155], v[220:223], v[244:247], v[152:155]
    v_mfma_f32_16x16x32_bf16 v[156:159], v[224:227], v[244:247], v[156:159]
    s_waitcnt lgkmcnt(1)
    v_mfma_f32_16x16x32_bf16 v[176:179], v[220:223], v[248:251], v[176:179]
    v_mfma_f32_16x16x32_bf16 v[180:183], v[224:227], v[248:251], v[180:183]
    buffer_load_dwordx4 v[220:223], v8, s[36:39], s75 offen offset:1280 sc1
    v_exp_f32 v42, v42
    v_exp_f32 v43, v43
    s_waitcnt vmcnt(12)
    v_mfma_f32_16x16x32_bf16 v[112:115], v[228:231], v[200:203], v[112:115]
    s_waitcnt vmcnt(9)
    v_mfma_f32_16x16x32_bf16 v[116:119], v[232:235], v[200:203], v[116:119]
    buffer_load_dwordx4 v[224:227], v8, s[36:39], s75 offen offset:2048 sc1
    v_exp_f32 v12, v12
    v_exp_f32 v13, v13
    v_smfmac_f32_32x32x32_bf16 v[60:75], v[100:103], v[36:43], v254
    ds_read_b128 v[100:103], v3 offset:5888
    v_mfma_f32_32x32x16_bf16 v[28:43], v[88:91], v[80:83], 0
    ds_read_b128 v[88:91], v1 offset:1024
    v_exp_f32 v14, v14
    v_exp_f32 v15, v15
    v_exp_f32 v16, v16
    v_exp_f32 v17, v17
    v_mfma_f32_16x16x32_bf16 v[136:139], v[228:231], v[204:207], v[136:139]
    v_mfma_f32_16x16x32_bf16 v[140:143], v[232:235], v[204:207], v[140:143]
    buffer_load_dwordx4 v10, s[60:63], s72 offen offset:1024  lds
    v_mfma_f32_32x32x8bf16_1k v[28:43], v[92:93], v[86:87], v[28:43]
    v_exp_f32 v18, v18
    v_exp_f32 v19, v19
    v_exp_f32 v20, v20
    v_exp_f32 v21, v21
    v_mfma_f32_16x16x32_bf16 v[160:163], v[228:231], v[244:247], v[160:163]
    v_mfma_f32_16x16x32_bf16 v[164:167], v[232:235], v[244:247], v[164:167]
    buffer_load_dwordx4 v11, s[60:63], s72 offen offset:2048  lds
    s_waitcnt lgkmcnt(2)
    v_smfmac_f32_32x32x32_bf16 v[44:59], v[96:99], v[12:19], v254
    v_exp_f32 v22, v22
    v_exp_f32 v23, v23
    v_exp_f32 v24, v24
    v_exp_f32 v25, v25
    v_mfma_f32_16x16x32_bf16 v[184:187], v[228:231], v[248:251], v[184:187]
    v_mfma_f32_16x16x32_bf16 v[188:191], v[232:235], v[248:251], v[188:191]
    buffer_load_dwordx4 v[228:231], v8, s[36:39], s75 offen offset:2304 sc1
    s_waitcnt vmcnt(12)
    v_mfma_f32_16x16x32_bf16 v[120:123], v[236:239], v[200:203], v[120:123]
    s_waitcnt vmcnt(10)
    v_mfma_f32_16x16x32_bf16 v[124:127], v[240:243], v[200:203], v[124:127]
    ds_read_b128 v[200:203], v4 offset:8192
    s_add_u32 s75, s75, 6144
    buffer_load_dwordx4 v[232:235], v8, s[36:39], s75 offen offset:0 sc1
    v_exp_f32 v26, v26
    v_exp_f32 v27, v27
    v_mfma_f32_16x16x32_bf16 v[144:147], v[236:239], v[204:207], v[144:147]
    v_mfma_f32_16x16x32_bf16 v[148:151], v[240:243], v[204:207], v[148:151]
    ds_read_b128 v[204:207], v6 offset:8192
    buffer_load_dwordx4 v252, s[60:63], s72 offen offset:3072  lds
    v_exp_f32 v28, v28
    v_exp_f32 v29, v29
    s_waitcnt lgkmcnt(3)
    v_smfmac_f32_32x32x32_bf16 v[44:59], v[100:103], v[20:27], v254
    s_waitcnt lgkmcnt(2)
    v_mfma_f32_32x32x16_bf16 v[12:27], v[88:91], v[76:79], 0
    v_exp_f32 v30, v30
    v_exp_f32 v31, v31
    v_exp_f32 v32, v32
    v_exp_f32 v33, v33
    v_mfma_f32_16x16x32_bf16 v[168:171], v[236:239], v[244:247], v[168:171]
    v_mfma_f32_16x16x32_bf16 v[172:175], v[240:243], v[244:247], v[172:175]
    s_waitcnt vmcnt(10)
    ds_read_b128 v[244:247], v4 offset:12288
    v_mfma_f32_32x32x8bf16_1k v[12:27], v[94:95], v[84:85], v[12:27]
    v_exp_f32 v34, v34
    v_exp_f32 v35, v35
    v_exp_f32 v36, v36
    v_exp_f32 v37, v37
    v_mfma_f32_16x16x32_bf16 v[192:195], v[236:239], v[248:251], v[192:195]
    v_mfma_f32_16x16x32_bf16 v[196:199], v[240:243], v[248:251], v[196:199]
    ds_read_b128 v[248:251], v6 offset:12288
    buffer_load_dwordx4 v[236:239], v8, s[36:39], s75 offen offset:256 sc1
    v_smfmac_f32_32x32x32_bf16 v[60:75], v[96:99], v[28:35], v254
    ds_read_b128 v[96:99], v3 offset:6656
    v_exp_f32 v38, v38
    v_exp_f32 v39, v39
    v_exp_f32 v40, v40
    v_exp_f32 v41, v41
    s_waitcnt lgkmcnt(4)
    v_mfma_f32_16x16x32_bf16 v[104:107], v[208:211], v[200:203], v[104:107]
    s_waitcnt vmcnt(10)
    v_mfma_f32_16x16x32_bf16 v[108:111], v[212:215], v[200:203], v[108:111]
    buffer_load_dwordx4 v[240:243], v8, s[36:39], s75 offen offset:1024 sc1
    s_waitcnt lgkmcnt(3)
    v_mfma_f32_16x16x32_bf16 v[128:131], v[208:211], v[204:207], v[128:131]
    v_mfma_f32_16x16x32_bf16 v[132:135], v[212:215], v[204:207], v[132:135]
    s_add_u32 m0, s68, 4096
    s_add_u32 s72, s70, s71
    buffer_load_dwordx4 v9, s[60:63], s72 offen offset:0  lds
    v_exp_f32 v42, v42
    v_exp_f32 v43, v43
    s_waitcnt lgkmcnt(2)
    v_mfma_f32_16x16x32_bf16 v[152:155], v[208:211], v[244:247], v[152:155]
    v_mfma_f32_16x16x32_bf16 v[156:159], v[212:215], v[244:247], v[156:159]
    buffer_load_dwordx4 v10, s[60:63], s72 offen offset:1024  lds
    v_exp_f32 v12, v12
    v_exp_f32 v13, v13
    v_smfmac_f32_32x32x32_bf16 v[60:75], v[100:103], v[36:43], v254
    ds_read_b128 v[100:103], v3 offset:7424
    v_mfma_f32_32x32x16_bf16 v[28:43], v[88:91], v[80:83], 0
    v_exp_f32 v14, v14
    v_exp_f32 v15, v15
    v_exp_f32 v16, v16
    s_waitcnt lgkmcnt(2)
    v_mfma_f32_16x16x32_bf16 v[176:179], v[208:211], v[248:251], v[176:179]
    v_mfma_f32_16x16x32_bf16 v[180:183], v[212:215], v[248:251], v[180:183]
    buffer_load_dwordx4 v[208:211], v8, s[36:39], s75 offen offset:1280 sc1
    v_mfma_f32_32x32x8bf16_1k v[28:43], v[94:95], v[86:87], v[28:43]
    v_exp_f32 v17, v17
    v_exp_f32 v18, v18
    v_exp_f32 v19, v19
    v_exp_f32 v20, v20
    s_waitcnt vmcnt(13)
    v_mfma_f32_16x16x32_bf16 v[112:115], v[216:219], v[200:203], v[112:115]
    s_waitcnt vmcnt(11)
    v_mfma_f32_16x16x32_bf16 v[116:119], v[220:223], v[200:203], v[116:119]
    buffer_load_dwordx4 v[212:215], v8, s[36:39], s75 offen offset:2048 sc1
    v_exp_f32 v21, v21
    v_exp_f32 v22, v22
    v_mfma_f32_16x16x32_bf16 v[136:139], v[216:219], v[204:207], v[136:139]
    v_mfma_f32_16x16x32_bf16 v[140:143], v[220:223], v[204:207], v[140:143]
    buffer_load_dwordx4 v11, s[60:63], s72 offen offset:2048  lds
    s_waitcnt lgkmcnt(1)
    v_smfmac_f32_32x32x32_bf16 v[44:59], v[96:99], v[12:19], v254
    v_exp_f32 v23, v23
    v_exp_f32 v24, v24
    v_exp_f32 v25, v25
    v_mfma_f32_16x16x32_bf16 v[160:163], v[216:219], v[244:247], v[160:163]
    v_mfma_f32_16x16x32_bf16 v[164:167], v[220:223], v[244:247], v[164:167]
    v_mfma_f32_16x16x32_bf16 v[184:187], v[216:219], v[248:251], v[184:187]
    v_mfma_f32_16x16x32_bf16 v[188:191], v[220:223], v[248:251], v[188:191]
    buffer_load_dwordx4 v[216:219], v8, s[36:39], s75 offen offset:2304 sc1
    v_exp_f32 v26, v26
    v_exp_f32 v27, v27
    s_waitcnt lgkmcnt(0)
    s_barrier
    ds_read_b128 v[88:91], v1 offset:12288
    ds_read_b128 v[92:95], v2 offset:16384
    s_waitcnt vmcnt(13)
    v_mfma_f32_16x16x32_bf16 v[120:123], v[224:227], v[200:203], v[120:123]
    s_waitcnt vmcnt(10)
    v_mfma_f32_16x16x32_bf16 v[124:127], v[228:231], v[200:203], v[124:127]
    ds_read_b128 v[200:203], v5 offset:8192
    s_mul_i32 s75, s74, 96
    s_add_u32 s74, s74, 128
    s_add_u32 s75, s75, s73
    s_and_b32 s74, s74, 0x3ff
    buffer_load_dwordx4 v[220:223], v8, s[36:39], s75 offen offset:0 sc1
    v_exp_f32 v28, v28
    v_exp_f32 v29, v29
    v_smfmac_f32_32x32x32_bf16 v[44:59], v[100:103], v[20:27], v254
    s_waitcnt lgkmcnt(2)
    v_mfma_f32_32x32x16_bf16 v[12:27], v[88:91], v[76:79], 0
    v_exp_f32 v30, v30
    v_exp_f32 v31, v31
    v_exp_f32 v32, v32
    v_exp_f32 v33, v33
    v_mfma_f32_16x16x32_bf16 v[144:147], v[224:227], v[204:207], v[144:147]
    v_mfma_f32_16x16x32_bf16 v[148:151], v[228:231], v[204:207], v[148:151]
    ds_read_b128 v[204:207], v7 offset:8192
    buffer_load_dwordx4 v252, s[60:63], s72 offen offset:3072  lds
    s_add_u32 s71, s71, 128
    s_and_b32 s71, s71, 0x3ff
    s_waitcnt lgkmcnt(2)
    v_mfma_f32_32x32x8bf16_1k v[12:27], v[92:93], v[84:85], v[12:27]
    v_exp_f32 v34, v34
    v_exp_f32 v35, v35
    v_exp_f32 v36, v36
    v_exp_f32 v37, v37
    v_mfma_f32_16x16x32_bf16 v[168:171], v[224:227], v[244:247], v[168:171]
    v_mfma_f32_16x16x32_bf16 v[172:175], v[228:231], v[244:247], v[172:175]
    ds_read_b128 v[244:247], v5 offset:12288
    v_smfmac_f32_32x32x32_bf16 v[60:75], v[96:99], v[28:35], v254
    ds_read_b128 v[96:99], v3 offset:17408
    v_exp_f32 v38, v38
    v_exp_f32 v39, v39
    v_exp_f32 v40, v40
    v_exp_f32 v41, v41
    v_mfma_f32_16x16x32_bf16 v[192:195], v[224:227], v[248:251], v[192:195]
    v_mfma_f32_16x16x32_bf16 v[196:199], v[228:231], v[248:251], v[196:199]
    ds_read_b128 v[248:251], v7 offset:12288
    buffer_load_dwordx4 v[224:227], v8, s[36:39], s75 offen offset:256 sc1
    s_waitcnt vmcnt(12) lgkmcnt(4)
    v_mfma_f32_16x16x32_bf16 v[104:107], v[232:235], v[200:203], v[104:107]
    s_waitcnt vmcnt(10)
    v_mfma_f32_16x16x32_bf16 v[108:111], v[236:239], v[200:203], v[108:111]
    buffer_load_dwordx4 v[228:231], v8, s[36:39], s75 offen offset:1024 sc1
    v_exp_f32 v42, v42
    v_exp_f32 v43, v43
    s_waitcnt lgkmcnt(3)
    v_mfma_f32_16x16x32_bf16 v[128:131], v[232:235], v[204:207], v[128:131]
    v_mfma_f32_16x16x32_bf16 v[132:135], v[236:239], v[204:207], v[132:135]
    s_add_u32 m0, s68, 8192
    s_add_u32 s72, s69, s71
    buffer_load_dwordx4 v9, s[60:63], s72 offen offset:0  lds
    v_exp_f32 v12, v12
    v_exp_f32 v13, v13
    v_smfmac_f32_32x32x32_bf16 v[60:75], v[100:103], v[36:43], v254
    ds_read_b128 v[100:103], v3 offset:18176
    v_mfma_f32_32x32x16_bf16 v[28:43], v[88:91], v[80:83], 0
    ds_read_b128 v[88:91], v1 offset:13312
    v_exp_f32 v14, v14
    v_exp_f32 v15, v15
    v_exp_f32 v16, v16
    v_exp_f32 v17, v17
    s_waitcnt lgkmcnt(4)
    v_mfma_f32_16x16x32_bf16 v[152:155], v[232:235], v[244:247], v[152:155]
    v_mfma_f32_16x16x32_bf16 v[156:159], v[236:239], v[244:247], v[156:159]
    v_mfma_f32_32x32x8bf16_1k v[28:43], v[92:93], v[86:87], v[28:43]
    v_exp_f32 v18, v18
    v_exp_f32 v19, v19
    v_exp_f32 v20, v20
    v_exp_f32 v21, v21
    s_waitcnt lgkmcnt(2)
    v_mfma_f32_16x16x32_bf16 v[176:179], v[232:235], v[248:251], v[176:179]
    v_mfma_f32_16x16x32_bf16 v[180:183], v[236:239], v[248:251], v[180:183]
    buffer_load_dwordx4 v[232:235], v8, s[36:39], s75 offen offset:1280 sc1
    v_smfmac_f32_32x32x32_bf16 v[44:59], v[96:99], v[12:19], v254
    v_exp_f32 v22, v22
    v_exp_f32 v23, v23
    v_exp_f32 v24, v24
    v_exp_f32 v25, v25
    s_waitcnt vmcnt(12)
    v_mfma_f32_16x16x32_bf16 v[112:115], v[240:243], v[200:203], v[112:115]
    s_waitcnt vmcnt(9)
    v_mfma_f32_16x16x32_bf16 v[116:119], v[208:211], v[200:203], v[116:119]
    buffer_load_dwordx4 v[236:239], v8, s[36:39], s75 offen offset:2048 sc1
    v_mfma_f32_16x16x32_bf16 v[136:139], v[240:243], v[204:207], v[136:139]
    v_mfma_f32_16x16x32_bf16 v[140:143], v[208:211], v[204:207], v[140:143]
    buffer_load_dwordx4 v10, s[60:63], s72 offen offset:1024  lds
    v_exp_f32 v26, v26
    v_exp_f32 v27, v27
    v_mfma_f32_16x16x32_bf16 v[160:163], v[240:243], v[244:247], v[160:163]
    v_mfma_f32_16x16x32_bf16 v[164:167], v[208:211], v[244:247], v[164:167]
    buffer_load_dwordx4 v11, s[60:63], s72 offen offset:2048  lds
    v_exp_f32 v28, v28
    v_exp_f32 v29, v29
    s_waitcnt lgkmcnt(1)
    v_smfmac_f32_32x32x32_bf16 v[44:59], v[100:103], v[20:27], v254
    s_waitcnt lgkmcnt(0)
    v_mfma_f32_32x32x16_bf16 v[12:27], v[88:91], v[76:79], 0
    v_exp_f32 v30, v30
    v_exp_f32 v31, v31
    v_exp_f32 v32, v32
    v_mfma_f32_16x16x32_bf16 v[184:187], v[240:243], v[248:251], v[184:187]
    v_mfma_f32_16x16x32_bf16 v[188:191], v[208:211], v[248:251], v[188:191]
    buffer_load_dwordx4 v[240:243], v8, s[36:39], s75 offen offset:2304 sc1
    v_mfma_f32_32x32x8bf16_1k v[12:27], v[94:95], v[84:85], v[12:27]
    v_exp_f32 v33, v33
    v_exp_f32 v34, v34
    v_exp_f32 v35, v35
    v_exp_f32 v36, v36
    s_waitcnt vmcnt(12)
    v_mfma_f32_16x16x32_bf16 v[120:123], v[212:215], v[200:203], v[120:123]
    s_waitcnt vmcnt(10)
    v_mfma_f32_16x16x32_bf16 v[124:127], v[216:219], v[200:203], v[124:127]
    ds_read_b128 v[200:203], v4 offset:0
    s_add_u32 s75, s75, 6144
    buffer_load_dwordx4 v[208:211], v8, s[36:39], s75 offen offset:0 sc1
    v_exp_f32 v37, v37
    v_exp_f32 v38, v38
    v_mfma_f32_16x16x32_bf16 v[144:147], v[212:215], v[204:207], v[144:147]
    v_mfma_f32_16x16x32_bf16 v[148:151], v[216:219], v[204:207], v[148:151]
    ds_read_b128 v[204:207], v6 offset:0
    buffer_load_dwordx4 v252, s[60:63], s72 offen offset:3072  lds
    v_smfmac_f32_32x32x32_bf16 v[60:75], v[96:99], v[28:35], v254
    ds_read_b128 v[96:99], v3 offset:18944
    v_exp_f32 v39, v39
    v_exp_f32 v40, v40
    v_exp_f32 v41, v41
    v_mfma_f32_16x16x32_bf16 v[168:171], v[212:215], v[244:247], v[168:171]
    v_mfma_f32_16x16x32_bf16 v[172:175], v[216:219], v[244:247], v[172:175]
    s_waitcnt vmcnt(10)
    ds_read_b128 v[244:247], v4 offset:4096
    v_mfma_f32_16x16x32_bf16 v[192:195], v[212:215], v[248:251], v[192:195]
    v_mfma_f32_16x16x32_bf16 v[196:199], v[216:219], v[248:251], v[196:199]
    ds_read_b128 v[248:251], v6 offset:4096
    buffer_load_dwordx4 v[212:215], v8, s[36:39], s75 offen offset:256 sc1
    v_exp_f32 v42, v42
    v_exp_f32 v43, v43
    s_waitcnt lgkmcnt(4)
    v_mfma_f32_16x16x32_bf16 v[104:107], v[220:223], v[200:203], v[104:107]
    s_waitcnt vmcnt(10)
    v_mfma_f32_16x16x32_bf16 v[108:111], v[224:227], v[200:203], v[108:111]
    buffer_load_dwordx4 v[216:219], v8, s[36:39], s75 offen offset:1024 sc1
    v_exp_f32 v12, v12
    v_exp_f32 v13, v13
    v_smfmac_f32_32x32x32_bf16 v[60:75], v[100:103], v[36:43], v254
    ds_read_b128 v[100:103], v3 offset:19712
    v_mfma_f32_32x32x16_bf16 v[28:43], v[88:91], v[80:83], 0
    v_exp_f32 v14, v14
    v_exp_f32 v15, v15
    v_exp_f32 v16, v16
    v_exp_f32 v17, v17
    s_waitcnt lgkmcnt(4)
    v_mfma_f32_16x16x32_bf16 v[128:131], v[220:223], v[204:207], v[128:131]
    v_mfma_f32_16x16x32_bf16 v[132:135], v[224:227], v[204:207], v[132:135]
    s_add_u32 m0, s68, 12288
    s_add_u32 s72, s70, s71
    buffer_load_dwordx4 v9, s[60:63], s72 offen offset:0  lds
    v_mfma_f32_32x32x8bf16_1k v[28:43], v[94:95], v[86:87], v[28:43]
    v_exp_f32 v18, v18
    v_exp_f32 v19, v19
    v_exp_f32 v20, v20
    v_exp_f32 v21, v21
    s_waitcnt lgkmcnt(2)
    v_mfma_f32_16x16x32_bf16 v[152:155], v[220:223], v[244:247], v[152:155]
    v_mfma_f32_16x16x32_bf16 v[156:159], v[224:227], v[244:247], v[156:159]
    buffer_load_dwordx4 v10, s[60:63], s72 offen offset:1024  lds
    v_smfmac_f32_32x32x32_bf16 v[44:59], v[96:99], v[12:19], v254
    v_exp_f32 v22, v22
    v_exp_f32 v23, v23
    v_exp_f32 v24, v24
    v_exp_f32 v25, v25
    s_waitcnt lgkmcnt(1)
    v_mfma_f32_16x16x32_bf16 v[176:179], v[220:223], v[248:251], v[176:179]
    v_mfma_f32_16x16x32_bf16 v[180:183], v[224:227], v[248:251], v[180:183]
    buffer_load_dwordx4 v[220:223], v8, s[36:39], s75 offen offset:1280 sc1
    s_waitcnt vmcnt(13)
    v_mfma_f32_16x16x32_bf16 v[112:115], v[228:231], v[200:203], v[112:115]
    s_waitcnt vmcnt(11)
    v_mfma_f32_16x16x32_bf16 v[116:119], v[232:235], v[200:203], v[116:119]
    buffer_load_dwordx4 v[224:227], v8, s[36:39], s75 offen offset:2048 sc1
    v_exp_f32 v26, v26
    v_exp_f32 v27, v27
    s_waitcnt lgkmcnt(0)
    s_barrier
    ds_read_b128 v[88:91], v1 offset:24576
    ds_read_b128 v[92:95], v2 offset:28672
    v_mfma_f32_16x16x32_bf16 v[136:139], v[228:231], v[204:207], v[136:139]
    v_mfma_f32_16x16x32_bf16 v[140:143], v[232:235], v[204:207], v[140:143]
    buffer_load_dwordx4 v11, s[60:63], s72 offen offset:2048  lds
    v_exp_f32 v28, v28
    v_exp_f32 v29, v29
    v_smfmac_f32_32x32x32_bf16 v[44:59], v[100:103], v[20:27], v254
    s_waitcnt lgkmcnt(1)
    v_mfma_f32_32x32x16_bf16 v[12:27], v[88:91], v[76:79], 0
    v_exp_f32 v30, v30
    v_exp_f32 v31, v31
    v_exp_f32 v32, v32
    v_exp_f32 v33, v33
    v_mfma_f32_16x16x32_bf16 v[160:163], v[228:231], v[244:247], v[160:163]
    v_mfma_f32_16x16x32_bf16 v[164:167], v[232:235], v[244:247], v[164:167]
    s_waitcnt lgkmcnt(0)
    v_mfma_f32_32x32x8bf16_1k v[12:27], v[92:93], v[84:85], v[12:27]
    v_exp_f32 v34, v34
    v_exp_f32 v35, v35
    v_exp_f32 v36, v36
    v_exp_f32 v37, v37
    v_mfma_f32_16x16x32_bf16 v[184:187], v[228:231], v[248:251], v[184:187]
    v_mfma_f32_16x16x32_bf16 v[188:191], v[232:235], v[248:251], v[188:191]
    buffer_load_dwordx4 v[228:231], v8, s[36:39], s75 offen offset:2304 sc1
    v_smfmac_f32_32x32x32_bf16 v[60:75], v[96:99], v[28:35], v254
    ds_read_b128 v[96:99], v3 offset:29696
    v_exp_f32 v38, v38
    v_exp_f32 v39, v39
    v_exp_f32 v40, v40
    v_exp_f32 v41, v41
    s_waitcnt vmcnt(13)
    v_mfma_f32_16x16x32_bf16 v[120:123], v[236:239], v[200:203], v[120:123]
    s_waitcnt vmcnt(10)
    v_mfma_f32_16x16x32_bf16 v[124:127], v[240:243], v[200:203], v[124:127]
    ds_read_b128 v[200:203], v5 offset:0
    s_mul_i32 s75, s74, 96
    s_add_u32 s74, s74, 128
    s_add_u32 s75, s75, s73
    s_and_b32 s74, s74, 0x3ff
    buffer_load_dwordx4 v[232:235], v8, s[36:39], s75 offen offset:0 sc1
    v_mfma_f32_16x16x32_bf16 v[144:147], v[236:239], v[204:207], v[144:147]
    v_mfma_f32_16x16x32_bf16 v[148:151], v[240:243], v[204:207], v[148:151]
    ds_read_b128 v[204:207], v7 offset:0
    buffer_load_dwordx4 v252, s[60:63], s72 offen offset:3072  lds
    s_add_u32 s71, s71, 128
    s_and_b32 s71, s71, 0x3ff
    v_exp_f32 v42, v42
    v_exp_f32 v43, v43
    v_mfma_f32_16x16x32_bf16 v[168:171], v[236:239], v[244:247], v[168:171]
    v_mfma_f32_16x16x32_bf16 v[172:175], v[240:243], v[244:247], v[172:175]
    ds_read_b128 v[244:247], v5 offset:4096
    v_exp_f32 v12, v12
    v_exp_f32 v13, v13
    v_smfmac_f32_32x32x32_bf16 v[60:75], v[100:103], v[36:43], v254
    ds_read_b128 v[100:103], v3 offset:30464
    v_mfma_f32_32x32x16_bf16 v[28:43], v[88:91], v[80:83], 0
    ds_read_b128 v[88:91], v1 offset:25600
    v_exp_f32 v14, v14
    v_exp_f32 v15, v15
    v_exp_f32 v16, v16
    v_mfma_f32_16x16x32_bf16 v[192:195], v[236:239], v[248:251], v[192:195]
    v_mfma_f32_16x16x32_bf16 v[196:199], v[240:243], v[248:251], v[196:199]
    ds_read_b128 v[248:251], v7 offset:4096
    buffer_load_dwordx4 v[236:239], v8, s[36:39], s75 offen offset:256 sc1
    v_mfma_f32_32x32x8bf16_1k v[28:43], v[92:93], v[86:87], v[28:43]
    v_exp_f32 v17, v17
    v_exp_f32 v18, v18
    v_exp_f32 v19, v19
    v_exp_f32 v20, v20
    s_waitcnt vmcnt(12) lgkmcnt(5)
    v_mfma_f32_16x16x32_bf16 v[104:107], v[208:211], v[200:203], v[104:107]
    s_waitcnt vmcnt(10)
    v_mfma_f32_16x16x32_bf16 v[108:111], v[212:215], v[200:203], v[108:111]
    buffer_load_dwordx4 v[240:243], v8, s[36:39], s75 offen offset:1024 sc1
    v_exp_f32 v21, v21
    v_exp_f32 v22, v22
    s_waitcnt lgkmcnt(4)
    v_mfma_f32_16x16x32_bf16 v[128:131], v[208:211], v[204:207], v[128:131]
    v_mfma_f32_16x16x32_bf16 v[132:135], v[212:215], v[204:207], v[132:135]
    s_add_u32 m0, s68, 0
    s_add_u32 s72, s69, s71
    buffer_load_dwordx4 v9, s[60:63], s72 offen offset:0  lds
    v_smfmac_f32_32x32x32_bf16 v[44:59], v[96:99], v[12:19], v254
    v_exp_f32 v23, v23
    v_exp_f32 v24, v24
    v_exp_f32 v25, v25
    s_waitcnt lgkmcnt(3)
    v_mfma_f32_16x16x32_bf16 v[152:155], v[208:211], v[244:247], v[152:155]
    v_mfma_f32_16x16x32_bf16 v[156:159], v[212:215], v[244:247], v[156:159]
    s_waitcnt lgkmcnt(0)
    v_mfma_f32_16x16x32_bf16 v[176:179], v[208:211], v[248:251], v[176:179]
    v_mfma_f32_16x16x32_bf16 v[180:183], v[212:215], v[248:251], v[180:183]
    buffer_load_dwordx4 v[208:211], v8, s[36:39], s75 offen offset:1280 sc1
    v_exp_f32 v26, v26
    v_exp_f32 v27, v27
    s_waitcnt vmcnt(12)
    v_mfma_f32_16x16x32_bf16 v[112:115], v[216:219], v[200:203], v[112:115]
    s_waitcnt vmcnt(9)
    v_mfma_f32_16x16x32_bf16 v[116:119], v[220:223], v[200:203], v[116:119]
    buffer_load_dwordx4 v[212:215], v8, s[36:39], s75 offen offset:2048 sc1
    v_exp_f32 v28, v28
    v_exp_f32 v29, v29
    v_smfmac_f32_32x32x32_bf16 v[44:59], v[100:103], v[20:27], v254
    v_mfma_f32_32x32x16_bf16 v[12:27], v[88:91], v[76:79], 0
    v_exp_f32 v30, v30
    v_exp_f32 v31, v31
    v_exp_f32 v32, v32
    v_exp_f32 v33, v33
    v_mfma_f32_16x16x32_bf16 v[136:139], v[216:219], v[204:207], v[136:139]
    v_mfma_f32_16x16x32_bf16 v[140:143], v[220:223], v[204:207], v[140:143]
    buffer_load_dwordx4 v10, s[60:63], s72 offen offset:1024  lds
    v_mfma_f32_32x32x8bf16_1k v[12:27], v[94:95], v[84:85], v[12:27]
    v_exp_f32 v34, v34
    v_exp_f32 v35, v35
    v_exp_f32 v36, v36
    v_exp_f32 v37, v37
    v_mfma_f32_16x16x32_bf16 v[160:163], v[216:219], v[244:247], v[160:163]
    v_mfma_f32_16x16x32_bf16 v[164:167], v[220:223], v[244:247], v[164:167]
    buffer_load_dwordx4 v11, s[60:63], s72 offen offset:2048  lds
    v_smfmac_f32_32x32x32_bf16 v[60:75], v[96:99], v[28:35], v254
    ds_read_b128 v[96:99], v3 offset:31232
    v_exp_f32 v38, v38
    v_exp_f32 v39, v39
    v_exp_f32 v40, v40
    v_exp_f32 v41, v41
    v_mfma_f32_16x16x32_bf16 v[184:187], v[216:219], v[248:251], v[184:187]
    v_mfma_f32_16x16x32_bf16 v[188:191], v[220:223], v[248:251], v[188:191]
    buffer_load_dwordx4 v[216:219], v8, s[36:39], s75 offen offset:2304 sc1
    s_waitcnt vmcnt(12)
    v_mfma_f32_16x16x32_bf16 v[120:123], v[224:227], v[200:203], v[120:123]
    s_waitcnt vmcnt(10)
    v_mfma_f32_16x16x32_bf16 v[124:127], v[228:231], v[200:203], v[124:127]
    ds_read_b128 v[200:203], v4 offset:8192
    s_add_u32 s75, s75, 6144
    buffer_load_dwordx4 v[220:223], v8, s[36:39], s75 offen offset:0 sc1
    v_exp_f32 v42, v42
    v_exp_f32 v43, v43
    v_mfma_f32_16x16x32_bf16 v[144:147], v[224:227], v[204:207], v[144:147]
    v_mfma_f32_16x16x32_bf16 v[148:151], v[228:231], v[204:207], v[148:151]
    ds_read_b128 v[204:207], v6 offset:8192
    buffer_load_dwordx4 v252, s[60:63], s72 offen offset:3072  lds
    v_exp_f32 v12, v12
    v_exp_f32 v13, v13
    v_smfmac_f32_32x32x32_bf16 v[60:75], v[100:103], v[36:43], v254
    ds_read_b128 v[100:103], v3 offset:32000
    v_mfma_f32_32x32x16_bf16 v[28:43], v[88:91], v[80:83], 0
    v_exp_f32 v14, v14
    v_exp_f32 v15, v15
    v_exp_f32 v16, v16
    v_exp_f32 v17, v17
    v_mfma_f32_16x16x32_bf16 v[168:171], v[224:227], v[244:247], v[168:171]
    v_mfma_f32_16x16x32_bf16 v[172:175], v[228:231], v[244:247], v[172:175]
    s_waitcnt vmcnt(10)
    ds_read_b128 v[244:247], v4 offset:12288
    v_mfma_f32_32x32x8bf16_1k v[28:43], v[94:95], v[86:87], v[28:43]
    v_exp_f32 v18, v18
    v_exp_f32 v19, v19
    v_exp_f32 v20, v20
    v_exp_f32 v21, v21
    v_mfma_f32_16x16x32_bf16 v[192:195], v[224:227], v[248:251], v[192:195]
    v_mfma_f32_16x16x32_bf16 v[196:199], v[228:231], v[248:251], v[196:199]
    ds_read_b128 v[248:251], v6 offset:12288
    buffer_load_dwordx4 v[224:227], v8, s[36:39], s75 offen offset:256 sc1
    s_waitcnt lgkmcnt(5)
    v_smfmac_f32_32x32x32_bf16 v[44:59], v[96:99], v[12:19], v254
    v_exp_f32 v22, v22
    v_exp_f32 v23, v23
    v_exp_f32 v24, v24
    v_exp_f32 v25, v25
    s_waitcnt lgkmcnt(4)
    v_mfma_f32_16x16x32_bf16 v[104:107], v[232:235], v[200:203], v[104:107]
    s_waitcnt vmcnt(10)
    v_mfma_f32_16x16x32_bf16 v[108:111], v[236:239], v[200:203], v[108:111]
    buffer_load_dwordx4 v[228:231], v8, s[36:39], s75 offen offset:1024 sc1
    s_waitcnt lgkmcnt(3)
    v_mfma_f32_16x16x32_bf16 v[128:131], v[232:235], v[204:207], v[128:131]
    v_mfma_f32_16x16x32_bf16 v[132:135], v[236:239], v[204:207], v[132:135]
    s_add_u32 m0, s68, 4096
    s_add_u32 s72, s70, s71
    buffer_load_dwordx4 v9, s[60:63], s72 offen offset:0  lds
    v_exp_f32 v26, v26
    v_exp_f32 v27, v27
    s_waitcnt lgkmcnt(2)
    s_barrier
    ds_read_b128 v[88:91], v1 offset:0
    ds_read_b128 v[92:95], v2 offset:4096
    s_waitcnt lgkmcnt(3)
    v_mfma_f32_16x16x32_bf16 v[152:155], v[232:235], v[244:247], v[152:155]
    v_mfma_f32_16x16x32_bf16 v[156:159], v[236:239], v[244:247], v[156:159]
    buffer_load_dwordx4 v10, s[60:63], s72 offen offset:1024  lds
    v_exp_f32 v28, v28
    v_exp_f32 v29, v29
    v_smfmac_f32_32x32x32_bf16 v[44:59], v[100:103], v[20:27], v254
    s_waitcnt lgkmcnt(1)
    v_mfma_f32_32x32x16_bf16 v[12:27], v[88:91], v[76:79], 0
    v_exp_f32 v30, v30
    v_exp_f32 v31, v31
    v_exp_f32 v32, v32
    v_mfma_f32_16x16x32_bf16 v[176:179], v[232:235], v[248:251], v[176:179]
    v_mfma_f32_16x16x32_bf16 v[180:183], v[236:239], v[248:251], v[180:183]
    buffer_load_dwordx4 v[232:235], v8, s[36:39], s75 offen offset:1280 sc1
    s_waitcnt lgkmcnt(0)
    v_mfma_f32_32x32x8bf16_1k v[12:27], v[92:93], v[84:85], v[12:27]
    v_exp_f32 v33, v33
    v_exp_f32 v34, v34
    v_exp_f32 v35, v35
    v_exp_f32 v36, v36
    s_waitcnt vmcnt(13)
    v_mfma_f32_16x16x32_bf16 v[112:115], v[240:243], v[200:203], v[112:115]
    s_waitcnt vmcnt(11)
    v_mfma_f32_16x16x32_bf16 v[116:119], v[208:211], v[200:203], v[116:119]
    buffer_load_dwordx4 v[236:239], v8, s[36:39], s75 offen offset:2048 sc1
    v_exp_f32 v37, v37
    v_exp_f32 v38, v38
    v_mfma_f32_16x16x32_bf16 v[136:139], v[240:243], v[204:207], v[136:139]
    v_mfma_f32_16x16x32_bf16 v[140:143], v[208:211], v[204:207], v[140:143]
    buffer_load_dwordx4 v11, s[60:63], s72 offen offset:2048  lds
    v_smfmac_f32_32x32x32_bf16 v[60:75], v[96:99], v[28:35], v254
    ds_read_b128 v[96:99], v3 offset:5120
    v_exp_f32 v39, v39
    v_exp_f32 v40, v40
    v_exp_f32 v41, v41
    v_mfma_f32_16x16x32_bf16 v[160:163], v[240:243], v[244:247], v[160:163]
    v_mfma_f32_16x16x32_bf16 v[164:167], v[208:211], v[244:247], v[164:167]
    v_mfma_f32_16x16x32_bf16 v[184:187], v[240:243], v[248:251], v[184:187]
    v_mfma_f32_16x16x32_bf16 v[188:191], v[208:211], v[248:251], v[188:191]
    buffer_load_dwordx4 v[240:243], v8, s[36:39], s75 offen offset:2304 sc1
    v_exp_f32 v42, v42
    v_exp_f32 v43, v43
    s_waitcnt vmcnt(13)
    v_mfma_f32_16x16x32_bf16 v[120:123], v[212:215], v[200:203], v[120:123]
    s_waitcnt vmcnt(10)
    v_mfma_f32_16x16x32_bf16 v[124:127], v[216:219], v[200:203], v[124:127]
    ds_read_b128 v[200:203], v5 offset:8192
    s_mul_i32 s75, s74, 96
    s_add_u32 s74, s74, 128
    s_add_u32 s75, s75, s73
    s_and_b32 s74, s74, 0x3ff
    buffer_load_dwordx4 v[208:211], v8, s[36:39], s75 offen offset:0 sc1
    v_exp_f32 v12, v12
    v_exp_f32 v13, v13
    v_smfmac_f32_32x32x32_bf16 v[60:75], v[100:103], v[36:43], v254
    ds_read_b128 v[100:103], v3 offset:5888
    v_mfma_f32_32x32x16_bf16 v[28:43], v[88:91], v[80:83], 0
    ds_read_b128 v[88:91], v1 offset:1024
    v_exp_f32 v14, v14
    v_exp_f32 v15, v15
    v_exp_f32 v16, v16
    v_exp_f32 v17, v17
    v_mfma_f32_16x16x32_bf16 v[144:147], v[212:215], v[204:207], v[144:147]
    v_mfma_f32_16x16x32_bf16 v[148:151], v[216:219], v[204:207], v[148:151]
    ds_read_b128 v[204:207], v7 offset:8192
    buffer_load_dwordx4 v252, s[60:63], s72 offen offset:3072  lds
    s_add_u32 s71, s71, 128
    s_and_b32 s71, s71, 0x3ff
    v_mfma_f32_32x32x8bf16_1k v[28:43], v[92:93], v[86:87], v[28:43]
    v_exp_f32 v18, v18
    v_exp_f32 v19, v19
    v_exp_f32 v20, v20
    v_exp_f32 v21, v21
    v_mfma_f32_16x16x32_bf16 v[168:171], v[212:215], v[244:247], v[168:171]
    v_mfma_f32_16x16x32_bf16 v[172:175], v[216:219], v[244:247], v[172:175]
    ds_read_b128 v[244:247], v5 offset:12288
    s_waitcnt lgkmcnt(5)
    v_smfmac_f32_32x32x32_bf16 v[44:59], v[96:99], v[12:19], v254
    v_exp_f32 v22, v22
    v_exp_f32 v23, v23
    v_exp_f32 v24, v24
    v_exp_f32 v25, v25
    v_mfma_f32_16x16x32_bf16 v[192:195], v[212:215], v[248:251], v[192:195]
    v_mfma_f32_16x16x32_bf16 v[196:199], v[216:219], v[248:251], v[196:199]
    ds_read_b128 v[248:251], v7 offset:12288
    buffer_load_dwordx4 v[212:215], v8, s[36:39], s75 offen offset:256 sc1
    s_waitcnt vmcnt(12) lgkmcnt(5)
    v_mfma_f32_16x16x32_bf16 v[104:107], v[220:223], v[200:203], v[104:107]
    s_waitcnt vmcnt(10)
    v_mfma_f32_16x16x32_bf16 v[108:111], v[224:227], v[200:203], v[108:111]
    buffer_load_dwordx4 v[216:219], v8, s[36:39], s75 offen offset:1024 sc1
    v_exp_f32 v26, v26
    v_exp_f32 v27, v27
    s_waitcnt lgkmcnt(2)
    v_mfma_f32_16x16x32_bf16 v[128:131], v[220:223], v[204:207], v[128:131]
    v_mfma_f32_16x16x32_bf16 v[132:135], v[224:227], v[204:207], v[132:135]
    s_add_u32 m0, s68, 8192
    s_add_u32 s72, s69, s71
    buffer_load_dwordx4 v9, s[60:63], s72 offen offset:0  lds
    v_exp_f32 v28, v28
    v_exp_f32 v29, v29
    v_smfmac_f32_32x32x32_bf16 v[44:59], v[100:103], v[20:27], v254
    v_mfma_f32_32x32x16_bf16 v[12:27], v[88:91], v[76:79], 0
    v_exp_f32 v30, v30
    v_exp_f32 v31, v31
    v_exp_f32 v32, v32
    v_exp_f32 v33, v33
    s_waitcnt lgkmcnt(1)
    v_mfma_f32_16x16x32_bf16 v[152:155], v[220:223], v[244:247], v[152:155]
    v_mfma_f32_16x16x32_bf16 v[156:159], v[224:227], v[244:247], v[156:159]
    v_mfma_f32_32x32x8bf16_1k v[12:27], v[94:95], v[84:85], v[12:27]
    v_exp_f32 v34, v34
    v_exp_f32 v35, v35
    v_exp_f32 v36, v36
    v_exp_f32 v37, v37
    s_waitcnt lgkmcnt(0)
    v_mfma_f32_16x16x32_bf16 v[176:179], v[220:223], v[248:251], v[176:179]
    v_mfma_f32_16x16x32_bf16 v[180:183], v[224:227], v[248:251], v[180:183]
    buffer_load_dwordx4 v[220:223], v8, s[36:39], s75 offen offset:1280 sc1
    v_smfmac_f32_32x32x32_bf16 v[60:75], v[96:99], v[28:35], v254
    ds_read_b128 v[96:99], v3 offset:6656
    v_exp_f32 v38, v38
    v_exp_f32 v39, v39
    v_exp_f32 v40, v40
    v_exp_f32 v41, v41
    s_waitcnt vmcnt(12)
    v_mfma_f32_16x16x32_bf16 v[112:115], v[228:231], v[200:203], v[112:115]
    s_waitcnt vmcnt(9)
    v_mfma_f32_16x16x32_bf16 v[116:119], v[232:235], v[200:203], v[116:119]
    buffer_load_dwordx4 v[224:227], v8, s[36:39], s75 offen offset:2048 sc1
    v_mfma_f32_16x16x32_bf16 v[136:139], v[228:231], v[204:207], v[136:139]
    v_mfma_f32_16x16x32_bf16 v[140:143], v[232:235], v[204:207], v[140:143]
    buffer_load_dwordx4 v10, s[60:63], s72 offen offset:1024  lds
    v_exp_f32 v42, v42
    v_exp_f32 v43, v43
    v_mfma_f32_16x16x32_bf16 v[160:163], v[228:231], v[244:247], v[160:163]
    v_mfma_f32_16x16x32_bf16 v[164:167], v[232:235], v[244:247], v[164:167]
    buffer_load_dwordx4 v11, s[60:63], s72 offen offset:2048  lds
    v_exp_f32 v12, v12
    v_exp_f32 v13, v13
    v_smfmac_f32_32x32x32_bf16 v[60:75], v[100:103], v[36:43], v254
    ds_read_b128 v[100:103], v3 offset:7424
    v_mfma_f32_32x32x16_bf16 v[28:43], v[88:91], v[80:83], 0
    v_exp_f32 v14, v14
    v_exp_f32 v15, v15
    v_exp_f32 v16, v16
    v_mfma_f32_16x16x32_bf16 v[184:187], v[228:231], v[248:251], v[184:187]
    v_mfma_f32_16x16x32_bf16 v[188:191], v[232:235], v[248:251], v[188:191]
    buffer_load_dwordx4 v[228:231], v8, s[36:39], s75 offen offset:2304 sc1
    v_mfma_f32_32x32x8bf16_1k v[28:43], v[94:95], v[86:87], v[28:43]
    v_exp_f32 v17, v17
    v_exp_f32 v18, v18
    v_exp_f32 v19, v19
    v_exp_f32 v20, v20
    s_waitcnt vmcnt(12)
    v_mfma_f32_16x16x32_bf16 v[120:123], v[236:239], v[200:203], v[120:123]
    s_waitcnt vmcnt(10)
    v_mfma_f32_16x16x32_bf16 v[124:127], v[240:243], v[200:203], v[124:127]
    ds_read_b128 v[200:203], v4 offset:0
    s_add_u32 s75, s75, 6144
    buffer_load_dwordx4 v[232:235], v8, s[36:39], s75 offen offset:0 sc1
    v_exp_f32 v21, v21
    v_exp_f32 v22, v22
    v_mfma_f32_16x16x32_bf16 v[144:147], v[236:239], v[204:207], v[144:147]
    v_mfma_f32_16x16x32_bf16 v[148:151], v[240:243], v[204:207], v[148:151]
    ds_read_b128 v[204:207], v6 offset:0
    buffer_load_dwordx4 v252, s[60:63], s72 offen offset:3072  lds
    s_waitcnt lgkmcnt(3)
    v_smfmac_f32_32x32x32_bf16 v[44:59], v[96:99], v[12:19], v254
    v_exp_f32 v23, v23
    v_exp_f32 v24, v24
    v_exp_f32 v25, v25
    v_mfma_f32_16x16x32_bf16 v[168:171], v[236:239], v[244:247], v[168:171]
    v_mfma_f32_16x16x32_bf16 v[172:175], v[240:243], v[244:247], v[172:175]
    s_waitcnt vmcnt(10)
    ds_read_b128 v[244:247], v4 offset:4096
    v_mfma_f32_16x16x32_bf16 v[192:195], v[236:239], v[248:251], v[192:195]
    v_mfma_f32_16x16x32_bf16 v[196:199], v[240:243], v[248:251], v[196:199]
    ds_read_b128 v[248:251], v6 offset:4096
    buffer_load_dwordx4 v[236:239], v8, s[36:39], s75 offen offset:256 sc1
    v_exp_f32 v26, v26
    v_exp_f32 v27, v27
    s_waitcnt lgkmcnt(4)
    s_barrier
    ds_read_b128 v[88:91], v1 offset:12288
    ds_read_b128 v[92:95], v2 offset:16384
    s_waitcnt lgkmcnt(5)
    v_mfma_f32_16x16x32_bf16 v[104:107], v[208:211], v[200:203], v[104:107]
    s_waitcnt vmcnt(10)
    v_mfma_f32_16x16x32_bf16 v[108:111], v[212:215], v[200:203], v[108:111]
    buffer_load_dwordx4 v[240:243], v8, s[36:39], s75 offen offset:1024 sc1
    v_exp_f32 v28, v28
    v_exp_f32 v29, v29
    v_smfmac_f32_32x32x32_bf16 v[44:59], v[100:103], v[20:27], v254
    s_waitcnt lgkmcnt(1)
    v_mfma_f32_32x32x16_bf16 v[12:27], v[88:91], v[76:79], 0
    v_exp_f32 v30, v30
    v_exp_f32 v31, v31
    v_exp_f32 v32, v32
    v_exp_f32 v33, v33
    v_mfma_f32_16x16x32_bf16 v[128:131], v[208:211], v[204:207], v[128:131]
    v_mfma_f32_16x16x32_bf16 v[132:135], v[212:215], v[204:207], v[132:135]
    s_add_u32 m0, s68, 12288
    s_add_u32 s72, s70, s71
    buffer_load_dwordx4 v9, s[60:63], s72 offen offset:0  lds
    s_waitcnt lgkmcnt(0)
    v_mfma_f32_32x32x8bf16_1k v[12:27], v[92:93], v[84:85], v[12:27]
    v_exp_f32 v34, v34
    v_exp_f32 v35, v35
    v_exp_f32 v36, v36
    v_exp_f32 v37, v37
    v_mfma_f32_16x16x32_bf16 v[152:155], v[208:211], v[244:247], v[152:155]
    v_mfma_f32_16x16x32_bf16 v[156:159], v[212:215], v[244:247], v[156:159]
    buffer_load_dwordx4 v10, s[60:63], s72 offen offset:1024  lds
    v_smfmac_f32_32x32x32_bf16 v[60:75], v[96:99], v[28:35], v254
    ds_read_b128 v[96:99], v3 offset:17408
    v_exp_f32 v38, v38
    v_exp_f32 v39, v39
    v_exp_f32 v40, v40
    v_exp_f32 v41, v41
    v_mfma_f32_16x16x32_bf16 v[176:179], v[208:211], v[248:251], v[176:179]
    v_mfma_f32_16x16x32_bf16 v[180:183], v[212:215], v[248:251], v[180:183]
    buffer_load_dwordx4 v[208:211], v8, s[36:39], s75 offen offset:1280 sc1
    s_waitcnt vmcnt(13)
    v_mfma_f32_16x16x32_bf16 v[112:115], v[216:219], v[200:203], v[112:115]
    s_waitcnt vmcnt(11)
    v_mfma_f32_16x16x32_bf16 v[116:119], v[220:223], v[200:203], v[116:119]
    buffer_load_dwordx4 v[212:215], v8, s[36:39], s75 offen offset:2048 sc1
    v_exp_f32 v42, v42
    v_exp_f32 v43, v43
    v_mfma_f32_16x16x32_bf16 v[136:139], v[216:219], v[204:207], v[136:139]
    v_mfma_f32_16x16x32_bf16 v[140:143], v[220:223], v[204:207], v[140:143]
    buffer_load_dwordx4 v11, s[60:63], s72 offen offset:2048  lds
    v_exp_f32 v12, v12
    v_exp_f32 v13, v13
    v_smfmac_f32_32x32x32_bf16 v[60:75], v[100:103], v[36:43], v254
    ds_read_b128 v[100:103], v3 offset:18176
    v_mfma_f32_32x32x16_bf16 v[28:43], v[88:91], v[80:83], 0
    ds_read_b128 v[88:91], v1 offset:13312
    v_exp_f32 v14, v14
    v_exp_f32 v15, v15
    v_exp_f32 v16, v16
    v_exp_f32 v17, v17
    v_mfma_f32_16x16x32_bf16 v[160:163], v[216:219], v[244:247], v[160:163]
    v_mfma_f32_16x16x32_bf16 v[164:167], v[220:223], v[244:247], v[164:167]
    v_mfma_f32_32x32x8bf16_1k v[28:43], v[92:93], v[86:87], v[28:43]
    v_exp_f32 v18, v18
    v_exp_f32 v19, v19
    v_exp_f32 v20, v20
    v_exp_f32 v21, v21
    v_mfma_f32_16x16x32_bf16 v[184:187], v[216:219], v[248:251], v[184:187]
    v_mfma_f32_16x16x32_bf16 v[188:191], v[220:223], v[248:251], v[188:191]
    buffer_load_dwordx4 v[216:219], v8, s[36:39], s75 offen offset:2304 sc1
    s_waitcnt lgkmcnt(2)
    v_smfmac_f32_32x32x32_bf16 v[44:59], v[96:99], v[12:19], v254
    v_exp_f32 v22, v22
    v_exp_f32 v23, v23
    v_exp_f32 v24, v24
    v_exp_f32 v25, v25
    s_waitcnt vmcnt(13)
    v_mfma_f32_16x16x32_bf16 v[120:123], v[224:227], v[200:203], v[120:123]
    s_waitcnt vmcnt(10)
    v_mfma_f32_16x16x32_bf16 v[124:127], v[228:231], v[200:203], v[124:127]
    ds_read_b128 v[200:203], v5 offset:0
    s_mul_i32 s75, s74, 96
    s_add_u32 s74, s74, 128
    s_add_u32 s75, s75, s73
    s_and_b32 s74, s74, 0x3ff
    buffer_load_dwordx4 v[220:223], v8, s[36:39], s75 offen offset:0 sc1
    v_mfma_f32_16x16x32_bf16 v[144:147], v[224:227], v[204:207], v[144:147]
    v_mfma_f32_16x16x32_bf16 v[148:151], v[228:231], v[204:207], v[148:151]
    ds_read_b128 v[204:207], v7 offset:0
    buffer_load_dwordx4 v252, s[60:63], s72 offen offset:3072  lds
    s_add_u32 s71, s71, 128
    s_and_b32 s71, s71, 0x3ff
    v_exp_f32 v26, v26
    v_exp_f32 v27, v27
    v_mfma_f32_16x16x32_bf16 v[168:171], v[224:227], v[244:247], v[168:171]
    v_mfma_f32_16x16x32_bf16 v[172:175], v[228:231], v[244:247], v[172:175]
    ds_read_b128 v[244:247], v5 offset:4096
    v_exp_f32 v28, v28
    v_exp_f32 v29, v29
    s_waitcnt lgkmcnt(4)
    v_smfmac_f32_32x32x32_bf16 v[44:59], v[100:103], v[20:27], v254
    s_waitcnt lgkmcnt(3)
    v_mfma_f32_32x32x16_bf16 v[12:27], v[88:91], v[76:79], 0
    v_exp_f32 v30, v30
    v_exp_f32 v31, v31
    v_exp_f32 v32, v32
    v_mfma_f32_16x16x32_bf16 v[192:195], v[224:227], v[248:251], v[192:195]
    v_mfma_f32_16x16x32_bf16 v[196:199], v[228:231], v[248:251], v[196:199]
    ds_read_b128 v[248:251], v7 offset:4096
    buffer_load_dwordx4 v[224:227], v8, s[36:39], s75 offen offset:256 sc1
    v_mfma_f32_32x32x8bf16_1k v[12:27], v[94:95], v[84:85], v[12:27]
    v_exp_f32 v33, v33
    v_exp_f32 v34, v34
    v_exp_f32 v35, v35
    v_exp_f32 v36, v36
    s_waitcnt vmcnt(12) lgkmcnt(3)
    v_mfma_f32_16x16x32_bf16 v[104:107], v[232:235], v[200:203], v[104:107]
    s_waitcnt vmcnt(10)
    v_mfma_f32_16x16x32_bf16 v[108:111], v[236:239], v[200:203], v[108:111]
    buffer_load_dwordx4 v[228:231], v8, s[36:39], s75 offen offset:1024 sc1
    v_exp_f32 v37, v37
    v_exp_f32 v38, v38
    s_waitcnt lgkmcnt(2)
    v_mfma_f32_16x16x32_bf16 v[128:131], v[232:235], v[204:207], v[128:131]
    v_mfma_f32_16x16x32_bf16 v[132:135], v[236:239], v[204:207], v[132:135]
    v_smfmac_f32_32x32x32_bf16 v[60:75], v[96:99], v[28:35], v254
    ds_read_b128 v[96:99], v3 offset:18944
    v_exp_f32 v39, v39
    v_exp_f32 v40, v40
    v_exp_f32 v41, v41
    s_waitcnt lgkmcnt(2)
    v_mfma_f32_16x16x32_bf16 v[152:155], v[232:235], v[244:247], v[152:155]
    v_mfma_f32_16x16x32_bf16 v[156:159], v[236:239], v[244:247], v[156:159]
    s_waitcnt lgkmcnt(1)
    v_mfma_f32_16x16x32_bf16 v[176:179], v[232:235], v[248:251], v[176:179]
    v_mfma_f32_16x16x32_bf16 v[180:183], v[236:239], v[248:251], v[180:183]
    buffer_load_dwordx4 v[232:235], v8, s[36:39], s75 offen offset:1280 sc1
    v_exp_f32 v42, v42
    v_exp_f32 v43, v43
    s_waitcnt vmcnt(11)
    v_mfma_f32_16x16x32_bf16 v[112:115], v[240:243], v[200:203], v[112:115]
    s_waitcnt vmcnt(8)
    v_mfma_f32_16x16x32_bf16 v[116:119], v[208:211], v[200:203], v[116:119]
    buffer_load_dwordx4 v[236:239], v8, s[36:39], s75 offen offset:2048 sc1
    v_exp_f32 v12, v12
    v_exp_f32 v13, v13
    v_smfmac_f32_32x32x32_bf16 v[60:75], v[100:103], v[36:43], v254
    ds_read_b128 v[100:103], v3 offset:19712
    v_mfma_f32_32x32x16_bf16 v[28:43], v[88:91], v[80:83], 0
    v_exp_f32 v14, v14
    v_exp_f32 v15, v15
    v_exp_f32 v16, v16
    v_exp_f32 v17, v17
    v_mfma_f32_16x16x32_bf16 v[136:139], v[240:243], v[204:207], v[136:139]
    v_mfma_f32_16x16x32_bf16 v[140:143], v[208:211], v[204:207], v[140:143]
    v_mfma_f32_32x32x8bf16_1k v[28:43], v[94:95], v[86:87], v[28:43]
    v_exp_f32 v18, v18
    v_exp_f32 v19, v19
    v_exp_f32 v20, v20
    v_exp_f32 v21, v21
    v_mfma_f32_16x16x32_bf16 v[160:163], v[240:243], v[244:247], v[160:163]
    v_mfma_f32_16x16x32_bf16 v[164:167], v[208:211], v[244:247], v[164:167]
    s_waitcnt lgkmcnt(1)
    v_smfmac_f32_32x32x32_bf16 v[44:59], v[96:99], v[12:19], v254
    v_exp_f32 v22, v22
    v_exp_f32 v23, v23
    v_exp_f32 v24, v24
    v_exp_f32 v25, v25
    v_mfma_f32_16x16x32_bf16 v[184:187], v[240:243], v[248:251], v[184:187]
    v_mfma_f32_16x16x32_bf16 v[188:191], v[208:211], v[248:251], v[188:191]
    buffer_load_dwordx4 v[240:243], v8, s[36:39], s75 offen offset:2304 sc1
    s_waitcnt vmcnt(9)
    v_mfma_f32_16x16x32_bf16 v[120:123], v[212:215], v[200:203], v[120:123]
    s_waitcnt vmcnt(7)
    v_mfma_f32_16x16x32_bf16 v[124:127], v[216:219], v[200:203], v[124:127]
    ds_read_b128 v[200:203], v4 offset:8192
    s_add_u32 s75, s75, 6144
    buffer_load_dwordx4 v[208:211], v8, s[36:39], s75 offen offset:0 sc1
    v_exp_f32 v26, v26
    v_exp_f32 v27, v27
    s_waitcnt lgkmcnt(1)
    s_barrier
    ds_read_b128 v[88:91], v1 offset:24576
    ds_read_b128 v[92:95], v2 offset:28672
    v_mfma_f32_16x16x32_bf16 v[144:147], v[212:215], v[204:207], v[144:147]
    v_mfma_f32_16x16x32_bf16 v[148:151], v[216:219], v[204:207], v[148:151]
    ds_read_b128 v[204:207], v6 offset:8192
    v_exp_f32 v28, v28
    v_exp_f32 v29, v29
    v_smfmac_f32_32x32x32_bf16 v[44:59], v[100:103], v[20:27], v254
    s_waitcnt lgkmcnt(2)
    v_mfma_f32_32x32x16_bf16 v[12:27], v[88:91], v[76:79], 0
    v_exp_f32 v30, v30
    v_exp_f32 v31, v31
    v_exp_f32 v32, v32
    v_exp_f32 v33, v33
    v_mfma_f32_16x16x32_bf16 v[168:171], v[212:215], v[244:247], v[168:171]
    v_mfma_f32_16x16x32_bf16 v[172:175], v[216:219], v[244:247], v[172:175]
    s_waitcnt vmcnt(6)
    ds_read_b128 v[244:247], v4 offset:12288
    s_waitcnt lgkmcnt(2)
    v_mfma_f32_32x32x8bf16_1k v[12:27], v[92:93], v[84:85], v[12:27]
    v_exp_f32 v34, v34
    v_exp_f32 v35, v35
    v_exp_f32 v36, v36
    v_exp_f32 v37, v37
    v_mfma_f32_16x16x32_bf16 v[192:195], v[212:215], v[248:251], v[192:195]
    v_mfma_f32_16x16x32_bf16 v[196:199], v[216:219], v[248:251], v[196:199]
    ds_read_b128 v[248:251], v6 offset:12288
    buffer_load_dwordx4 v[212:215], v8, s[36:39], s75 offen offset:256 sc1
    v_smfmac_f32_32x32x32_bf16 v[60:75], v[96:99], v[28:35], v254
    ds_read_b128 v[96:99], v3 offset:29696
    v_exp_f32 v38, v38
    v_exp_f32 v39, v39
    v_exp_f32 v40, v40
    v_exp_f32 v41, v41
    v_mfma_f32_16x16x32_bf16 v[104:107], v[220:223], v[200:203], v[104:107]
    s_waitcnt vmcnt(6)
    v_mfma_f32_16x16x32_bf16 v[108:111], v[224:227], v[200:203], v[108:111]
    buffer_load_dwordx4 v[216:219], v8, s[36:39], s75 offen offset:1024 sc1
    s_waitcnt lgkmcnt(3)
    v_mfma_f32_16x16x32_bf16 v[128:131], v[220:223], v[204:207], v[128:131]
    v_mfma_f32_16x16x32_bf16 v[132:135], v[224:227], v[204:207], v[132:135]
    v_exp_f32 v42, v42
    v_exp_f32 v43, v43
    s_waitcnt lgkmcnt(2)
    v_mfma_f32_16x16x32_bf16 v[152:155], v[220:223], v[244:247], v[152:155]
    v_mfma_f32_16x16x32_bf16 v[156:159], v[224:227], v[244:247], v[156:159]
    v_exp_f32 v12, v12
    v_exp_f32 v13, v13
    v_smfmac_f32_32x32x32_bf16 v[60:75], v[100:103], v[36:43], v254
    ds_read_b128 v[100:103], v3 offset:30464
    v_mfma_f32_32x32x16_bf16 v[28:43], v[88:91], v[80:83], 0
    ds_read_b128 v[88:91], v1 offset:25600
    v_exp_f32 v14, v14
    v_exp_f32 v15, v15
    v_exp_f32 v16, v16
    s_waitcnt lgkmcnt(3)
    v_mfma_f32_16x16x32_bf16 v[176:179], v[220:223], v[248:251], v[176:179]
    v_mfma_f32_16x16x32_bf16 v[180:183], v[224:227], v[248:251], v[180:183]
    buffer_load_dwordx4 v[220:223], v8, s[36:39], s75 offen offset:1280 sc1
    v_mfma_f32_32x32x8bf16_1k v[28:43], v[92:93], v[86:87], v[28:43]
    v_exp_f32 v17, v17
    v_exp_f32 v18, v18
    v_exp_f32 v19, v19
    v_exp_f32 v20, v20
    s_waitcnt vmcnt(7)
    v_mfma_f32_16x16x32_bf16 v[112:115], v[228:231], v[200:203], v[112:115]
    s_waitcnt vmcnt(6)
    v_mfma_f32_16x16x32_bf16 v[116:119], v[232:235], v[200:203], v[116:119]
    buffer_load_dwordx4 v[224:227], v8, s[36:39], s75 offen offset:2048 sc1
    v_exp_f32 v21, v21
    v_exp_f32 v22, v22
    v_mfma_f32_16x16x32_bf16 v[136:139], v[228:231], v[204:207], v[136:139]
    v_mfma_f32_16x16x32_bf16 v[140:143], v[232:235], v[204:207], v[140:143]
    s_waitcnt lgkmcnt(2)
    v_smfmac_f32_32x32x32_bf16 v[44:59], v[96:99], v[12:19], v254
    v_exp_f32 v23, v23
    v_exp_f32 v24, v24
    v_exp_f32 v25, v25
    v_mfma_f32_16x16x32_bf16 v[160:163], v[228:231], v[244:247], v[160:163]
    v_mfma_f32_16x16x32_bf16 v[164:167], v[232:235], v[244:247], v[164:167]
    v_mfma_f32_16x16x32_bf16 v[184:187], v[228:231], v[248:251], v[184:187]
    v_mfma_f32_16x16x32_bf16 v[188:191], v[232:235], v[248:251], v[188:191]
    buffer_load_dwordx4 v[228:231], v8, s[36:39], s75 offen offset:2304 sc1
    v_exp_f32 v26, v26
    v_exp_f32 v27, v27
    s_waitcnt vmcnt(7)
    v_mfma_f32_16x16x32_bf16 v[120:123], v[236:239], v[200:203], v[120:123]
    s_waitcnt vmcnt(6)
    v_mfma_f32_16x16x32_bf16 v[124:127], v[240:243], v[200:203], v[124:127]
    ds_read_b128 v[200:203], v5 offset:8192
    v_exp_f32 v28, v28
    v_exp_f32 v29, v29
    s_waitcnt lgkmcnt(2)
    v_smfmac_f32_32x32x32_bf16 v[44:59], v[100:103], v[20:27], v254
    s_waitcnt lgkmcnt(1)
    v_mfma_f32_32x32x16_bf16 v[12:27], v[88:91], v[76:79], 0
    v_exp_f32 v30, v30
    v_exp_f32 v31, v31
    v_exp_f32 v32, v32
    v_exp_f32 v33, v33
    v_mfma_f32_16x16x32_bf16 v[144:147], v[236:239], v[204:207], v[144:147]
    v_mfma_f32_16x16x32_bf16 v[148:151], v[240:243], v[204:207], v[148:151]
    ds_read_b128 v[204:207], v7 offset:8192
    v_mfma_f32_32x32x8bf16_1k v[12:27], v[94:95], v[84:85], v[12:27]
    v_exp_f32 v34, v34
    v_exp_f32 v35, v35
    v_exp_f32 v36, v36
    v_exp_f32 v37, v37
    v_mfma_f32_16x16x32_bf16 v[168:171], v[236:239], v[244:247], v[168:171]
    v_mfma_f32_16x16x32_bf16 v[172:175], v[240:243], v[244:247], v[172:175]
    ds_read_b128 v[244:247], v5 offset:12288
    v_smfmac_f32_32x32x32_bf16 v[60:75], v[96:99], v[28:35], v254
    ds_read_b128 v[96:99], v3 offset:31232
    v_exp_f32 v38, v38
    v_exp_f32 v39, v39
    v_exp_f32 v40, v40
    v_exp_f32 v41, v41
    v_mfma_f32_16x16x32_bf16 v[192:195], v[236:239], v[248:251], v[192:195]
    v_mfma_f32_16x16x32_bf16 v[196:199], v[240:243], v[248:251], v[196:199]
    ds_read_b128 v[248:251], v7 offset:12288
    s_waitcnt vmcnt(5) lgkmcnt(4)
    v_mfma_f32_16x16x32_bf16 v[104:107], v[208:211], v[200:203], v[104:107]
    s_waitcnt vmcnt(4)
    v_mfma_f32_16x16x32_bf16 v[108:111], v[212:215], v[200:203], v[108:111]
    v_exp_f32 v42, v42
    v_exp_f32 v43, v43
    s_waitcnt lgkmcnt(3)
    v_mfma_f32_16x16x32_bf16 v[128:131], v[208:211], v[204:207], v[128:131]
    v_mfma_f32_16x16x32_bf16 v[132:135], v[212:215], v[204:207], v[132:135]
    v_exp_f32 v12, v12
    v_exp_f32 v13, v13
    v_smfmac_f32_32x32x32_bf16 v[60:75], v[100:103], v[36:43], v254
    ds_read_b128 v[100:103], v3 offset:32000
    v_mfma_f32_32x32x16_bf16 v[28:43], v[88:91], v[80:83], 0
    v_exp_f32 v14, v14
    v_exp_f32 v15, v15
    v_exp_f32 v16, v16
    v_exp_f32 v17, v17
    s_waitcnt lgkmcnt(3)
    v_mfma_f32_16x16x32_bf16 v[152:155], v[208:211], v[244:247], v[152:155]
    v_mfma_f32_16x16x32_bf16 v[156:159], v[212:215], v[244:247], v[156:159]
    v_mfma_f32_32x32x8bf16_1k v[28:43], v[94:95], v[86:87], v[28:43]
    v_exp_f32 v18, v18
    v_exp_f32 v19, v19
    v_exp_f32 v20, v20
    v_exp_f32 v21, v21
    s_waitcnt lgkmcnt(1)
    v_mfma_f32_16x16x32_bf16 v[176:179], v[208:211], v[248:251], v[176:179]
    v_mfma_f32_16x16x32_bf16 v[180:183], v[212:215], v[248:251], v[180:183]
    v_smfmac_f32_32x32x32_bf16 v[44:59], v[96:99], v[12:19], v254
    v_exp_f32 v22, v22
    v_exp_f32 v23, v23
    v_exp_f32 v24, v24
    v_exp_f32 v25, v25
    s_waitcnt vmcnt(3)
    v_mfma_f32_16x16x32_bf16 v[112:115], v[216:219], v[200:203], v[112:115]
    s_waitcnt vmcnt(2)
    v_mfma_f32_16x16x32_bf16 v[116:119], v[220:223], v[200:203], v[116:119]
    v_mfma_f32_16x16x32_bf16 v[136:139], v[216:219], v[204:207], v[136:139]
    v_mfma_f32_16x16x32_bf16 v[140:143], v[220:223], v[204:207], v[140:143]
    v_exp_f32 v26, v26
    v_exp_f32 v27, v27
    s_waitcnt lgkmcnt(0)
    s_barrier
    ds_read_b128 v[88:91], v1 offset:0
    ds_read_b128 v[92:95], v2 offset:4096
    v_mfma_f32_16x16x32_bf16 v[160:163], v[216:219], v[244:247], v[160:163]
    v_mfma_f32_16x16x32_bf16 v[164:167], v[220:223], v[244:247], v[164:167]
    v_exp_f32 v28, v28
    v_exp_f32 v29, v29
    v_smfmac_f32_32x32x32_bf16 v[44:59], v[100:103], v[20:27], v254
    s_waitcnt lgkmcnt(1)
    v_mfma_f32_32x32x16_bf16 v[12:27], v[88:91], v[76:79], 0
    v_exp_f32 v30, v30
    v_exp_f32 v31, v31
    v_exp_f32 v32, v32
    v_mfma_f32_16x16x32_bf16 v[184:187], v[216:219], v[248:251], v[184:187]
    v_mfma_f32_16x16x32_bf16 v[188:191], v[220:223], v[248:251], v[188:191]
    s_waitcnt lgkmcnt(0)
    v_mfma_f32_32x32x8bf16_1k v[12:27], v[92:93], v[84:85], v[12:27]
    v_exp_f32 v33, v33
    v_exp_f32 v34, v34
    v_exp_f32 v35, v35
    v_exp_f32 v36, v36
    s_waitcnt vmcnt(1)
    v_mfma_f32_16x16x32_bf16 v[120:123], v[224:227], v[200:203], v[120:123]
    s_waitcnt vmcnt(0)
    v_mfma_f32_16x16x32_bf16 v[124:127], v[228:231], v[200:203], v[124:127]
    v_exp_f32 v37, v37
    v_exp_f32 v38, v38
    v_mfma_f32_16x16x32_bf16 v[144:147], v[224:227], v[204:207], v[144:147]
    v_mfma_f32_16x16x32_bf16 v[148:151], v[228:231], v[204:207], v[148:151]
    v_smfmac_f32_32x32x32_bf16 v[60:75], v[96:99], v[28:35], v254
    ds_read_b128 v[96:99], v3 offset:5120
    v_exp_f32 v39, v39
    v_exp_f32 v40, v40
    v_exp_f32 v41, v41
    v_mfma_f32_16x16x32_bf16 v[168:171], v[224:227], v[244:247], v[168:171]
    v_mfma_f32_16x16x32_bf16 v[172:175], v[228:231], v[244:247], v[172:175]
    v_mfma_f32_16x16x32_bf16 v[192:195], v[224:227], v[248:251], v[192:195]
    v_mfma_f32_16x16x32_bf16 v[196:199], v[228:231], v[248:251], v[196:199]
    v_exp_f32 v42, v42
    v_exp_f32 v43, v43
    v_lshlrev_b32 v240, 4, v0
    v_add_u32 v228, s68, v240
    s_lshl_b32 s48, s52, 12
    s_add_u32 s48, s48, 127488
    v_add_u32 v224, s48, v240
    v_exp_f32 v12, v12
    v_exp_f32 v13, v13
    s_lshl_b32 s48, s54, 12
    s_lshl_b32 s49, s53, 8
    s_add_u32 s48, s48, s49
    s_add_u32 s48, s48, 127488
    v_lshrrev_b32 v242, 5, v0
    v_mul_u32_u24 v242, 5120, v242
    v_add3_u32 v223, v242, v8, s48
    v_smfmac_f32_32x32x32_bf16 v[60:75], v[100:103], v[36:43], v254
    ds_read_b128 v[100:103], v3 offset:5888
    v_exp_f32 v14, v14
    ds_read_b32 v220, v223 offset:3072
    v_exp_f32 v15, v15
    v_mfma_f32_32x32x16_bf16 v[28:43], v[88:91], v[80:83], 0
    ds_read_b128 v[88:91], v1 offset:1024
    ds_read_b128 v[208:211], v223 offset:0
    v_exp_f32 v16, v16
    v_mfma_f32_32x32x8bf16_1k v[28:43], v[92:93], v[86:87], v[28:43]
    ds_read_b128 v[212:215], v223 offset:1024
    v_exp_f32 v17, v17
    v_exp_f32 v18, v18
    ds_read_b128 v[216:219], v223 offset:2048
    v_exp_f32 v19, v19
    v_exp_f32 v20, v20
    s_lshl_b32 s48, s32, 2
    s_add_u32 s48, s48, s52
    s_lshl_b32 s49, s48, 5
    v_bfe_u32 v242, v253, 6, 5
    ds_read_b32 v222, v224 offset:3072
    buffer_load_ushort v221, v242, s[64:67], s49 offen
    v_exp_f32 v21, v21
    ds_write_b128 v228, v[152:155] offset:6144
    s_waitcnt lgkmcnt(8)
    v_smfmac_f32_32x32x32_bf16 v[44:59], v[96:99], v[12:19], v254
    v_exp_f32 v22, v22
    ds_write_b128 v228, v[156:159] offset:7168
    v_exp_f32 v23, v23
    v_exp_f32 v24, v24
    ds_write_b128 v228, v[160:163] offset:8192
    v_exp_f32 v25, v25
    v_exp_f32 v26, v26
    ds_write_b128 v228, v[164:167] offset:9216
    v_exp_f32 v27, v27
    v_exp_f32 v28, v28
    ds_write_b128 v228, v[168:171] offset:10240
    v_exp_f32 v29, v29
    s_waitcnt lgkmcnt(11)
    v_smfmac_f32_32x32x32_bf16 v[44:59], v[100:103], v[20:27], v254
    ds_write_b128 v228, v[172:175] offset:11264
    v_exp_f32 v30, v30
    v_exp_f32 v31, v31
    s_xor_b32 s48, s52, 2
    s_mul_i32 s48, s48, 18432
    v_add_u32 v230, s48, v240
    s_waitcnt lgkmcnt(10)
    v_mfma_f32_32x32x16_bf16 v[12:27], v[88:91], v[76:79], 0
    v_exp_f32 v32, v32
    ds_write_b128 v228, v[128:131] offset:0
    v_mfma_f32_32x32x8bf16_1k v[12:27], v[94:95], v[84:85], v[12:27]
    ds_write_b128 v228, v[132:135] offset:1024
    v_exp_f32 v33, v33
    v_exp_f32 v34, v34
    ds_write_b128 v228, v[136:139] offset:2048
    v_exp_f32 v35, v35
    v_exp_f32 v36, v36
    ds_write_b128 v228, v[140:143] offset:3072
    v_exp_f32 v37, v37
    v_smfmac_f32_32x32x32_bf16 v[60:75], v[96:99], v[28:35], v254
    ds_read_b128 v[96:99], v3 offset:6656
    ds_write_b128 v228, v[144:147] offset:4096
    v_exp_f32 v38, v38
    v_exp_f32 v39, v39
    ds_write_b128 v228, v[148:151] offset:5120
    v_exp_f32 v40, v40
    v_exp_f32 v41, v41
    s_xor_b32 s48, s52, 1
    s_mul_i32 s48, s48, 18432
    v_add_u32 v229, s48, v240
    v_exp_f32 v42, v42
    v_exp_f32 v43, v43
    ds_write_b128 v228, v[176:179] offset:12288
    v_exp_f32 v12, v12
    ds_write_b128 v228, v[180:183] offset:13312
    v_exp_f32 v13, v13
    v_smfmac_f32_32x32x32_bf16 v[60:75], v[100:103], v[36:43], v254
    ds_read_b128 v[100:103], v3 offset:7424
    ds_write_b128 v228, v[184:187] offset:14336
    v_exp_f32 v14, v14
    v_exp_f32 v15, v15
    ds_write_b128 v228, v[188:191] offset:15360
    v_mfma_f32_32x32x16_bf16 v[28:43], v[88:91], v[80:83], 0
    v_exp_f32 v16, v16
    ds_write_b128 v228, v[192:195] offset:16384
    v_mfma_f32_32x32x8bf16_1k v[28:43], v[94:95], v[86:87], v[28:43]
    v_exp_f32 v17, v17
    ds_write_b128 v228, v[196:199] offset:17408
    v_exp_f32 v18, v18
    v_exp_f32 v19, v19
    s_xor_b32 s48, s52, 3
    s_mul_i32 s48, s48, 18432
    v_add_u32 v231, s48, v240
    v_exp_f32 v20, v20
    v_exp_f32 v21, v21
    s_waitcnt lgkmcnt(9)
    v_smfmac_f32_32x32x32_bf16 v[44:59], v[96:99], v[12:19], v254
    v_exp_f32 v22, v22
    v_exp_f32 v23, v23
    v_exp_f32 v24, v24
    v_exp_f32 v25, v25
    v_exp_f32 v26, v26
    v_exp_f32 v27, v27
    s_waitcnt lgkmcnt(0)
    s_barrier
    ds_read_b128 v[128:131], v229 offset:0
    ds_read_b128 v[152:155], v230 offset:6144
    ds_read_b128 v[88:91], v1 offset:12288
    ds_read_b128 v[92:95], v2 offset:16384
    ds_read_b128 v[176:179], v231 offset:12288
    ds_read_b128 v[132:135], v229 offset:1024
    v_exp_f32 v28, v28
    ds_read_b128 v[156:159], v230 offset:7168
    ds_read_b128 v[180:183], v231 offset:13312
    v_exp_f32 v29, v29
    s_waitcnt vmcnt(0)
    v_sub_f32 v220, 1.0, v220
    v_lshlrev_b32 v221, 16, v221
    v_mul_f32 v221, v220, v221
    v_bfe_u32 v224, v0, 4, 1
    v_mul_u32_u24 v232, 45056, v224
    v_and_b32 v224, 15, v0
    v_smfmac_f32_32x32x32_bf16 v[44:59], v[100:103], v[20:27], v254
    v_cmp_gt_u32 vcc, 32, v0
    v_lshl_add_u32 v232, v224, 4, v232
    v_lshrrev_b32 v224, 5, v0
    v_cndmask_b32 v233, -4.0, v232, vcc
    v_lshl_add_u32 v232, v224, 8, v232
    v_mov_b64 v[244:245], -1
    v_mov_b64 v[246:247], -1
    v_exp_f32 v30, v30
    buffer_store_dwordx4 v[244:247], v232, s[36:39], s79 offen sc1
    v_exp_f32 v31, v31
    buffer_store_dwordx4 v[244:247], v232, s[36:39], s79 offen offset:512 sc1
    buffer_store_dwordx4 v[244:247], v233, s[36:39], s80 offen sc1
    s_waitcnt lgkmcnt(5)
    v_mfma_f32_32x32x16_bf16 v[12:27], v[88:91], v[76:79], 0
    s_waitcnt lgkmcnt(3)
    v_add_f32 v104, v104, v128
    v_add_f32 v105, v105, v129
    v_add_f32 v152, v152, v176
    v_add_f32 v153, v153, v177
    v_lshlrev_b32 v224, 16, v208
    v_add_f32 v104, v104, v152
    v_add_f32 v105, v105, v153
    v_exp_f32 v32, v32
    v_and_b32 v225, 0xffff0000, v208
    v_fma_f32 v104, v104, v220, v221
    v_fma_f32 v105, v105, v220, v221
    v_mul_f32 v104, v104, v224
    v_mul_f32 v105, v105, v225
    v_cvt_pk_bf16_f32 v208, v104, v105
    v_mfma_f32_32x32x8bf16_1k v[12:27], v[92:93], v[84:85], v[12:27]
    ds_read_b128 v[136:139], v229 offset:2048
    ds_read_b128 v[160:163], v230 offset:8192
    v_exp_f32 v33, v33
    v_add_f32 v106, v106, v130
    v_add_f32 v107, v107, v131
    v_add_f32 v154, v154, v178
    v_add_f32 v155, v155, v179
    v_lshlrev_b32 v224, 16, v209
    v_add_f32 v106, v106, v154
    v_add_f32 v107, v107, v155
    v_exp_f32 v34, v34
    v_and_b32 v225, 0xffff0000, v209
    v_fma_f32 v106, v106, v220, v221
    v_fma_f32 v107, v107, v220, v221
    v_mul_f32 v106, v106, v224
    v_mul_f32 v107, v107, v225
    v_cvt_pk_bf16_f32 v209, v106, v107
    v_exp_f32 v35, v35
    ds_read_b128 v[184:187], v231 offset:14336
    ds_read_b128 v[140:143], v229 offset:3072
    v_exp_f32 v36, v36
    s_waitcnt lgkmcnt(4)
    v_add_f32 v108, v108, v132
    v_add_f32 v109, v109, v133
    v_add_f32 v156, v156, v180
    v_add_f32 v157, v157, v181
    v_lshlrev_b32 v224, 16, v210
    v_add_f32 v108, v108, v156
    v_add_f32 v109, v109, v157
    v_exp_f32 v37, v37
    v_and_b32 v225, 0xffff0000, v210
    v_fma_f32 v108, v108, v220, v221
    v_fma_f32 v109, v109, v220, v221
    v_mul_f32 v108, v108, v224
    v_mul_f32 v109, v109, v225
    v_cvt_pk_bf16_f32 v210, v108, v109
    v_smfmac_f32_32x32x32_bf16 v[60:75], v[96:99], v[28:35], v254
    ds_read_b128 v[96:99], v3 offset:17408
    ds_read_b128 v[164:167], v230 offset:9216
    v_exp_f32 v38, v38
    ds_read_b128 v[188:191], v231 offset:15360
    v_add_f32 v110, v110, v134
    v_add_f32 v111, v111, v135
    v_add_f32 v158, v158, v182
    v_add_f32 v159, v159, v183
    v_exp_f32 v39, v39
    v_lshlrev_b32 v224, 16, v211
    v_add_f32 v110, v110, v158
    v_add_f32 v111, v111, v159
    v_and_b32 v225, 0xffff0000, v211
    v_fma_f32 v110, v110, v220, v221
    v_fma_f32 v111, v111, v220, v221
    v_exp_f32 v40, v40
    v_mul_f32 v110, v110, v224
    v_mul_f32 v111, v111, v225
    v_cvt_pk_bf16_f32 v211, v110, v111
    buffer_store_dwordx4 v[208:211], v240, s[36:39], s78 offen offset:0 sc1
    v_exp_f32 v41, v41
    s_waitcnt lgkmcnt(4)
    v_add_f32 v112, v112, v136
    v_add_f32 v113, v113, v137
    v_add_f32 v160, v160, v184
    v_add_f32 v161, v161, v185
    v_lshlrev_b32 v224, 16, v212
    v_add_f32 v112, v112, v160
    v_add_f32 v113, v113, v161
    v_exp_f32 v42, v42
    v_and_b32 v225, 0xffff0000, v212
    v_fma_f32 v112, v112, v220, v221
    v_fma_f32 v113, v113, v220, v221
    v_mul_f32 v112, v112, v224
    v_mul_f32 v113, v113, v225
    v_cvt_pk_bf16_f32 v212, v112, v113
    v_exp_f32 v43, v43
    ds_read_b128 v[144:147], v229 offset:4096
    ds_read_b128 v[168:171], v230 offset:10240
    v_exp_f32 v12, v12
    v_add_f32 v114, v114, v138
    v_add_f32 v115, v115, v139
    v_add_f32 v162, v162, v186
    v_add_f32 v163, v163, v187
    v_lshlrev_b32 v224, 16, v213
    v_add_f32 v114, v114, v162
    v_add_f32 v115, v115, v163
    v_exp_f32 v13, v13
    v_and_b32 v225, 0xffff0000, v213
    v_fma_f32 v114, v114, v220, v221
    v_fma_f32 v115, v115, v220, v221
    v_mul_f32 v114, v114, v224
    v_mul_f32 v115, v115, v225
    v_cvt_pk_bf16_f32 v213, v114, v115
    v_smfmac_f32_32x32x32_bf16 v[60:75], v[100:103], v[36:43], v254
    ds_read_b128 v[100:103], v3 offset:18176
    ds_read_b128 v[192:195], v231 offset:16384
    ds_read_b128 v[148:151], v229 offset:5120
    v_exp_f32 v14, v14
    s_waitcnt lgkmcnt(5)
    v_add_f32 v116, v116, v140
    v_add_f32 v117, v117, v141
    v_add_f32 v164, v164, v188
    v_add_f32 v165, v165, v189
    v_exp_f32 v15, v15
    v_lshlrev_b32 v224, 16, v214
    v_add_f32 v116, v116, v164
    v_add_f32 v117, v117, v165
    v_and_b32 v225, 0xffff0000, v214
    v_fma_f32 v116, v116, v220, v221
    v_fma_f32 v117, v117, v220, v221
    v_mfma_f32_32x32x16_bf16 v[28:43], v[88:91], v[80:83], 0
    ds_read_b128 v[88:91], v1 offset:13312
    v_mul_f32 v116, v116, v224
    v_mul_f32 v117, v117, v225
    v_cvt_pk_bf16_f32 v214, v116, v117
    ds_read_b128 v[172:175], v230 offset:11264
    v_exp_f32 v16, v16
    ds_read_b128 v[196:199], v231 offset:17408
    v_add_f32 v118, v118, v142
    v_add_f32 v119, v119, v143
    v_add_f32 v166, v166, v190
    v_add_f32 v167, v167, v191
    v_mfma_f32_32x32x8bf16_1k v[28:43], v[92:93], v[86:87], v[28:43]
    v_lshlrev_b32 v224, 16, v215
    v_add_f32 v118, v118, v166
    v_add_f32 v119, v119, v167
    v_and_b32 v225, 0xffff0000, v215
    v_fma_f32 v118, v118, v220, v221
    v_fma_f32 v119, v119, v220, v221
    v_exp_f32 v17, v17
    v_mul_f32 v118, v118, v224
    v_mul_f32 v119, v119, v225
    v_cvt_pk_bf16_f32 v215, v118, v119
    buffer_store_dwordx4 v[212:215], v240, s[36:39], s78 offen offset:1024 sc1
    v_exp_f32 v18, v18
    s_waitcnt lgkmcnt(4)
    v_add_f32 v120, v120, v144
    v_add_f32 v121, v121, v145
    v_add_f32 v168, v168, v192
    v_add_f32 v169, v169, v193
    v_lshlrev_b32 v224, 16, v216
    v_add_f32 v120, v120, v168
    v_add_f32 v121, v121, v169
    v_exp_f32 v19, v19
    v_and_b32 v225, 0xffff0000, v216
    v_fma_f32 v120, v120, v220, v221
    v_fma_f32 v121, v121, v220, v221
    v_mul_f32 v120, v120, v224
    v_mul_f32 v121, v121, v225
    v_cvt_pk_bf16_f32 v216, v120, v121
    v_exp_f32 v20, v20
    v_add_f32 v122, v122, v146
    v_add_f32 v123, v123, v147
    v_add_f32 v170, v170, v194
    v_add_f32 v171, v171, v195
    v_lshlrev_b32 v224, 16, v217
    v_add_f32 v122, v122, v170
    v_add_f32 v123, v123, v171
    v_exp_f32 v21, v21
    v_and_b32 v225, 0xffff0000, v217
    v_fma_f32 v122, v122, v220, v221
    v_fma_f32 v123, v123, v220, v221
    v_mul_f32 v122, v122, v224
    v_mul_f32 v123, v123, v225
    v_cvt_pk_bf16_f32 v217, v122, v123
    v_smfmac_f32_32x32x32_bf16 v[44:59], v[96:99], v[12:19], v254
    s_waitcnt lgkmcnt(0)
    v_add_f32 v124, v124, v148
    v_add_f32 v125, v125, v149
    v_add_f32 v172, v172, v196
    v_add_f32 v173, v173, v197
    v_exp_f32 v22, v22
    v_lshlrev_b32 v224, 16, v218
    v_add_f32 v124, v124, v172
    v_add_f32 v125, v125, v173
    v_and_b32 v225, 0xffff0000, v218
    v_fma_f32 v124, v124, v220, v221
    v_fma_f32 v125, v125, v220, v221
    v_exp_f32 v23, v23
    v_mul_f32 v124, v124, v224
    v_mul_f32 v125, v125, v225
    v_cvt_pk_bf16_f32 v218, v124, v125
    v_add_f32 v126, v126, v150
    v_add_f32 v127, v127, v151
    v_add_f32 v174, v174, v198
    v_add_f32 v175, v175, v199
    v_exp_f32 v24, v24
    v_lshlrev_b32 v224, 16, v219
    v_add_f32 v126, v126, v174
    v_add_f32 v127, v127, v175
    v_and_b32 v225, 0xffff0000, v219
    v_fma_f32 v126, v126, v220, v221
    v_fma_f32 v127, v127, v220, v221
    v_exp_f32 v25, v25
    v_mul_f32 v126, v126, v224
    v_mul_f32 v127, v127, v225
    v_cvt_pk_bf16_f32 v219, v126, v127
    buffer_store_dwordx4 v[216:219], v240, s[36:39], s78 offen offset:2048 sc1
    v_exp_f32 v26, v26
    s_lshl_b32 s48, s33, 2
    s_add_u32 s48, s48, s52
    s_mul_i32 s85, s48, 56320
    s_add_u32 s85, s85, 0x1169800
    s_or_b32 s48, s2, s52
    s_cmp_eq_u32 s48, 0
    s_cselect_b32 s56, 1, 0
    s_mov_b32 s57, 0
    v_mov_b32 v225, s59
    v_cndmask_b32 v224, -4.0, v0, s[56:57]
    s_mov_b32 s48, 0x135b000
    buffer_store_dword v225, v224, s[36:39], s48 offen sc1
    v_exp_f32 v27, v27
    v_exp_f32 v28, v28
    v_exp_f32 v29, v29
    v_smfmac_f32_32x32x32_bf16 v[44:59], v[100:103], v[20:27], v254
    v_exp_f32 v30, v30
    buffer_load_dwordx4 v[104:107], v240, s[36:39], s85 offen offset:0 sc1
    v_exp_f32 v31, v31
    v_mfma_f32_32x32x16_bf16 v[12:27], v[88:91], v[76:79], 0
    v_exp_f32 v32, v32
    v_mfma_f32_32x32x8bf16_1k v[12:27], v[94:95], v[84:85], v[12:27]
    v_exp_f32 v33, v33
    v_exp_f32 v34, v34
    buffer_load_dwordx4 v[108:111], v240, s[36:39], s85 offen offset:1024 sc1
    v_exp_f32 v35, v35
    v_exp_f32 v36, v36
    v_exp_f32 v37, v37
    v_smfmac_f32_32x32x32_bf16 v[60:75], v[96:99], v[28:35], v254
    ds_read_b128 v[96:99], v3 offset:18944
    v_exp_f32 v38, v38
    v_exp_f32 v39, v39
    v_exp_f32 v40, v40
    buffer_load_dwordx4 v[112:115], v240, s[36:39], s85 offen offset:2048 sc1
    v_exp_f32 v41, v41
    v_exp_f32 v42, v42
    v_exp_f32 v43, v43
    v_exp_f32 v12, v12
    v_exp_f32 v13, v13
    v_smfmac_f32_32x32x32_bf16 v[60:75], v[100:103], v[36:43], v254
    ds_read_b128 v[100:103], v3 offset:19712
    buffer_load_dwordx4 v[116:119], v240, s[36:39], s85 offen offset:3072 sc1
    v_exp_f32 v14, v14
    v_exp_f32 v15, v15
    v_mfma_f32_32x32x16_bf16 v[28:43], v[88:91], v[80:83], 0
    v_exp_f32 v16, v16
    v_mfma_f32_32x32x8bf16_1k v[28:43], v[94:95], v[86:87], v[28:43]
    v_exp_f32 v17, v17
    s_add_u32 s85, s85, 0x1000
    buffer_load_dwordx4 v[120:123], v240, s[36:39], s85 offen offset:0 sc1
    v_exp_f32 v18, v18
    v_exp_f32 v19, v19
    v_exp_f32 v20, v20
    s_mov_b64 exec, 1
    s_waitcnt vmcnt(6)
    buffer_store_dword v225, off, s[36:39], s84 sc1
    s_mov_b64 exec, -1
    v_exp_f32 v21, v21
    s_waitcnt lgkmcnt(1)
    v_smfmac_f32_32x32x32_bf16 v[44:59], v[96:99], v[12:19], v254
    v_exp_f32 v22, v22
    buffer_load_dwordx4 v[124:127], v240, s[36:39], s85 offen offset:1024 sc1
    v_exp_f32 v23, v23
    v_exp_f32 v24, v24
    v_exp_f32 v25, v25
    v_exp_f32 v26, v26
    v_exp_f32 v27, v27
    s_waitcnt lgkmcnt(0)
    s_barrier
    buffer_load_dwordx4 v[128:131], v240, s[36:39], s85 offen offset:2048 sc1
    ds_read_b128 v[88:91], v1 offset:24576
    ds_read_b128 v[92:95], v2 offset:28672
    v_exp_f32 v28, v28
    v_exp_f32 v29, v29
    v_smfmac_f32_32x32x32_bf16 v[44:59], v[100:103], v[20:27], v254
    v_exp_f32 v30, v30
    v_exp_f32 v31, v31
    buffer_load_dwordx4 v[132:135], v240, s[36:39], s85 offen offset:3072 sc1
    s_waitcnt lgkmcnt(1)
    v_mfma_f32_32x32x16_bf16 v[12:27], v[88:91], v[76:79], 0
    v_exp_f32 v32, v32
    s_waitcnt lgkmcnt(0)
    v_mfma_f32_32x32x8bf16_1k v[12:27], v[92:93], v[84:85], v[12:27]
    v_exp_f32 v33, v33
    v_exp_f32 v34, v34
    v_exp_f32 v35, v35
    v_exp_f32 v36, v36
    s_add_u32 s85, s85, 0x1000
    buffer_load_dwordx4 v[136:139], v240, s[36:39], s85 offen offset:0 sc1
    v_exp_f32 v37, v37
    v_smfmac_f32_32x32x32_bf16 v[60:75], v[96:99], v[28:35], v254
    ds_read_b128 v[96:99], v3 offset:29696
    v_exp_f32 v38, v38
    v_exp_f32 v39, v39
    v_exp_f32 v40, v40
    v_exp_f32 v41, v41
    buffer_load_dwordx4 v[140:143], v240, s[36:39], s85 offen offset:1024 sc1
    v_exp_f32 v42, v42
    v_exp_f32 v43, v43
    v_exp_f32 v12, v12
    v_exp_f32 v13, v13
    v_smfmac_f32_32x32x32_bf16 v[60:75], v[100:103], v[36:43], v254
    ds_read_b128 v[100:103], v3 offset:30464
    v_exp_f32 v14, v14
    buffer_load_dwordx4 v[144:147], v240, s[36:39], s85 offen offset:2048 sc1
    v_exp_f32 v15, v15
    v_mfma_f32_32x32x16_bf16 v[28:43], v[88:91], v[80:83], 0
    ds_read_b128 v[88:91], v1 offset:25600
    v_exp_f32 v16, v16
    v_mfma_f32_32x32x8bf16_1k v[28:43], v[92:93], v[86:87], v[28:43]
    v_exp_f32 v17, v17
    v_exp_f32 v18, v18
    buffer_load_dwordx4 v[148:151], v240, s[36:39], s85 offen offset:3072 sc1
    v_exp_f32 v19, v19
    v_exp_f32 v20, v20
    v_exp_f32 v21, v21
    s_waitcnt lgkmcnt(2)
    v_smfmac_f32_32x32x32_bf16 v[44:59], v[96:99], v[12:19], v254
    v_exp_f32 v22, v22
    v_exp_f32 v23, v23
    s_add_u32 s85, s85, 0x1000
    buffer_load_dwordx4 v[152:155], v240, s[36:39], s85 offen offset:0 sc1
    v_exp_f32 v24, v24
    v_exp_f32 v25, v25
    v_exp_f32 v26, v26
    v_exp_f32 v27, v27
    v_exp_f32 v28, v28
    v_exp_f32 v29, v29
    buffer_load_dwordx4 v[156:159], v240, s[36:39], s85 offen offset:1024 sc1
    s_waitcnt lgkmcnt(1)
    v_smfmac_f32_32x32x32_bf16 v[44:59], v[100:103], v[20:27], v254
    v_exp_f32 v30, v30
    v_exp_f32 v31, v31
    s_waitcnt lgkmcnt(0)
    v_mfma_f32_32x32x16_bf16 v[12:27], v[88:91], v[76:79], 0
    v_exp_f32 v32, v32
    v_mfma_f32_32x32x8bf16_1k v[12:27], v[94:95], v[84:85], v[12:27]
    v_exp_f32 v33, v33
    buffer_load_dwordx4 v[160:163], v240, s[36:39], s85 offen offset:2048 sc1
    v_exp_f32 v34, v34
    v_exp_f32 v35, v35
    v_exp_f32 v36, v36
    v_exp_f32 v37, v37
    v_smfmac_f32_32x32x32_bf16 v[60:75], v[96:99], v[28:35], v254
    ds_read_b128 v[96:99], v3 offset:31232
    v_exp_f32 v38, v38
    buffer_load_dwordx4 v[164:167], v240, s[36:39], s85 offen offset:3072 sc1
    v_exp_f32 v39, v39
    v_exp_f32 v40, v40
    v_exp_f32 v41, v41
    v_exp_f32 v42, v42
    v_exp_f32 v43, v43
    v_exp_f32 v12, v12
    s_add_u32 s85, s85, 0x1000
    buffer_load_dwordx4 v[168:171], v240, s[36:39], s85 offen offset:0 sc1
    v_exp_f32 v13, v13
    v_smfmac_f32_32x32x32_bf16 v[60:75], v[100:103], v[36:43], v254
    ds_read_b128 v[100:103], v3 offset:32000
    v_exp_f32 v14, v14
    v_exp_f32 v15, v15
    v_mfma_f32_32x32x16_bf16 v[28:43], v[88:91], v[80:83], 0
    v_exp_f32 v16, v16
    buffer_load_dwordx4 v[172:175], v240, s[36:39], s85 offen offset:1024 sc1
    v_mfma_f32_32x32x8bf16_1k v[28:43], v[94:95], v[86:87], v[28:43]
    v_exp_f32 v17, v17
    v_exp_f32 v18, v18
    v_exp_f32 v19, v19
    v_exp_f32 v20, v20
    v_exp_f32 v21, v21
    buffer_load_dwordx4 v[176:179], v240, s[36:39], s85 offen offset:2048 sc1
    s_waitcnt lgkmcnt(1)
    v_smfmac_f32_32x32x32_bf16 v[44:59], v[96:99], v[12:19], v254
    v_exp_f32 v22, v22
    v_exp_f32 v23, v23
    v_exp_f32 v24, v24
    v_exp_f32 v25, v25
    v_exp_f32 v26, v26
    buffer_load_dwordx4 v[180:183], v240, s[36:39], s85 offen offset:3072 sc1
    v_exp_f32 v27, v27
    s_waitcnt lgkmcnt(0)
    s_barrier
    s_add_u32 s85, s85, 0x1000
    buffer_load_dwordx4 v[184:187], v240, s[36:39], s85 offen offset:0 sc1
    v_exp_f32 v28, v28
    buffer_load_dwordx4 v[188:191], v240, s[36:39], s85 offen offset:1024 sc1
    v_exp_f32 v29, v29
    v_smfmac_f32_32x32x32_bf16 v[44:59], v[100:103], v[20:27], v254
    buffer_load_dwordx4 v[192:195], v240, s[36:39], s85 offen offset:2048 sc1
    v_exp_f32 v30, v30
    buffer_load_dwordx4 v[196:199], v240, s[36:39], s85 offen offset:3072 sc1
    v_exp_f32 v31, v31
    v_exp_f32 v32, v32
    s_add_u32 s85, s85, 0x1000
    buffer_load_dwordx4 v[200:203], v240, s[36:39], s85 offen offset:0 sc1
    v_exp_f32 v33, v33
    v_exp_f32 v34, v34
    v_exp_f32 v35, v35
    v_exp_f32 v36, v36
    v_exp_f32 v37, v37
    v_smfmac_f32_32x32x32_bf16 v[60:75], v[96:99], v[28:35], v254
    v_exp_f32 v38, v38
    v_exp_f32 v39, v39
    v_exp_f32 v40, v40
    v_exp_f32 v41, v41
    v_exp_f32 v42, v42
    v_exp_f32 v43, v43
    s_nop 1
    v_smfmac_f32_32x32x32_bf16 v[60:75], v[100:103], v[36:43], v254
    s_mul_i32 s48, s52, 6144
    v_add_u32 v244, s48, v1
    s_mov_b32 s51, 0
    v_lshlrev_b32 v4, 4, v0
    v_add_u32 v5, 0x1000, v4
    s_mov_b32 s60, s26
    s_mov_b32 s61, s27
    s_mov_b32 s62, 0x280000
    s_mov_b32 s63, 0x20000
    v_add_u32 v6, s68, v4
    s_mul_i32 s48, s52, 5120
    s_add_u32 s48, s48, 74240
    v_add_u32 v10, s48, v4
    v_and_b32 v245, 15, v0
    v_mul_u32_u24 v11, 0x500, v245
    v_lshrrev_b32 v245, 4, v0
    v_lshl_add_u32 v11, v245, 3, v11
    v_mov_b32 v7, v229
    v_mov_b32 v8, v230
    v_mov_b32 v9, v231
    s_lshl_b32 s48, s32, 2
    s_add_u32 s48, s48, s58
    s_mul_i32 s50, s48, 20480
    s_mul_i32 s49, s33, 160
    s_add_u32 s50, s50, s49
    v_and_b32 v245, 15, v0
    v_mul_u32_u24 v245, 1120, v245
    v_sub_u32 v11, v11, v245
    v_add_u32 v11, s68, v11
    s_barrier
    ds_read_b128 v[12:15], v244 offset:0
    ds_read_b128 v[16:19], v244 offset:1024
    ds_read_b128 v[20:23], v244 offset:2048
    ds_read_b128 v[28:31], v244 offset:3072
    ds_read_b128 v[32:35], v244 offset:4096
    ds_read_b128 v[36:39], v244 offset:5120
    s_waitcnt lgkmcnt(3)
    v_pk_add_f32 v[52:53], v[52:53], v[20:21]
    v_pk_add_f32 v[54:55], v[54:55], v[22:23]
    s_waitcnt lgkmcnt(0)
    v_pk_add_f32 v[68:69], v[68:69], v[36:37]
    v_pk_add_f32 v[70:71], v[70:71], v[38:39]
    v_pk_add_f32 v[44:45], v[44:45], v[12:13]
    v_pk_add_f32 v[46:47], v[46:47], v[14:15]
    v_pk_add_f32 v[60:61], v[60:61], v[28:29]
    v_pk_add_f32 v[62:63], v[62:63], v[30:31]
    v_pk_add_f32 v[48:49], v[48:49], v[16:17]
    v_pk_add_f32 v[50:51], v[50:51], v[18:19]
    v_pk_add_f32 v[64:65], v[64:65], v[32:33]
    v_pk_add_f32 v[66:67], v[66:67], v[34:35]
gated_mix__grouped_kv_mqa__mixer_gmlp__prompt_kernel_fin:
    v_permlane32_swap_b32 v52, v68
    v_permlane32_swap_b32 v53, v69
    v_permlane32_swap_b32 v54, v70
    v_permlane32_swap_b32 v55, v71
    v_rcp_f32 v244, v68
    v_cmp_ngt_f32 vcc, 0x5f800000, v68
    s_mov_b32 s48, 0x1f800000
    v_mul_f32 v244, v244, v222
    v_cmp_nlt_f32 s[56:57], s48, v68
    v_mov_b32 v246, v244
    v_mov_b32 v248, v244
    s_or_b64 s[56:57], s[56:57], vcc
    v_pk_mul_f32 v[52:53], v[52:53], v[244:245] op_sel_hi:[1,0]
    v_permlane32_swap_b32 v246, v248
    v_pk_mul_f32 v[54:55], v[54:55], v[244:245] op_sel_hi:[1,0]
    v_pk_mul_f32 v[44:45], v[44:45], v[246:247] op_sel_hi:[1,0]
    v_pk_mul_f32 v[46:47], v[46:47], v[246:247] op_sel_hi:[1,0]
    v_pk_mul_f32 v[48:49], v[48:49], v[246:247] op_sel_hi:[1,0]
    v_pk_mul_f32 v[50:51], v[50:51], v[246:247] op_sel_hi:[1,0]
    v_pk_mul_f32 v[60:61], v[60:61], v[248:249] op_sel_hi:[1,0]
    v_pk_mul_f32 v[62:63], v[62:63], v[248:249] op_sel_hi:[1,0]
    v_pk_mul_f32 v[64:65], v[64:65], v[248:249] op_sel_hi:[1,0]
    v_pk_mul_f32 v[66:67], v[66:67], v[248:249] op_sel_hi:[1,0]
    v_pk_mul_f32 v[250:251], v[52:53], 0 op_sel_hi:[1,0]
    v_pk_fma_f32 v[250:251], v[54:55], 0, v[250:251] op_sel_hi:[1,0,1]
    v_pk_fma_f32 v[250:251], v[44:45], 0, v[250:251] op_sel_hi:[1,0,1]
    v_cvt_pk_bf16_f32 v208, v44, v45
    v_pk_fma_f32 v[250:251], v[46:47], 0, v[250:251] op_sel_hi:[1,0,1]
    v_cvt_pk_bf16_f32 v209, v46, v47
    v_pk_fma_f32 v[250:251], v[48:49], 0, v[250:251] op_sel_hi:[1,0,1]
    v_cvt_pk_bf16_f32 v210, v48, v49
    v_pk_fma_f32 v[250:251], v[50:51], 0, v[250:251] op_sel_hi:[1,0,1]
    v_cvt_pk_bf16_f32 v211, v50, v51
    v_pk_fma_f32 v[250:251], v[60:61], 0, v[250:251] op_sel_hi:[1,0,1]
    v_cvt_pk_bf16_f32 v212, v60, v61
    v_pk_fma_f32 v[250:251], v[62:63], 0, v[250:251] op_sel_hi:[1,0,1]
    v_cvt_pk_bf16_f32 v213, v62, v63
    v_pk_fma_f32 v[250:251], v[64:65], 0, v[250:251] op_sel_hi:[1,0,1]
    v_cvt_pk_bf16_f32 v214, v64, v65
    v_pk_fma_f32 v[250:251], v[66:67], 0, v[250:251] op_sel_hi:[1,0,1]
    v_cvt_pk_bf16_f32 v215, v66, v67
    v_cmp_u_f32 vcc, v250, v251
    v_cvt_pk_bf16_f32 v216, v52, v53
    v_cvt_pk_bf16_f32 v217, v54, v55
    s_or_b64 vcc, s[56:57], vcc
    s_cbranch_vccnz gated_mix__grouped_kv_mqa__mixer_gmlp__prompt_kernel_slow
gated_mix__grouped_kv_mqa__mixer_gmlp__prompt_kernel_pub:
    s_barrier
    buffer_store_dwordx4 v[208:211], v232, s[36:39], s79 offen sc1
    v_permlane32_swap_b32 v216, v218
    v_permlane32_swap_b32 v217, v219
    buffer_store_dwordx4 v[212:215], v232, s[36:39], s79 offen offset:512 sc1
    buffer_store_dwordx4 v[216:219], v233, s[36:39], s80 offen sc1
    v_add_u32 v245, 0, v0
    v_mul_u32_u24 v245, 6554, v245
    v_lshrrev_b32 v245, 16, v245
    v_mul_u32_u24 v245, 1120, v245
    v_add_u32 v248, v245, v4
    v_add_u32 v245, 64, v0
    v_mul_u32_u24 v245, 6554, v245
    v_lshrrev_b32 v245, 16, v245
    v_mul_u32_u24 v245, 1120, v245
    v_add_u32 v249, v245, v4
    v_add_u32 v245, 128, v0
    v_mul_u32_u24 v245, 6554, v245
    v_lshrrev_b32 v245, 16, v245
    v_mul_u32_u24 v245, 1120, v245
    v_add_u32 v252, v245, v4
    s_waitcnt vmcnt(0)
    s_barrier
    buffer_load_dwordx4 v[12:15], v4, s[36:39], s44 offen offset:0 sc1
    buffer_load_dwordx4 v[16:19], v4, s[36:39], s44 offen offset:1024 sc1
    buffer_load_dwordx4 v[20:23], v4, s[36:39], s44 offen offset:2048 sc1
    buffer_load_dwordx4 v[24:27], v4, s[36:39], s44 offen offset:3072 sc1
    buffer_load_dwordx4 v[28:31], v5, s[36:39], s44 offen offset:0 sc1
    buffer_load_dwordx4 v[32:35], v4, s[36:39], s45 offen offset:0 sc1
    buffer_load_dwordx4 v[36:39], v4, s[36:39], s45 offen offset:1024 sc1
    buffer_load_dwordx4 v[40:43], v4, s[36:39], s45 offen offset:2048 sc1
    buffer_load_dwordx4 v[44:47], v4, s[36:39], s45 offen offset:3072 sc1
    buffer_load_dwordx4 v[48:51], v5, s[36:39], s45 offen offset:0 sc1
    s_barrier
    buffer_load_dwordx4 v[52:55], v4, s[36:39], s46 offen offset:0 sc1
    buffer_load_dwordx4 v[56:59], v4, s[36:39], s46 offen offset:1024 sc1
    buffer_load_dwordx4 v[60:63], v4, s[36:39], s46 offen offset:2048 sc1
    buffer_load_dwordx4 v[64:67], v4, s[36:39], s46 offen offset:3072 sc1
    buffer_load_dwordx4 v[68:71], v5, s[36:39], s46 offen offset:0 sc1
    buffer_load_dwordx4 v[72:75], v4, s[36:39], s47 offen offset:0 sc1
    buffer_load_dwordx4 v[76:79], v4, s[36:39], s47 offen offset:1024 sc1
    buffer_load_dwordx4 v[80:83], v4, s[36:39], s47 offen offset:2048 sc1
    buffer_load_dwordx4 v[84:87], v4, s[36:39], s47 offen offset:3072 sc1
    buffer_load_dwordx4 v[88:91], v5, s[36:39], s47 offen offset:0 sc1
gated_mix__grouped_kv_mqa__mixer_gmlp__prompt_kernel_o0:
    s_waitcnt vmcnt(19)
    v_mfma_f32_16x16x32_bf16 v[208:211], v[104:107], v[12:15], 0
    v_mfma_f32_16x16x32_bf16 v[212:215], v[108:111], v[12:15], 0
    v_max_u32 v250, v12, v13
    v_max_u32 v251, v14, v15
    v_mfma_f32_16x16x32_bf16 v[216:219], v[112:115], v[12:15], 0
    v_mfma_f32_16x16x32_bf16 v[220:223], v[116:119], v[12:15], 0
    v_mfma_f32_16x16x32_bf16 v[224:227], v[120:123], v[12:15], 0
    s_waitcnt vmcnt(18)
    v_mfma_f32_16x16x32_bf16 v[208:211], v[124:127], v[16:19], v[208:211]
    v_mfma_f32_16x16x32_bf16 v[212:215], v[128:131], v[16:19], v[212:215]
    v_max3_u32 v250, v16, v17, v250
    v_max3_u32 v251, v18, v19, v251
    v_mfma_f32_16x16x32_bf16 v[216:219], v[132:135], v[16:19], v[216:219]
    v_mfma_f32_16x16x32_bf16 v[220:223], v[136:139], v[16:19], v[220:223]
    v_mfma_f32_16x16x32_bf16 v[224:227], v[140:143], v[16:19], v[224:227]
    s_waitcnt vmcnt(17)
    v_mfma_f32_16x16x32_bf16 v[208:211], v[144:147], v[20:23], v[208:211]
    v_mfma_f32_16x16x32_bf16 v[212:215], v[148:151], v[20:23], v[212:215]
    v_max3_u32 v250, v20, v21, v250
    v_max3_u32 v251, v22, v23, v251
    v_mfma_f32_16x16x32_bf16 v[216:219], v[152:155], v[20:23], v[216:219]
    v_mfma_f32_16x16x32_bf16 v[220:223], v[156:159], v[20:23], v[220:223]
    v_mfma_f32_16x16x32_bf16 v[224:227], v[160:163], v[20:23], v[224:227]
    s_waitcnt vmcnt(16)
    v_mfma_f32_16x16x32_bf16 v[208:211], v[164:167], v[24:27], v[208:211]
    v_mfma_f32_16x16x32_bf16 v[212:215], v[168:171], v[24:27], v[212:215]
    v_max3_u32 v250, v24, v25, v250
    v_max3_u32 v251, v26, v27, v251
    v_mfma_f32_16x16x32_bf16 v[216:219], v[172:175], v[24:27], v[216:219]
    v_mfma_f32_16x16x32_bf16 v[220:223], v[176:179], v[24:27], v[220:223]
    v_mfma_f32_16x16x32_bf16 v[224:227], v[180:183], v[24:27], v[224:227]
    s_waitcnt vmcnt(15)
    v_mfma_f32_16x16x32_bf16 v[208:211], v[184:187], v[28:31], v[208:211]
    v_mfma_f32_16x16x32_bf16 v[212:215], v[188:191], v[28:31], v[212:215]
    v_max3_u32 v250, v28, v29, v250
    v_max3_u32 v251, v30, v31, v251
    v_mfma_f32_16x16x32_bf16 v[216:219], v[192:195], v[28:31], v[216:219]
    v_max_u32 v250, v250, v251
    v_cmp_eq_u32 vcc, -1, v250
    v_mfma_f32_16x16x32_bf16 v[220:223], v[196:199], v[28:31], v[220:223]
    v_mfma_f32_16x16x32_bf16 v[224:227], v[200:203], v[28:31], v[224:227]
    s_cbranch_vccnz gated_mix__grouped_kv_mqa__mixer_gmlp__prompt_kernel_o0_retry
gated_mix__grouped_kv_mqa__mixer_gmlp__prompt_kernel_o0_ok:
gated_mix__grouped_kv_mqa__mixer_gmlp__prompt_kernel_o1:
    s_waitcnt vmcnt(14)
    v_mfma_f32_16x16x32_bf16 v[228:231], v[104:107], v[32:35], 0
    v_mfma_f32_16x16x32_bf16 v[232:235], v[108:111], v[32:35], 0
    ds_write_b128 v6, v[208:211] offset:0
    v_max_u32 v250, v32, v33
    v_max_u32 v251, v34, v35
    v_mfma_f32_16x16x32_bf16 v[236:239], v[112:115], v[32:35], 0
    v_mfma_f32_16x16x32_bf16 v[240:243], v[116:119], v[32:35], 0
    v_mfma_f32_16x16x32_bf16 v[244:247], v[120:123], v[32:35], 0
    s_waitcnt vmcnt(13)
    v_mfma_f32_16x16x32_bf16 v[228:231], v[124:127], v[36:39], v[228:231]
    ds_write_b128 v6, v[212:215] offset:1024
    v_mfma_f32_16x16x32_bf16 v[232:235], v[128:131], v[36:39], v[232:235]
    v_max3_u32 v250, v36, v37, v250
    v_max3_u32 v251, v38, v39, v251
    v_mfma_f32_16x16x32_bf16 v[236:239], v[132:135], v[36:39], v[236:239]
    v_mfma_f32_16x16x32_bf16 v[240:243], v[136:139], v[36:39], v[240:243]
    v_mfma_f32_16x16x32_bf16 v[244:247], v[140:143], v[36:39], v[244:247]
    ds_write_b128 v6, v[216:219] offset:2048
    s_waitcnt vmcnt(12)
    v_mfma_f32_16x16x32_bf16 v[228:231], v[144:147], v[40:43], v[228:231]
    v_mfma_f32_16x16x32_bf16 v[232:235], v[148:151], v[40:43], v[232:235]
    v_max3_u32 v250, v40, v41, v250
    v_max3_u32 v251, v42, v43, v251
    v_mfma_f32_16x16x32_bf16 v[236:239], v[152:155], v[40:43], v[236:239]
    v_mfma_f32_16x16x32_bf16 v[240:243], v[156:159], v[40:43], v[240:243]
    ds_write_b128 v6, v[220:223] offset:3072
    v_mfma_f32_16x16x32_bf16 v[244:247], v[160:163], v[40:43], v[244:247]
    s_waitcnt vmcnt(11)
    v_mfma_f32_16x16x32_bf16 v[228:231], v[164:167], v[44:47], v[228:231]
    v_mfma_f32_16x16x32_bf16 v[232:235], v[168:171], v[44:47], v[232:235]
    v_max3_u32 v250, v44, v45, v250
    v_max3_u32 v251, v46, v47, v251
    v_mfma_f32_16x16x32_bf16 v[236:239], v[172:175], v[44:47], v[236:239]
    ds_write_b128 v6, v[224:227] offset:4096
    v_mfma_f32_16x16x32_bf16 v[240:243], v[176:179], v[44:47], v[240:243]
    v_mfma_f32_16x16x32_bf16 v[244:247], v[180:183], v[44:47], v[244:247]
    s_waitcnt vmcnt(10)
    v_mfma_f32_16x16x32_bf16 v[228:231], v[184:187], v[48:51], v[228:231]
    v_mfma_f32_16x16x32_bf16 v[232:235], v[188:191], v[48:51], v[232:235]
    v_max3_u32 v250, v48, v49, v250
    v_max3_u32 v251, v50, v51, v251
    v_mfma_f32_16x16x32_bf16 v[236:239], v[192:195], v[48:51], v[236:239]
    v_max_u32 v250, v250, v251
    v_cmp_eq_u32 vcc, -1, v250
    v_mfma_f32_16x16x32_bf16 v[240:243], v[196:199], v[48:51], v[240:243]
    v_mfma_f32_16x16x32_bf16 v[244:247], v[200:203], v[48:51], v[244:247]
    s_cbranch_vccnz gated_mix__grouped_kv_mqa__mixer_gmlp__prompt_kernel_o1_retry
gated_mix__grouped_kv_mqa__mixer_gmlp__prompt_kernel_o1_ok:
    s_waitcnt lgkmcnt(0)
    s_barrier
gated_mix__grouped_kv_mqa__mixer_gmlp__prompt_kernel_o2:
    s_waitcnt vmcnt(9)
    v_mfma_f32_16x16x32_bf16 v[208:211], v[104:107], v[52:55], 0
    ds_read_b128 v[12:15], v10 offset:0
    ds_read_b128 v[32:35], v7 offset:0
    v_mfma_f32_16x16x32_bf16 v[212:215], v[108:111], v[52:55], 0
    ds_write_b128 v6, v[228:231] offset:5120
    v_max_u32 v250, v52, v53
    v_max_u32 v251, v54, v55
    v_mfma_f32_16x16x32_bf16 v[216:219], v[112:115], v[52:55], 0
    v_mfma_f32_16x16x32_bf16 v[220:223], v[116:119], v[52:55], 0
    v_mfma_f32_16x16x32_bf16 v[224:227], v[120:123], v[52:55], 0
    ds_read_b128 v[16:19], v10 offset:1024
    ds_read_b128 v[36:39], v7 offset:1024
    s_waitcnt vmcnt(8)
    v_mfma_f32_16x16x32_bf16 v[208:211], v[124:127], v[56:59], v[208:211]
    ds_write_b128 v6, v[232:235] offset:6144
    v_mfma_f32_16x16x32_bf16 v[212:215], v[128:131], v[56:59], v[212:215]
    v_max3_u32 v250, v56, v57, v250
    v_max3_u32 v251, v58, v59, v251
    v_mfma_f32_16x16x32_bf16 v[216:219], v[132:135], v[56:59], v[216:219]
    v_mfma_f32_16x16x32_bf16 v[220:223], v[136:139], v[56:59], v[220:223]
    s_waitcnt lgkmcnt(4)
    v_add_f32 v32, v32, v12
    v_add_f32 v33, v33, v13
    v_add_f32 v34, v34, v14
    v_add_f32 v35, v35, v15
    ds_read_b128 v[20:23], v10 offset:2048
    ds_read_b128 v[40:43], v7 offset:2048
    v_mfma_f32_16x16x32_bf16 v[224:227], v[140:143], v[56:59], v[224:227]
    ds_write_b128 v6, v[236:239] offset:7168
    s_waitcnt vmcnt(7)
    v_mfma_f32_16x16x32_bf16 v[208:211], v[144:147], v[60:63], v[208:211]
    v_mfma_f32_16x16x32_bf16 v[212:215], v[148:151], v[60:63], v[212:215]
    v_max3_u32 v250, v60, v61, v250
    v_max3_u32 v251, v62, v63, v251
    v_mfma_f32_16x16x32_bf16 v[216:219], v[152:155], v[60:63], v[216:219]
    s_waitcnt lgkmcnt(4)
    v_add_f32 v36, v36, v16
    v_add_f32 v37, v37, v17
    v_add_f32 v38, v38, v18
    v_add_f32 v39, v39, v19
    ds_read_b128 v[24:27], v10 offset:3072
    ds_read_b128 v[44:47], v7 offset:3072
    v_mfma_f32_16x16x32_bf16 v[220:223], v[156:159], v[60:63], v[220:223]
    ds_write_b128 v6, v[240:243] offset:8192
    v_mfma_f32_16x16x32_bf16 v[224:227], v[160:163], v[60:63], v[224:227]
    s_waitcnt vmcnt(6)
    v_mfma_f32_16x16x32_bf16 v[208:211], v[164:167], v[64:67], v[208:211]
    v_mfma_f32_16x16x32_bf16 v[212:215], v[168:171], v[64:67], v[212:215]
    s_waitcnt lgkmcnt(4)
    v_add_f32 v40, v40, v20
    v_add_f32 v41, v41, v21
    v_add_f32 v42, v42, v22
    v_add_f32 v43, v43, v23
    v_max3_u32 v250, v64, v65, v250
    v_max3_u32 v251, v66, v67, v251
    ds_read_b128 v[28:31], v10 offset:4096
    ds_read_b128 v[48:51], v7 offset:4096
    v_mfma_f32_16x16x32_bf16 v[216:219], v[172:175], v[64:67], v[216:219]
    ds_write_b128 v6, v[244:247] offset:9216
    v_mfma_f32_16x16x32_bf16 v[220:223], v[176:179], v[64:67], v[220:223]
    v_mfma_f32_16x16x32_bf16 v[224:227], v[180:183], v[64:67], v[224:227]
    s_waitcnt vmcnt(5)
    v_mfma_f32_16x16x32_bf16 v[208:211], v[184:187], v[68:71], v[208:211]
    s_waitcnt lgkmcnt(4)
    v_add_f32 v44, v44, v24
    v_add_f32 v45, v45, v25
    v_add_f32 v46, v46, v26
    v_add_f32 v47, v47, v27
    v_mfma_f32_16x16x32_bf16 v[212:215], v[188:191], v[68:71], v[212:215]
    v_max3_u32 v250, v68, v69, v250
    v_max3_u32 v251, v70, v71, v251
    v_mfma_f32_16x16x32_bf16 v[216:219], v[192:195], v[68:71], v[216:219]
    v_max_u32 v250, v250, v251
    v_cmp_eq_u32 vcc, -1, v250
    v_mfma_f32_16x16x32_bf16 v[220:223], v[196:199], v[68:71], v[220:223]
    v_mfma_f32_16x16x32_bf16 v[224:227], v[200:203], v[68:71], v[224:227]
    s_waitcnt lgkmcnt(1)
    v_add_f32 v48, v48, v28
    v_add_f32 v49, v49, v29
    v_add_f32 v50, v50, v30
    v_add_f32 v51, v51, v31
    s_cbranch_vccnz gated_mix__grouped_kv_mqa__mixer_gmlp__prompt_kernel_o2_retry
gated_mix__grouped_kv_mqa__mixer_gmlp__prompt_kernel_o2_ok:
    s_waitcnt lgkmcnt(0)
    s_barrier
gated_mix__grouped_kv_mqa__mixer_gmlp__prompt_kernel_o3:
    s_waitcnt vmcnt(4)
    v_mfma_f32_16x16x32_bf16 v[228:231], v[104:107], v[72:75], v[32:35]
    v_max_u32 v250, v72, v73
    v_max_u32 v251, v74, v75
    v_mfma_f32_16x16x32_bf16 v[232:235], v[108:111], v[72:75], v[36:39]
    ds_write_b128 v6, v[208:211] offset:10240
    s_waitcnt vmcnt(3)
    v_max3_u32 v250, v76, v77, v250
    v_max3_u32 v251, v78, v79, v251
    v_mfma_f32_16x16x32_bf16 v[236:239], v[112:115], v[72:75], v[40:43]
    s_waitcnt vmcnt(2)
    v_max3_u32 v250, v80, v81, v250
    v_max3_u32 v251, v82, v83, v251
    v_mfma_f32_16x16x32_bf16 v[240:243], v[116:119], v[72:75], v[44:47]
    ds_write_b128 v6, v[212:215] offset:11264
    s_waitcnt vmcnt(1)
    v_max3_u32 v250, v84, v85, v250
    v_max3_u32 v251, v86, v87, v251
    v_mfma_f32_16x16x32_bf16 v[244:247], v[120:123], v[72:75], v[48:51]
    s_waitcnt vmcnt(0)
    v_max3_u32 v250, v88, v89, v250
    v_max3_u32 v251, v90, v91, v251
    v_max_u32 v250, v250, v251
    v_cmp_eq_u32 vcc, -1, v250
    v_mfma_f32_16x16x32_bf16 v[228:231], v[124:127], v[76:79], v[228:231]
    s_cbranch_vccnz gated_mix__grouped_kv_mqa__mixer_gmlp__prompt_kernel_o3_retry
gated_mix__grouped_kv_mqa__mixer_gmlp__prompt_kernel_o3_ok:
    ds_write_b128 v6, v[216:219] offset:12288
    v_mfma_f32_16x16x32_bf16 v[232:235], v[128:131], v[76:79], v[232:235]
    v_mfma_f32_16x16x32_bf16 v[236:239], v[132:135], v[76:79], v[236:239]
    ds_write_b128 v6, v[220:223] offset:13312
    v_mfma_f32_16x16x32_bf16 v[240:243], v[136:139], v[76:79], v[240:243]
    ds_read_b128 v[52:55], v8 offset:5120
    v_mfma_f32_16x16x32_bf16 v[244:247], v[140:143], v[76:79], v[244:247]
    ds_read_b128 v[56:59], v8 offset:6144
    ds_write_b128 v6, v[224:227] offset:14336
    v_mfma_f32_16x16x32_bf16 v[228:231], v[144:147], v[80:83], v[228:231]
    ds_read_b128 v[60:63], v8 offset:7168
    v_mfma_f32_16x16x32_bf16 v[232:235], v[148:151], v[80:83], v[232:235]
    ds_read_b128 v[64:67], v8 offset:8192
    v_mfma_f32_16x16x32_bf16 v[236:239], v[152:155], v[80:83], v[236:239]
    ds_read_b128 v[68:71], v8 offset:9216
    v_mfma_f32_16x16x32_bf16 v[240:243], v[156:159], v[80:83], v[240:243]
    v_mfma_f32_16x16x32_bf16 v[244:247], v[160:163], v[80:83], v[244:247]
    s_waitcnt lgkmcnt(3)
    s_barrier
    ds_read_b128 v[12:15], v9 offset:10240
    v_mfma_f32_16x16x32_bf16 v[228:231], v[164:167], v[84:87], v[228:231]
    ds_read_b128 v[16:19], v9 offset:11264
    v_mfma_f32_16x16x32_bf16 v[232:235], v[168:171], v[84:87], v[232:235]
    ds_read_b128 v[20:23], v9 offset:12288
    v_mfma_f32_16x16x32_bf16 v[236:239], v[172:175], v[84:87], v[236:239]
    ds_read_b128 v[24:27], v9 offset:13312
    v_mfma_f32_16x16x32_bf16 v[240:243], v[176:179], v[84:87], v[240:243]
    ds_read_b128 v[28:31], v9 offset:14336
    v_mfma_f32_16x16x32_bf16 v[244:247], v[180:183], v[84:87], v[244:247]
    v_mfma_f32_16x16x32_bf16 v[228:231], v[184:187], v[88:91], v[228:231]
    s_waitcnt lgkmcnt(4)
    v_add_f32 v12, v12, v52
    v_add_f32 v13, v13, v53
    v_add_f32 v14, v14, v54
    v_add_f32 v15, v15, v55
    v_mfma_f32_16x16x32_bf16 v[232:235], v[188:191], v[88:91], v[232:235]
    s_waitcnt lgkmcnt(3)
    v_add_f32 v16, v16, v56
    v_add_f32 v17, v17, v57
    v_add_f32 v18, v18, v58
    v_add_f32 v19, v19, v59
    v_mfma_f32_16x16x32_bf16 v[236:239], v[192:195], v[88:91], v[236:239]
    s_waitcnt lgkmcnt(2)
    v_add_f32 v20, v20, v60
    v_add_f32 v21, v21, v61
    v_add_f32 v22, v22, v62
    v_add_f32 v23, v23, v63
    v_mfma_f32_16x16x32_bf16 v[240:243], v[196:199], v[88:91], v[240:243]
    s_waitcnt lgkmcnt(1)
    v_add_f32 v24, v24, v64
    v_add_f32 v25, v25, v65
    v_add_f32 v26, v26, v66
    v_add_f32 v27, v27, v67
    v_mfma_f32_16x16x32_bf16 v[244:247], v[200:203], v[88:91], v[244:247]
    s_waitcnt lgkmcnt(0)
    v_add_f32 v28, v28, v68
    v_add_f32 v29, v29, v69
    v_add_f32 v30, v30, v70
    v_add_f32 v31, v31, v71
    v_pk_add_f32 v[228:229], v[228:229], v[12:13]
    v_pk_add_f32 v[230:231], v[230:231], v[14:15]
    v_cvt_pk_bf16_f32 v228, v228, v229
    v_cvt_pk_bf16_f32 v229, v230, v231
    ds_write_b64 v11, v[228:229] offset:15360
    v_pk_add_f32 v[232:233], v[232:233], v[16:17]
    v_pk_add_f32 v[234:235], v[234:235], v[18:19]
    v_cvt_pk_bf16_f32 v232, v232, v233
    v_cvt_pk_bf16_f32 v233, v234, v235
    ds_write_b64 v11, v[232:233] offset:15392
    v_pk_add_f32 v[236:237], v[236:237], v[20:21]
    v_pk_add_f32 v[238:239], v[238:239], v[22:23]
    v_cvt_pk_bf16_f32 v236, v236, v237
    v_cvt_pk_bf16_f32 v237, v238, v239
    ds_write_b64 v11, v[236:237] offset:15424
    v_pk_add_f32 v[240:241], v[240:241], v[24:25]
    v_pk_add_f32 v[242:243], v[242:243], v[26:27]
    v_cvt_pk_bf16_f32 v240, v240, v241
    v_cvt_pk_bf16_f32 v241, v242, v243
    ds_write_b64 v11, v[240:241] offset:15456
    v_pk_add_f32 v[244:245], v[244:245], v[28:29]
    v_pk_add_f32 v[246:247], v[246:247], v[30:31]
    v_cvt_pk_bf16_f32 v244, v244, v245
    v_cvt_pk_bf16_f32 v245, v246, v247
    ds_write_b64 v11, v[244:245] offset:15488
    ds_read_b128 v[32:35], v6 offset:15360
    ds_read_b128 v[36:39], v6 offset:16384
    ds_read_b128 v[40:43], v6 offset:17408
    s_waitcnt lgkmcnt(2)
    buffer_store_dwordx4 v[32:35], v248, s[60:63], s50 offen offset:0
    s_waitcnt lgkmcnt(1)
    buffer_store_dwordx4 v[36:39], v249, s[60:63], s50 offen offset:1024
    s_mov_b32 exec_hi, 0
    s_waitcnt lgkmcnt(0)
    buffer_store_dwordx4 v[40:43], v252, s[60:63], s50 offen offset:2048
    s_endpgm
gated_mix__grouped_kv_mqa__mixer_gmlp__prompt_kernel_pretry:
    s_cmp_eq_u32 s77, 0
    s_cbranch_scc1 gated_mix__grouped_kv_mqa__mixer_gmlp__prompt_kernel_pok
    s_sub_u32 s77, s77, 1
    buffer_load_dword v204, v253, s[36:39], s76 offen sc1
    s_waitcnt vmcnt(0)
    s_branch gated_mix__grouped_kv_mqa__mixer_gmlp__prompt_kernel_poll
gated_mix__grouped_kv_mqa__mixer_gmlp__prompt_kernel_o0_retry:
    s_cmp_eq_u32 s77, 0
    s_cbranch_scc1 gated_mix__grouped_kv_mqa__mixer_gmlp__prompt_kernel_o0_ok
    s_sub_u32 s77, s77, 1
    buffer_load_dwordx4 v[12:15], v4, s[36:39], s44 offen offset:0 sc1
    buffer_load_dwordx4 v[16:19], v4, s[36:39], s44 offen offset:1024 sc1
    buffer_load_dwordx4 v[20:23], v4, s[36:39], s44 offen offset:2048 sc1
    buffer_load_dwordx4 v[24:27], v4, s[36:39], s44 offen offset:3072 sc1
    buffer_load_dwordx4 v[28:31], v5, s[36:39], s44 offen offset:0 sc1
    s_waitcnt vmcnt(15)
    v_max_u32 v250, v32, v33
    v_max_u32 v251, v34, v35
    v_max3_u32 v250, v36, v37, v250
    v_max3_u32 v251, v38, v39, v251
    v_max3_u32 v250, v40, v41, v250
    v_max3_u32 v251, v42, v43, v251
    v_max3_u32 v250, v44, v45, v250
    v_max3_u32 v251, v46, v47, v251
    v_max3_u32 v250, v48, v49, v250
    v_max3_u32 v251, v50, v51, v251
    v_max_u32 v250, v250, v251
    v_cmp_eq_u32 vcc, -1, v250
    s_cbranch_vccz gated_mix__grouped_kv_mqa__mixer_gmlp__prompt_kernel_o0_r1
    buffer_load_dwordx4 v[32:35], v4, s[36:39], s45 offen offset:0 sc1
    buffer_load_dwordx4 v[36:39], v4, s[36:39], s45 offen offset:1024 sc1
    buffer_load_dwordx4 v[40:43], v4, s[36:39], s45 offen offset:2048 sc1
    buffer_load_dwordx4 v[44:47], v4, s[36:39], s45 offen offset:3072 sc1
    buffer_load_dwordx4 v[48:51], v5, s[36:39], s45 offen offset:0 sc1
gated_mix__grouped_kv_mqa__mixer_gmlp__prompt_kernel_o0_r1:
    s_waitcnt vmcnt(10)
    v_max_u32 v250, v52, v53
    v_max_u32 v251, v54, v55
    v_max3_u32 v250, v56, v57, v250
    v_max3_u32 v251, v58, v59, v251
    v_max3_u32 v250, v60, v61, v250
    v_max3_u32 v251, v62, v63, v251
    v_max3_u32 v250, v64, v65, v250
    v_max3_u32 v251, v66, v67, v251
    v_max3_u32 v250, v68, v69, v250
    v_max3_u32 v251, v70, v71, v251
    v_max_u32 v250, v250, v251
    v_cmp_eq_u32 vcc, -1, v250
    s_cbranch_vccz gated_mix__grouped_kv_mqa__mixer_gmlp__prompt_kernel_o0_r2
    buffer_load_dwordx4 v[52:55], v4, s[36:39], s46 offen offset:0 sc1
    buffer_load_dwordx4 v[56:59], v4, s[36:39], s46 offen offset:1024 sc1
    buffer_load_dwordx4 v[60:63], v4, s[36:39], s46 offen offset:2048 sc1
    buffer_load_dwordx4 v[64:67], v4, s[36:39], s46 offen offset:3072 sc1
    buffer_load_dwordx4 v[68:71], v5, s[36:39], s46 offen offset:0 sc1
gated_mix__grouped_kv_mqa__mixer_gmlp__prompt_kernel_o0_r2:
    s_waitcnt vmcnt(5)
    v_max_u32 v250, v72, v73
    v_max_u32 v251, v74, v75
    v_max3_u32 v250, v76, v77, v250
    v_max3_u32 v251, v78, v79, v251
    v_max3_u32 v250, v80, v81, v250
    v_max3_u32 v251, v82, v83, v251
    v_max3_u32 v250, v84, v85, v250
    v_max3_u32 v251, v86, v87, v251
    v_max3_u32 v250, v88, v89, v250
    v_max3_u32 v251, v90, v91, v251
    v_max_u32 v250, v250, v251
    v_cmp_eq_u32 vcc, -1, v250
    s_cbranch_vccz gated_mix__grouped_kv_mqa__mixer_gmlp__prompt_kernel_o0_r3
    buffer_load_dwordx4 v[72:75], v4, s[36:39], s47 offen offset:0 sc1
    buffer_load_dwordx4 v[76:79], v4, s[36:39], s47 offen offset:1024 sc1
    buffer_load_dwordx4 v[80:83], v4, s[36:39], s47 offen offset:2048 sc1
    buffer_load_dwordx4 v[84:87], v4, s[36:39], s47 offen offset:3072 sc1
    buffer_load_dwordx4 v[88:91], v5, s[36:39], s47 offen offset:0 sc1
gated_mix__grouped_kv_mqa__mixer_gmlp__prompt_kernel_o0_r3:
    s_waitcnt vmcnt(0) lgkmcnt(0)
    s_branch gated_mix__grouped_kv_mqa__mixer_gmlp__prompt_kernel_o0
gated_mix__grouped_kv_mqa__mixer_gmlp__prompt_kernel_o1_retry:
    s_cmp_eq_u32 s77, 0
    s_cbranch_scc1 gated_mix__grouped_kv_mqa__mixer_gmlp__prompt_kernel_o1_ok
    s_sub_u32 s77, s77, 1
    buffer_load_dwordx4 v[32:35], v4, s[36:39], s45 offen offset:0 sc1
    buffer_load_dwordx4 v[36:39], v4, s[36:39], s45 offen offset:1024 sc1
    buffer_load_dwordx4 v[40:43], v4, s[36:39], s45 offen offset:2048 sc1
    buffer_load_dwordx4 v[44:47], v4, s[36:39], s45 offen offset:3072 sc1
    buffer_load_dwordx4 v[48:51], v5, s[36:39], s45 offen offset:0 sc1
    s_waitcnt vmcnt(10)
    v_max_u32 v250, v52, v53
    v_max_u32 v251, v54, v55
    v_max3_u32 v250, v56, v57, v250
    v_max3_u32 v251, v58, v59, v251
    v_max3_u32 v250, v60, v61, v250
    v_max3_u32 v251, v62, v63, v251
    v_max3_u32 v250, v64, v65, v250
    v_max3_u32 v251, v66, v67, v251
    v_max3_u32 v250, v68, v69, v250
    v_max3_u32 v251, v70, v71, v251
    v_max_u32 v250, v250, v251
    v_cmp_eq_u32 vcc, -1, v250
    s_cbranch_vccz gated_mix__grouped_kv_mqa__mixer_gmlp__prompt_kernel_o1_r2
    buffer_load_dwordx4 v[52:55], v4, s[36:39], s46 offen offset:0 sc1
    buffer_load_dwordx4 v[56:59], v4, s[36:39], s46 offen offset:1024 sc1
    buffer_load_dwordx4 v[60:63], v4, s[36:39], s46 offen offset:2048 sc1
    buffer_load_dwordx4 v[64:67], v4, s[36:39], s46 offen offset:3072 sc1
    buffer_load_dwordx4 v[68:71], v5, s[36:39], s46 offen offset:0 sc1
gated_mix__grouped_kv_mqa__mixer_gmlp__prompt_kernel_o1_r2:
    s_waitcnt vmcnt(5)
    v_max_u32 v250, v72, v73
    v_max_u32 v251, v74, v75
    v_max3_u32 v250, v76, v77, v250
    v_max3_u32 v251, v78, v79, v251
    v_max3_u32 v250, v80, v81, v250
    v_max3_u32 v251, v82, v83, v251
    v_max3_u32 v250, v84, v85, v250
    v_max3_u32 v251, v86, v87, v251
    v_max3_u32 v250, v88, v89, v250
    v_max3_u32 v251, v90, v91, v251
    v_max_u32 v250, v250, v251
    v_cmp_eq_u32 vcc, -1, v250
    s_cbranch_vccz gated_mix__grouped_kv_mqa__mixer_gmlp__prompt_kernel_o1_r3
    buffer_load_dwordx4 v[72:75], v4, s[36:39], s47 offen offset:0 sc1
    buffer_load_dwordx4 v[76:79], v4, s[36:39], s47 offen offset:1024 sc1
    buffer_load_dwordx4 v[80:83], v4, s[36:39], s47 offen offset:2048 sc1
    buffer_load_dwordx4 v[84:87], v4, s[36:39], s47 offen offset:3072 sc1
    buffer_load_dwordx4 v[88:91], v5, s[36:39], s47 offen offset:0 sc1
gated_mix__grouped_kv_mqa__mixer_gmlp__prompt_kernel_o1_r3:
    s_waitcnt vmcnt(0) lgkmcnt(0)
    s_branch gated_mix__grouped_kv_mqa__mixer_gmlp__prompt_kernel_o1
gated_mix__grouped_kv_mqa__mixer_gmlp__prompt_kernel_o2_retry:
    s_cmp_eq_u32 s77, 0
    s_cbranch_scc1 gated_mix__grouped_kv_mqa__mixer_gmlp__prompt_kernel_o2_ok
    s_sub_u32 s77, s77, 1
    buffer_load_dwordx4 v[52:55], v4, s[36:39], s46 offen offset:0 sc1
    buffer_load_dwordx4 v[56:59], v4, s[36:39], s46 offen offset:1024 sc1
    buffer_load_dwordx4 v[60:63], v4, s[36:39], s46 offen offset:2048 sc1
    buffer_load_dwordx4 v[64:67], v4, s[36:39], s46 offen offset:3072 sc1
    buffer_load_dwordx4 v[68:71], v5, s[36:39], s46 offen offset:0 sc1
    s_waitcnt vmcnt(5)
    v_max_u32 v250, v72, v73
    v_max_u32 v251, v74, v75
    v_max3_u32 v250, v76, v77, v250
    v_max3_u32 v251, v78, v79, v251
    v_max3_u32 v250, v80, v81, v250
    v_max3_u32 v251, v82, v83, v251
    v_max3_u32 v250, v84, v85, v250
    v_max3_u32 v251, v86, v87, v251
    v_max3_u32 v250, v88, v89, v250
    v_max3_u32 v251, v90, v91, v251
    v_max_u32 v250, v250, v251
    v_cmp_eq_u32 vcc, -1, v250
    s_cbranch_vccz gated_mix__grouped_kv_mqa__mixer_gmlp__prompt_kernel_o2_r3
    buffer_load_dwordx4 v[72:75], v4, s[36:39], s47 offen offset:0 sc1
    buffer_load_dwordx4 v[76:79], v4, s[36:39], s47 offen offset:1024 sc1
    buffer_load_dwordx4 v[80:83], v4, s[36:39], s47 offen offset:2048 sc1
    buffer_load_dwordx4 v[84:87], v4, s[36:39], s47 offen offset:3072 sc1
    buffer_load_dwordx4 v[88:91], v5, s[36:39], s47 offen offset:0 sc1
gated_mix__grouped_kv_mqa__mixer_gmlp__prompt_kernel_o2_r3:
    s_waitcnt vmcnt(0) lgkmcnt(0)
    s_branch gated_mix__grouped_kv_mqa__mixer_gmlp__prompt_kernel_o2
gated_mix__grouped_kv_mqa__mixer_gmlp__prompt_kernel_o3_retry:
    s_cmp_eq_u32 s77, 0
    s_cbranch_scc1 gated_mix__grouped_kv_mqa__mixer_gmlp__prompt_kernel_o3_ok
    s_sub_u32 s77, s77, 1
    buffer_load_dwordx4 v[72:75], v4, s[36:39], s47 offen offset:0 sc1
    buffer_load_dwordx4 v[76:79], v4, s[36:39], s47 offen offset:1024 sc1
    buffer_load_dwordx4 v[80:83], v4, s[36:39], s47 offen offset:2048 sc1
    buffer_load_dwordx4 v[84:87], v4, s[36:39], s47 offen offset:3072 sc1
    buffer_load_dwordx4 v[88:91], v5, s[36:39], s47 offen offset:0 sc1
    s_waitcnt vmcnt(0) lgkmcnt(0)
    s_branch gated_mix__grouped_kv_mqa__mixer_gmlp__prompt_kernel_o3
gated_mix__grouped_kv_mqa__mixer_gmlp__prompt_kernel_slow:
    s_cmp_lg_u32 s51, 0
    s_cbranch_scc1 gated_mix__grouped_kv_mqa__mixer_gmlp__prompt_kernel_pub
    v_mov_b32 v226, 0xff800000
    v_mov_b32 v227, 0xff800000
    s_mov_b32 s69, 0
gated_mix__grouped_kv_mqa__mixer_gmlp__prompt_kernel_spass:
    s_mov_b32 s51, 0
    v_mov_b64 v[44:45], 0
    v_mov_b64 v[46:47], 0
    v_mov_b64 v[48:49], 0
    v_mov_b64 v[50:51], 0
    v_mov_b64 v[52:53], 0
    v_mov_b64 v[54:55], 0
    v_mov_b64 v[56:57], 0
    v_mov_b64 v[58:59], 0
    v_mov_b64 v[60:61], 0
    v_mov_b64 v[62:63], 0
    v_mov_b64 v[64:65], 0
    v_mov_b64 v[66:67], 0
    v_mov_b64 v[68:69], 0
    v_mov_b64 v[70:71], 0
    v_mov_b64 v[72:73], 0
    v_mov_b64 v[74:75], 0
gated_mix__grouped_kv_mqa__mixer_gmlp__prompt_kernel_sloop:
    s_lshr_b32 s48, s51, 2
    s_mul_i32 s48, s48, 12288
    s_add_u32 s48, s48, 0x26de00
    s_and_b32 s73, s51, 3
    s_lshl_b32 s70, s73, 10
    s_add_u32 s70, s70, s48
    s_mul_i32 s73, s73, 1536
    s_add_u32 s73, s73, s48
    s_add_u32 s73, s73, 5120
    s_bfe_u32 s71, s51, 0x10001
    s_lshl_b32 s71, s71, 9
    s_add_u32 s48, s48, s71
    s_and_b32 s71, s51, 1
    s_lshl_b32 s71, s71, 3
    s_add_u32 s71, s71, s48
    s_add_u32 s71, s71, 4096
    buffer_load_dwordx4 v[88:91], v1, s[36:39], s70 offen sc1
    buffer_load_dwordx2 v[92:93], v2, s[36:39], s71 offen sc1
    buffer_load_dwordx4 v[96:99], v3, s[36:39], s73 offen sc1
    buffer_load_dwordx4 v[100:103], v3, s[36:39], s73 offen offset:768 sc1
    s_waitcnt vmcnt(0)
    v_mfma_f32_32x32x16_bf16 v[12:27], v[88:91], v[76:79], 0
    v_mfma_f32_32x32x8bf16_1k v[12:27], v[92:93], v[84:85], v[12:27]
    v_mfma_f32_32x32x16_bf16 v[28:43], v[88:91], v[80:83], 0
    v_mfma_f32_32x32x8bf16_1k v[28:43], v[92:93], v[86:87], v[28:43]
    s_cmp_lg_u32 s69, 0
    s_nop 10
    s_cbranch_scc1 gated_mix__grouped_kv_mqa__mixer_gmlp__prompt_kernel_s2
    v_max3_f32 v226, v12, v13, v226
    v_max3_f32 v226, v14, v15, v226
    v_max3_f32 v226, v16, v17, v226
    v_max3_f32 v226, v18, v19, v226
    v_max3_f32 v226, v20, v21, v226
    v_max3_f32 v226, v22, v23, v226
    v_max3_f32 v226, v24, v25, v226
    v_max3_f32 v226, v26, v27, v226
    v_max3_f32 v227, v28, v29, v227
    v_max3_f32 v227, v30, v31, v227
    v_max3_f32 v227, v32, v33, v227
    v_max3_f32 v227, v34, v35, v227
    v_max3_f32 v227, v36, v37, v227
    v_max3_f32 v227, v38, v39, v227
    v_max3_f32 v227, v40, v41, v227
    v_max3_f32 v227, v42, v43, v227
    s_branch gated_mix__grouped_kv_mqa__mixer_gmlp__prompt_kernel_snext
gated_mix__grouped_kv_mqa__mixer_gmlp__prompt_kernel_s2:
    v_sub_f32 v12, v12, v226
    v_sub_f32 v13, v13, v226
    v_sub_f32 v14, v14, v226
    v_sub_f32 v15, v15, v226
    v_sub_f32 v16, v16, v226
    v_sub_f32 v17, v17, v226
    v_sub_f32 v18, v18, v226
    v_sub_f32 v19, v19, v226
    v_sub_f32 v20, v20, v226
    v_sub_f32 v21, v21, v226
    v_sub_f32 v22, v22, v226
    v_sub_f32 v23, v23, v226
    v_sub_f32 v24, v24, v226
    v_sub_f32 v25, v25, v226
    v_sub_f32 v26, v26, v226
    v_sub_f32 v27, v27, v226
    v_exp_f32 v12, v12
    v_exp_f32 v13, v13
    v_exp_f32 v14, v14
    v_exp_f32 v15, v15
    v_exp_f32 v16, v16
    v_exp_f32 v17, v17
    v_exp_f32 v18, v18
    v_exp_f32 v19, v19
    v_exp_f32 v20, v20
    v_exp_f32 v21, v21
    v_exp_f32 v22, v22
    v_exp_f32 v23, v23
    v_exp_f32 v24, v24
    v_exp_f32 v25, v25
    v_exp_f32 v26, v26
    v_exp_f32 v27, v27
    s_nop 1
    v_smfmac_f32_32x32x32_bf16 v[44:59], v[96:99], v[12:19], v254
    v_smfmac_f32_32x32x32_bf16 v[44:59], v[100:103], v[20:27], v254
    v_sub_f32 v28, v28, v227
    v_sub_f32 v29, v29, v227
    v_sub_f32 v30, v30, v227
    v_sub_f32 v31, v31, v227
    v_sub_f32 v32, v32, v227
    v_sub_f32 v33, v33, v227
    v_sub_f32 v34, v34, v227
    v_sub_f32 v35, v35, v227
    v_sub_f32 v36, v36, v227
    v_sub_f32 v37, v37, v227
    v_sub_f32 v38, v38, v227
    v_sub_f32 v39, v39, v227
    v_sub_f32 v40, v40, v227
    v_sub_f32 v41, v41, v227
    v_sub_f32 v42, v42, v227
    v_sub_f32 v43, v43, v227
    v_exp_f32 v28, v28
    v_exp_f32 v29, v29
    v_exp_f32 v30, v30
    v_exp_f32 v31, v31
    v_exp_f32 v32, v32
    v_exp_f32 v33, v33
    v_exp_f32 v34, v34
    v_exp_f32 v35, v35
    v_exp_f32 v36, v36
    v_exp_f32 v37, v37
    v_exp_f32 v38, v38
    v_exp_f32 v39, v39
    v_exp_f32 v40, v40
    v_exp_f32 v41, v41
    v_exp_f32 v42, v42
    v_exp_f32 v43, v43
    s_nop 1
    v_smfmac_f32_32x32x32_bf16 v[60:75], v[96:99], v[28:35], v254
    v_smfmac_f32_32x32x32_bf16 v[60:75], v[100:103], v[36:43], v254
gated_mix__grouped_kv_mqa__mixer_gmlp__prompt_kernel_snext:
    s_add_u32 s51, s51, 1
    s_cmp_lt_u32 s51, 64
    s_cbranch_scc1 gated_mix__grouped_kv_mqa__mixer_gmlp__prompt_kernel_sloop
    s_cmp_lg_u32 s69, 0
    s_nop 8
    s_cbranch_scc1 gated_mix__grouped_kv_mqa__mixer_gmlp__prompt_kernel_fin
    s_mov_b32 s69, 1
    v_mov_b64 v[244:245], v[226:227]
    s_nop 1
    v_permlane32_swap_b32 v226, v244
    v_permlane32_swap_b32 v227, v245
    v_max_f32 v226, v226, v244
    v_max_f32 v227, v227, v245
    s_branch gated_mix__grouped_kv_mqa__mixer_gmlp__prompt_kernel_spass
gated_mix__grouped_kv_mqa__mixer_gmlp__prompt_kernel_end:
gated_mix__grouped_kv_mqa__mixer_gmlp__prompt_kernel_exit:
    s_endpgm

.section .rodata,"a"
.p2align 6
.amdhsa_kernel gated_mix__grouped_kv_mqa__mixer_gmlp__prompt_kernel
  .amdhsa_next_free_vgpr 256
  .amdhsa_next_free_sgpr 102
  .amdhsa_accum_offset 256
  .amdhsa_group_segment_fixed_size 0
  .amdhsa_kernarg_size 112
  .amdhsa_user_sgpr_count 2
  .amdhsa_user_sgpr_kernarg_segment_ptr 1
  .amdhsa_system_sgpr_workgroup_id_x 1
.end_amdhsa_kernel
```
